```python
import torch

def _softmax(x, axis=-1):
    return torch.softmax(x, dim=axis)
def _gelu(x):
    return torch.nn.functional.gelu(x, approximate="tanh")
def _silu(x):
    return torch.nn.functional.silu(x)
def _sigmoid(x):
    return torch.sigmoid(x)
def _layernorm(x, axis=-1, eps=1e-5):
    m = x.mean(dim=axis, keepdim=True)
    v = x.var(dim=axis, keepdim=True, unbiased=False)
    return (x - m) / torch.sqrt(v + eps)
def _scatter_add(tgt, idx, src, axis=0):
    return tgt.clone().index_add_(axis, idx, src)
def _segment_sum(src, seg, n):
    out = torch.zeros((n,) + src.shape[1:], dtype=src.dtype)
    return out.index_add_(0, seg, src)
def _pad(x, pw):
    flat = tuple(v for pair in reversed(pw) for v in pair)
    return torch.nn.functional.pad(x, flat)

kernel_name = 'interleave_layers__linear_kernel_hedgehog__glu_gated_bilinear__prompt'

def setup_inputs():

    _w = (lambda a: (lambda t: t.to(torch.bfloat16) if t.is_floating_point() else t)(torch.as_tensor(a)))
    def _A_setup():
        B, S, D, H = 1, 2048, 512, 32
        Dh = D // H
        return {
            "x": _w((lambda *s: torch.randn(*s, dtype=torch.bfloat16) * 0.05)(B, S, D)),
            "wqkv": _w((lambda *s: torch.randn(*s, dtype=torch.bfloat16) * 0.4)(D, 3 * D)),
            "w_phi": _w((lambda *s: torch.randn(*s, dtype=torch.bfloat16) * 0.4)(H, Dh, Dh) * (Dh ** -0.5)),
            "wo": _w((lambda *s: torch.randn(*s, dtype=torch.bfloat16) * 0.05)(D, D)),
        }
    _A_in = _A_setup()

    def _B_setup():
        B, S, D, F = 1, 2048, 512, 1792
        return {
            "x": _w((lambda *s: torch.randn(*s, dtype=torch.bfloat16) * 0.05)(B, S, D)),
            "w_gate": _w((lambda *s: torch.randn(*s, dtype=torch.bfloat16) * 1.6)(D, F) * (D ** -0.5)),
            "w_up": _w((lambda *s: torch.randn(*s, dtype=torch.bfloat16) * 1.6)(D, F) * (D ** -0.5)),
            "w_down": _w((lambda *s: torch.randn(*s, dtype=torch.bfloat16) * 1.6)(F, D) * (F ** -0.5)),
        }
    _B_in = _B_setup()

    return {
        "A_x": _A_in["x"],
        "A_wqkv": _A_in["wqkv"],
        "A_w_phi": _A_in["w_phi"],
        "A_wo": _A_in["wo"],
        "B_x": _B_in["x"],
        "B_w_gate": _B_in["w_gate"],
        "B_w_up": _B_in["w_up"],
        "B_w_down": _B_in["w_down"],
    }

def reference(A_x, A_wqkv, A_w_phi, A_wo, B_x, B_w_gate, B_w_up, B_w_down):
    def _A_ref(x, wqkv, w_phi, wo):
        B, S, D = x.shape
        H = 32; Dh = D // H
        qkv = (lambda x, *d: x.permute(*d))((x @ wqkv).reshape(B, S, 3, H, Dh), 2, 0, 3, 1, 4)
        q, k, v = qkv[0], qkv[1], qkv[2]
        pq = torch.einsum("bhsd,hdf->bhsf", q, w_phi)
        pk = torch.einsum("bhsd,hdf->bhsf", k, w_phi)
        phi_q = torch.concatenate([_softmax(pq, axis=-1), _softmax(-pq, axis=-1)], axis=-1)
        phi_k = torch.concatenate([_softmax(pk, axis=-1), _softmax(-pk, axis=-1)], axis=-1)
        kv = torch.einsum("bhsf,bhsd->bhfd", phi_k, v)
        z  = torch.einsum("bhsf->bhf", phi_k)
        num = torch.einsum("bhqf,bhfd->bhqd", phi_q, kv)
        den = torch.einsum("bhqf,bhf->bhq", phi_q, z)[..., None] + 1e-6
        o = num / den
        return (lambda x, *d: x.permute(*d))(o, 0, 2, 1, 3).reshape(B, S, D) @ wo

    def _B_ref(x, w_gate, w_up, w_down):
        g = torch.einsum("bsd,df->bsf", x, w_gate)
        u = torch.einsum("bsd,df->bsf", x, w_up)
        h = g * u
        return torch.einsum("bsf,fd->bsd", h, w_down)

    x = A_x
    x = x + _A_ref(_layernorm(x, axis=-1), A_wqkv, A_w_phi, A_wo)
    x = x + _B_ref(_layernorm(x, axis=-1), B_w_gate, B_w_up, B_w_down)
    x = x + _A_ref(_layernorm(x, axis=-1), A_wqkv, A_w_phi, A_wo)
    x = x + _B_ref(_layernorm(x, axis=-1), B_w_gate, B_w_up, B_w_down)
    return x
```

```asm
; @launch grid=(256,1,1) block=(256,1,1) lds=163840
.amdgcn_target "amdgcn-amd-amdhsa--gfx950"
.text
.globl interleave_layers__linear_kernel_hedgehog__glu_gated_bilinear__prompt_kernel
.p2align 8
.type interleave_layers__linear_kernel_hedgehog__glu_gated_bilinear__prompt_kernel,@function
interleave_layers__linear_kernel_hedgehog__glu_gated_bilinear__prompt_kernel:
    s_cmp_lt_u32 s2, 256
    s_cbranch_scc1 L_main_go
    s_endpgm
L_main_go:
    s_load_dwordx2 s[32:33], s[0:1], 80
    s_load_dwordx16 s[16:31], s[0:1], 0
    v_lshrrev_b32 v5, 6, v0
    s_nop 0
    v_readfirstlane_b32 s3, v5
    s_getpc_b64 s[44:45]
L_pc:
    s_lshr_b32 s4, s2, 3
    s_lshl_b32 s4, s4, 2
    s_add_u32 s4, s4, s3
    s_min_u32 s4, s4, (L_code_end-L_pc)/1024-1
    s_lshl_b32 s4, s4, 10
    s_add_u32 s44, s44, s4
    s_addc_u32 s45, s45, 0
    s_and_b32 s44, s44, -16
    v_and_b32 v12, 63, v0
    v_lshlrev_b32 v12, 4, v12
    v_mov_b32 v13, s45
    v_add_co_u32 v12, vcc, s44, v12
    s_nop 1
    v_addc_co_u32 v13, vcc, 0, v13, vcc
    global_load_dwordx4 v[252:255], v[12:13], off
    v_and_b32 v201, 63, v0
    v_lshlrev_b32 v209, 4, v201
    v_and_b32 v202, 31, v0
    v_bfe_u32 v203, v0, 5, 1
    v_bfe_u32 v204, v0, 2, 1
    v_bfe_u32 v205, v0, 3, 1
    v_bfe_u32 v206, v0, 4, 1
    v_and_b32 v207, 3, v0
    s_and_b32 s44, s2, 7
    s_lshr_b32 s45, s2, 3
    s_and_b32 s46, s45, 3
    s_lshl_b32 s47, s46, 2
    s_add_u32 s47, s47, s3
    s_bfe_u32 s34, s45, 0x10002
    s_lshl_b32 s5, s44, 1
    s_add_u32 s34, s34, s5
    s_lshr_b32 s35, s45, 3
    v_lshl_add_u32 v212, v205, 2, v207
    v_lshl_add_u32 v215, v204, 3, v212
    v_lshl_add_u32 v215, v206, 4, v215
    v_lshl_add_u32 v211, v206, 3, v212
    v_lshl_add_u32 v211, v204, 4, v211
    s_cmp_eq_u32 s35, 3
    s_cselect_b64 vcc, -1, 0
    s_cselect_b32 s6, 1, 3
    s_lshl_b32 s6, s6, 10
    v_cndmask_b32 v211, v215, v211, vcc
    v_mul_lo_u32 v211, s6, v211
    v_lshl_add_u32 v211, v203, 4, v211
    s_add_u32 s5, s35, 1
    s_cmp_lt_u32 s35, 2
    s_cselect_b32 s5, s5, 0
    s_lshl_b32 s5, s5, 10
    s_lshl_b32 s4, s34, 6
    s_add_u32 s4, s4, s5
    s_mul_i32 s5, s47, s6
    s_lshl_b32 s5, s5, 5
    s_add_u32 s4, s4, s5
    v_lshlrev_b32 v212, 5, v215
    v_lshl_add_u32 v212, v203, 4, v212
    s_lshl_b32 s5, s34, 10
    s_lshl_b32 s7, s2, 2
    s_add_u32 s7, s7, s3
    s_lshl_b32 s7, s7, 11
    s_waitcnt lgkmcnt(0)
    s_cmp_eq_u32 s35, 3
    s_cselect_b32 s40, s22, s18
    s_cselect_b32 s41, s23, s19
    s_lshl_b32 s42, s6, 9
    s_and_b32 s41, s41, 0xffff
    s_mov_b32 s43, 0x20000
    s_mov_b32 s48, s20
    s_and_b32 s49, s21, 0xffff
    s_mov_b32 s50, 16384
    s_mov_b32 s51, 0x20000
    buffer_load_dwordx4 v[40:43], v212, s[48:51], s5 offen
    buffer_load_dwordx4 v[64:67], v211, s[40:43], s4 offen
    buffer_load_dwordx4 v[68:71], v211, s[40:43], s4 offen offset:32
    s_mov_b32 s12, s16
    s_and_b32 s13, s17, 0xffff
    s_mov_b32 s14, 2097152
    s_mov_b32 s15, 0x20000
    buffer_load_dwordx4 v[160:163], v209, s[12:15], s7 offen
    buffer_load_dwordx4 v[164:167], v209, s[12:15], s7 offen offset:1024
    s_mov_b32 s8, s32
    s_and_b32 s9, s33, 0xffff
    s_mov_b32 s10, 38633472
    s_mov_b32 s11, 0x20000
    s_cmp_lt_u32 s2, 112
    s_cbranch_scc1 L_nc_gu
    s_cmp_lt_u32 s2, 168
    s_cbranch_scc1 L_nc_wd
    s_mov_b32 s80, s22
    s_and_b32 s81, s23, 0xffff
    s_mov_b32 s82, 0
    s_mov_b32 s83, 0x20000
    s_mov_b32 s84, s22
    s_and_b32 s85, s23, 0xffff
    s_mov_b32 s86, 0
    s_mov_b32 s87, 0x20000
    s_mov_b32 s72, s8
    s_mov_b32 s73, s9
    s_mov_b32 s74, 0
    s_mov_b32 s75, 0x20000
    s_mov_b32 s88, 0
    s_mov_b32 s6, 0
    s_mov_b32 s89, 0
    s_mov_b32 s56, 0
    s_mov_b32 s57, 0
    s_branch L_nc_go
L_nc_gu:
    s_mov_b32 s80, s26
    s_and_b32 s81, s27, 0xffff
    s_mov_b32 s82, 1835008
    s_mov_b32 s83, 0x20000
    s_mov_b32 s84, s28
    s_and_b32 s85, s29, 0xffff
    s_mov_b32 s86, 1835008
    s_mov_b32 s87, 0x20000
    s_mov_b32 s72, s8
    s_mov_b32 s73, s9
    s_mov_b32 s74, 38633472
    s_mov_b32 s75, 0x20000
    s_lshr_b32 s56, s2, 2
    s_and_b32 s57, s2, 3
    s_lshl_b32 s5, s57, 2
    s_add_u32 s5, s5, s3
    s_mul_i32 s88, s5, 114688
    s_lshl_b32 s6, s56, 7
    s_add_u32 s88, s88, s6
    s_mov_b32 s6, 3584
    s_mov_b32 s89, s88
    s_branch L_nc_go
L_nc_wd:
    s_mov_b32 s80, s30
    s_and_b32 s81, s31, 0xffff
    s_mov_b32 s82, 1835008
    s_mov_b32 s83, 0x20000
    s_mov_b32 s84, s30
    s_and_b32 s85, s31, 0xffff
    s_mov_b32 s86, 1835008
    s_mov_b32 s87, 0x20000
    s_mov_b32 s72, s8
    s_mov_b32 s73, s9
    s_mov_b32 s74, 38633472
    s_mov_b32 s75, 0x20000
    s_sub_u32 s56, s2, 112
    s_mul_i32 s57, s56, 147
    s_lshr_b32 s57, s57, 10
    s_mul_i32 s5, s57, 7
    s_sub_u32 s56, s56, s5
    s_lshl_b32 s56, s56, 2
    s_add_u32 s56, s56, s3
    s_lshl_b32 s88, s56, 16
    s_lshl_b32 s5, s57, 7
    s_add_u32 s88, s88, s5
    s_mov_b32 s6, 1024
    s_add_u32 s89, s88, 32768
L_nc_go:
    v_lshrrev_b32 v213, 3, v201
    v_mul_lo_u32 v112, s6, v213
    v_lshrrev_b32 v213, 4, v201
    v_and_b32 v214, 7, v201
    v_xor_b32 v213, v213, v214
    v_lshl_add_u32 v112, v213, 4, v112
    v_xor_b32 v113, 64, v112
    s_lshl_b32 s90, s6, 3
    s_lshl_b32 s91, s3, 13
    s_add_u32 s91, s91, 0x20000
    s_add_u32 s54, s32, 7815168
    s_addc_u32 s55, s33, 0
    s_load_dword s60, s[54:55], 0
    s_mov_b64 s[62:63], s[32:33]
    s_mov_b32 s92, s12
    s_mov_b32 s93, s13
    s_mov_b32 s94, s14
    s_mov_b32 s95, 0x20000
    s_lshr_b32 s5, s2, 5
    s_lshr_b32 s4, s44, 2
    s_lshl_b32 s4, s4, 3
    s_add_u32 s4, s4, s5
    s_lshl_b32 s4, s4, 2
    s_add_u32 s4, s4, s3
    s_lshl_b32 s48, s4, 15
    s_lshl_b32 s49, s3, 15
    s_mul_i32 s37, s34, 98304
    s_add_u32 m0, s91, 0
    s_nop 0
    buffer_load_dwordx4 v112, s[80:83], s88 offen lds
    s_add_u32 s88, s88, s90
    s_cmp_lt_u32 s35, 2
    s_cselect_b32 s5, s35, 64
    s_cselect_b32 s7, 2, 1
    s_lshl_b32 s5, s5, 10
    s_lshl_b32 s7, s7, 10
    s_add_u32 s37, s37, s5
    s_mul_i32 s5, s47, s7
    s_lshl_b32 s5, s5, 1
    s_add_u32 s52, s37, s5
    s_add_u32 s52, s52, 0
    s_lshl_b32 s5, s35, 4
    s_add_u32 s5, s5, s34
    s_lshl_b32 s5, s5, 4
    s_add_u32 s5, s5, s47
    s_lshl_b32 s5, s5, 7
    s_add_u32 m0, s91, 1024
    s_nop 0
    buffer_load_dwordx4 v113, s[80:83], s88 offen lds
    s_add_u32 s88, s88, s90
    s_add_u32 s76, s5, 38535168
    s_lshl_b32 s53, s34, 15
    s_lshl_b32 s5, s47, 11
    s_add_u32 s53, s53, s5
    s_add_u32 s53, s53, 1572864
    s_cmp_eq_u32 s35, 3
    s_cselect_b32 s52, s53, s52
    s_cselect_b32 s76, 2147479552, s76
    s_cselect_b64 s[36:37], -1, 0
    s_add_u32 s53, s52, s7
    s_lshl_b32 s38, s2, 7
    s_add_u32 s38, s38, 7774208
    v_lshl_add_u32 v212, v204, 2, v207
    v_cmp_eq_u32 vcc, v203, v205
    s_nop 1
    v_cndmask_b32 v213, 0, 1, vcc
    v_and_b32 v214, v213, v206
    s_add_u32 m0, s91, 2048
    s_nop 0
    buffer_load_dwordx4 v112, s[80:83], s88 offen lds
    s_add_u32 s88, s88, s90
    v_sub_u32 v213, v213, v214
    v_and_b32 v224, 1, v212
    v_lshlrev_b32 v224, 4, v224
    v_mov_b32 v225, 0x3f80
    v_lshlrev_b32 v224, v224, v225
    v_cmp_ne_u32 vcc, 0, v213
    s_nop 1
    v_cndmask_b32 v224, 0, v224, vcc
    v_lshrrev_b32 v225, 1, v212
    v_cmp_eq_u32 vcc, 0, v225
    s_nop 1
    v_cndmask_b32 v216, 0, v224, vcc
    v_cmp_eq_u32 vcc, 1, v225
    s_nop 1
    v_cndmask_b32 v217, 0, v224, vcc
    v_cmp_eq_u32 vcc, 2, v225
    s_add_u32 m0, s91, 3072
    s_nop 0
    buffer_load_dwordx4 v113, s[80:83], s88 offen lds
    s_add_u32 s88, s88, s90
    v_cndmask_b32 v218, 0, v224, vcc
    v_cmp_eq_u32 vcc, 3, v225
    s_nop 1
    v_cndmask_b32 v219, 0, v224, vcc
    v_and_b32 v224, 1, v212
    v_lshlrev_b32 v224, 4, v224
    v_mov_b32 v225, 0x3f80
    v_lshlrev_b32 v224, v224, v225
    v_cmp_ne_u32 vcc, 0, v214
    s_nop 1
    v_cndmask_b32 v224, 0, v224, vcc
    v_lshrrev_b32 v225, 1, v212
    v_cmp_eq_u32 vcc, 0, v225
    s_nop 1
    v_cndmask_b32 v220, 0, v224, vcc
    v_cmp_eq_u32 vcc, 1, v225
    s_add_u32 m0, s91, 4096
    s_nop 0
    buffer_load_dwordx4 v112, s[84:87], s89 offen lds
    s_add_u32 s89, s89, s90
    v_cndmask_b32 v221, 0, v224, vcc
    v_cmp_eq_u32 vcc, 2, v225
    s_nop 1
    v_cndmask_b32 v222, 0, v224, vcc
    v_cmp_eq_u32 vcc, 3, v225
    s_nop 1
    v_cndmask_b32 v223, 0, v224, vcc
    v_lshl_add_u32 v212, v205, 2, v207
    v_cmp_eq_u32 vcc, v203, v204
    s_nop 1
    v_cndmask_b32 v213, 0, 1, vcc
    v_and_b32 v214, v213, v206
    v_sub_u32 v213, v213, v214
    v_and_b32 v224, 1, v212
    v_lshlrev_b32 v224, 4, v224
    v_mov_b32 v225, 0x3f80
    s_add_u32 m0, s91, 5120
    s_nop 0
    buffer_load_dwordx4 v113, s[84:87], s89 offen lds
    s_add_u32 s89, s89, s90
    v_lshlrev_b32 v224, v224, v225
    v_cmp_ne_u32 vcc, 0, v213
    s_nop 1
    v_cndmask_b32 v224, 0, v224, vcc
    v_lshrrev_b32 v225, 1, v212
    v_cmp_eq_u32 vcc, 0, v225
    s_nop 1
    v_cndmask_b32 v32, 0, v224, vcc
    v_cmp_eq_u32 vcc, 1, v225
    s_nop 1
    v_cndmask_b32 v33, 0, v224, vcc
    v_cmp_eq_u32 vcc, 2, v225
    s_nop 1
    v_cndmask_b32 v34, 0, v224, vcc
    v_cmp_eq_u32 vcc, 3, v225
    s_nop 1
    v_cndmask_b32 v35, 0, v224, vcc
    v_and_b32 v224, 1, v212
    s_add_u32 m0, s91, 6144
    s_nop 0
    buffer_load_dwordx4 v112, s[84:87], s89 offen lds
    s_add_u32 s89, s89, s90
    v_lshlrev_b32 v224, 4, v224
    v_mov_b32 v225, 0x3f80
    v_lshlrev_b32 v224, v224, v225
    v_cmp_ne_u32 vcc, 0, v214
    s_nop 1
    v_cndmask_b32 v224, 0, v224, vcc
    v_lshrrev_b32 v225, 1, v212
    v_cmp_eq_u32 vcc, 0, v225
    s_nop 1
    v_cndmask_b32 v36, 0, v224, vcc
    v_cmp_eq_u32 vcc, 1, v225
    s_nop 1
    v_cndmask_b32 v37, 0, v224, vcc
    v_cmp_eq_u32 vcc, 2, v225
    s_nop 1
    v_cndmask_b32 v38, 0, v224, vcc
    v_cmp_eq_u32 vcc, 3, v225
    s_add_u32 m0, s91, 7168
    s_nop 0
    buffer_load_dwordx4 v113, s[84:87], s89 offen lds
    s_add_u32 s89, s89, s90
    v_cndmask_b32 v39, 0, v224, vcc
    v_lshl_add_u32 v212, v205, 2, v207
    v_cmp_eq_u32 vcc, v203, v206
    s_nop 1
    v_cndmask_b32 v213, 0, 1, vcc
    v_and_b32 v224, 1, v212
    v_lshlrev_b32 v224, 4, v224
    v_mov_b32 v225, 0x3f80
    v_lshlrev_b32 v224, v224, v225
    v_cmp_ne_u32 vcc, 0, v213
    s_nop 1
    v_cndmask_b32 v224, 0, v224, vcc
    v_lshrrev_b32 v225, 1, v212
    v_cmp_eq_u32 vcc, 0, v225
    s_nop 1
    v_cndmask_b32 v44, 0, v224, vcc
    s_add_u32 m0, s49, 0
    s_add_u32 s50, s48, 0
    v_xor_b32 v114, 0, v209
    buffer_load_dwordx4 v114, s[92:95], s50 offen offset:0 lds
    v_cmp_eq_u32 vcc, 1, v225
    s_nop 1
    v_cndmask_b32 v45, 0, v224, vcc
    v_cmp_eq_u32 vcc, 2, v225
    s_nop 1
    v_cndmask_b32 v46, 0, v224, vcc
    v_cmp_eq_u32 vcc, 3, v225
    s_nop 1
    v_cndmask_b32 v47, 0, v224, vcc
    v_mov_b32 v116, v215
    v_lshl_add_u32 v212, v206, 2, v207
    v_cmp_eq_u32 vcc, v203, v204
    s_nop 1
    v_cndmask_b32 v213, 0, 1, vcc
    v_and_b32 v214, v213, v205
    v_sub_u32 v213, v213, v214
    v_and_b32 v224, 1, v212
    v_xor_b32 v115, 16, v209
    buffer_load_dwordx4 v115, s[92:95], s50 offen offset:1024 lds
    v_lshlrev_b32 v224, 4, v224
    v_mov_b32 v225, 0x3f80
    v_lshlrev_b32 v224, v224, v225
    v_cmp_ne_u32 vcc, 0, v213
    s_nop 1
    v_cndmask_b32 v224, 0, v224, vcc
    v_lshrrev_b32 v225, 1, v212
    v_cmp_eq_u32 vcc, 0, v225
    s_nop 1
    v_cndmask_b32 v48, 0, v224, vcc
    v_cmp_eq_u32 vcc, 1, v225
    s_nop 1
    v_cndmask_b32 v49, 0, v224, vcc
    v_cmp_eq_u32 vcc, 2, v225
    s_nop 1
    v_cndmask_b32 v50, 0, v224, vcc
    v_cmp_eq_u32 vcc, 3, v225
    v_xor_b32 v114, 32, v209
    buffer_load_dwordx4 v114, s[92:95], s50 offen offset:2048 lds
    v_cndmask_b32 v51, 0, v224, vcc
    v_and_b32 v224, 1, v212
    v_lshlrev_b32 v224, 4, v224
    v_mov_b32 v225, 0x3f80
    v_lshlrev_b32 v224, v224, v225
    v_cmp_ne_u32 vcc, 0, v214
    s_nop 1
    v_cndmask_b32 v224, 0, v224, vcc
    v_lshrrev_b32 v225, 1, v212
    v_cmp_eq_u32 vcc, 0, v225
    s_nop 1
    v_cndmask_b32 v52, 0, v224, vcc
    v_cmp_eq_u32 vcc, 1, v225
    s_nop 1
    v_cndmask_b32 v53, 0, v224, vcc
    v_cmp_eq_u32 vcc, 2, v225
    v_xor_b32 v115, 48, v209
    buffer_load_dwordx4 v115, s[92:95], s50 offen offset:3072 lds
    v_cndmask_b32 v54, 0, v224, vcc
    v_cmp_eq_u32 vcc, 3, v225
    s_nop 1
    v_cndmask_b32 v55, 0, v224, vcc
    s_cmp_lt_u32 s2, 112
    s_cselect_b64 vcc, -1, 0
    v_cndmask_b32 v212, v48, v216, vcc
    v_accvgpr_write_b32 a32, v212
    v_cndmask_b32 v216, v216, v32, s[36:37]
    v_cndmask_b32 v212, v49, v217, vcc
    v_accvgpr_write_b32 a33, v212
    v_cndmask_b32 v217, v217, v33, s[36:37]
    v_cndmask_b32 v212, v50, v218, vcc
    v_accvgpr_write_b32 a34, v212
    v_cndmask_b32 v218, v218, v34, s[36:37]
    s_add_u32 m0, s49, 4096
    s_add_u32 s50, s48, 4096
    v_xor_b32 v114, 64, v209
    buffer_load_dwordx4 v114, s[92:95], s50 offen offset:0 lds
    v_cndmask_b32 v212, v51, v219, vcc
    v_accvgpr_write_b32 a35, v212
    v_cndmask_b32 v219, v219, v35, s[36:37]
    v_cndmask_b32 v212, v52, v220, vcc
    v_accvgpr_write_b32 a36, v212
    v_cndmask_b32 v220, v220, v36, s[36:37]
    v_cndmask_b32 v212, v53, v221, vcc
    v_accvgpr_write_b32 a37, v212
    v_cndmask_b32 v221, v221, v37, s[36:37]
    v_cndmask_b32 v212, v54, v222, vcc
    v_accvgpr_write_b32 a38, v212
    v_cndmask_b32 v222, v222, v38, s[36:37]
    v_cndmask_b32 v212, v55, v223, vcc
    v_xor_b32 v115, 80, v209
    buffer_load_dwordx4 v115, s[92:95], s50 offen offset:1024 lds
    v_accvgpr_write_b32 a39, v212
    v_cndmask_b32 v223, v223, v39, s[36:37]
    s_lshr_b32 s36, s2, 2
    s_and_b32 s7, s2, 3
    s_lshl_b32 s5, s7, 15
    s_lshl_b32 s6, s36, 9
    s_add_u32 s5, s5, s6
    s_add_u32 s5, s5, 7643136
    s_min_u32 s4, s7, 2
    s_lshl_b32 s4, s4, 13
    s_lshl_b32 s6, s36, 7
    s_add_u32 s4, s4, s6
    s_add_u32 s4, s4, 7618560
    v_xor_b32 v114, 96, v209
    buffer_load_dwordx4 v114, s[92:95], s50 offen offset:2048 lds
    s_lshr_b32 s6, s35, 1
    s_lshl_b32 s6, s6, 13
    s_lshl_b32 s36, s34, 7
    s_add_u32 s6, s6, s36
    s_add_u32 s6, s6, 7591936
    v_lshlrev_b32 v208, 7, v201
    v_add_u32 v208, s5, v208
    v_mov_b32 v229, s4
    v_cmp_eq_u32 vcc, 4, v201
    s_nop 1
    v_cndmask_b32 v208, v208, v229, vcc
    v_lshlrev_b32 v229, 11, v201
    v_add_u32 v229, s6, v229
    v_cmp_lt_u32 vcc, 4, v201
    v_xor_b32 v115, 112, v209
    buffer_load_dwordx4 v115, s[92:95], s50 offen offset:3072 lds
    v_cndmask_b32 v208, v208, v229, vcc
    s_cmp_eq_u32 s46, 0
    s_cselect_b32 s6, 1, 0
    s_and_b32 s4, s35, 1
    s_andn2_b32 s6, s6, s4
    s_cmp_eq_u32 s6, 1
    s_cselect_b32 s36, 0x1ff, 31
    s_mov_b32 s37, 0
    s_load_dwordx2 s[6:7], s[0:1], 64
    v_and_b32 v6, 63, v0
    v_lshlrev_b32 v1, 4, v6
    s_and_b32 s42, s2, 7
    s_lshr_b32 s16, s2, 5
    s_lshr_b32 s46, s42, 2
    s_lshl_b32 s46, s46, 3
    s_add_u32 m0, s49, 8192
    s_add_u32 s50, s48, 8192
    v_xor_b32 v114, 128, v209
    buffer_load_dwordx4 v114, s[92:95], s50 offen offset:0 lds
    s_add_u32 s16, s16, s46
    s_bfe_u32 s17, s2, 131075
    s_and_b32 s42, s42, 3
    s_lshl_b32 s42, s42, 2
    s_add_u32 s17, s17, s42
    s_lshl_b32 s26, s3, 12
    s_lshl_b32 s27, s3, 14
    s_mul_i32 s22, s17, 98304
    s_add_u32 s22, s22, s26
    s_lshl_b32 s18, s16, 2
    s_add_u32 s18, s18, s3
    s_lshl_b32 s20, s18, 15
    s_lshl_b32 s21, s18, 12
    v_xor_b32 v115, 144, v209
    buffer_load_dwordx4 v115, s[92:95], s50 offen offset:1024 lds
    s_waitcnt lgkmcnt(0)
    s_add_u32 s60, s60, 1
    s_mov_b32 s12, s6
    s_and_b32 s13, s7, 0xffff
    s_mov_b32 s14, 2097152
    s_mov_b32 s15, 0x20000
    s_mul_i32 s23, s17, 229376
    s_add_u32 s23, s23, 2097152
    s_and_b32 s42, s17, 3
    s_lshl_b32 s42, s42, 2
    s_add_u32 s29, s42, s3
    s_lshl_b32 s24, s29, 15
    s_add_u32 s24, s24, 1572864
    v_xor_b32 v114, 160, v209
    buffer_load_dwordx4 v114, s[92:95], s50 offen offset:2048 lds
    s_lshr_b32 s42, s17, 2
    s_lshl_b32 s28, s16, 2
    s_add_u32 s28, s28, s42
    s_bfe_u32 s42, s2, 0x30003
    s_and_b32 s46, s2, 7
    s_lshl_b32 s46, s46, 2
    s_lshr_b32 s43, s2, 6
    s_add_u32 s46, s46, s43
    s_lshl_b32 s43, s42, 2
    s_add_u32 s43, s43, s3
    s_mul_i32 s25, s43, 57344
    s_add_u32 s25, s25, 5767168
    s_lshl_b32 s42, s42, 1
    v_xor_b32 v115, 176, v209
    buffer_load_dwordx4 v115, s[92:95], s50 offen offset:3072 lds
    s_and_b32 s43, s3, 1
    s_add_u32 s31, s42, s43
    s_lshl_b32 s42, s46, 1
    s_lshr_b32 s43, s3, 1
    s_add_u32 s30, s42, s43
    s_xor_b32 s43, s43, 1
    s_add_u32 s33, s42, s43
    s_mov_b32 s32, s30
    v_add_u32 v2, 0x10000, v1
    v_add_u32 v3, 0x20000, v1
    v_lshlrev_b32 v4, 2, v6
    v_and_b32 v7, 31, v6
    v_lshrrev_b32 v8, 5, v6
    s_add_u32 m0, s49, 12288
    s_add_u32 s50, s48, 12288
    v_xor_b32 v114, 192, v209
    buffer_load_dwordx4 v114, s[92:95], s50 offen offset:0 lds
    v_bfe_u32 v9, v6, 2, 1
    v_bfe_u32 v10, v6, 3, 1
    v_bfe_u32 v11, v6, 4, 1
    v_and_b32 v12, 3, v6
    v_and_b32 v13, 15, v6
    v_lshrrev_b32 v14, 4, v6
    s_add_u32 s42, s27, 98304
    v_lshlrev_b32 v15, 4, v7
    v_lshl_add_u32 v15, v8, 10, v15
    v_add_u32 v15, s42, v15
    v_accvgpr_write_b32 a232, v15
    v_lshl_add_u32 v15, v10, 2, v12
    v_lshl_add_u32 v15, v9, 3, v15
    v_xor_b32 v115, 208, v209
    buffer_load_dwordx4 v115, s[92:95], s50 offen offset:1024 lds
    v_lshl_add_u32 v15, v8, 4, v15
    v_lshl_add_u32 v15, v11, 5, v15
    v_lshlrev_b32 v15, 2, v15
    v_add_u32 v15, s42, v15
    v_accvgpr_write_b32 a233, v15
    v_lshl_add_u32 v15, v13, 1, v8
    v_lshlrev_b32 v15, 2, v15
    v_add_u32 v15, s42, v15
    v_accvgpr_write_b32 a234, v15
    v_lshlrev_b32 v15, 4, v8
    v_add_u32 v15, s42, v15
    v_accvgpr_write_b32 a235, v15
    v_and_b32 v15, 1, v6
    v_xor_b32 v114, 224, v209
    buffer_load_dwordx4 v114, s[92:95], s50 offen offset:2048 lds
    v_lshlrev_b32 v15, 5, v15
    v_lshrrev_b32 v16, 1, v7
    v_add_u32 v15, v15, v16
    v_lshlrev_b32 v15, 2, v15
    v_accvgpr_write_b32 a236, v15
    v_lshl_add_u32 v15, v7, 1, v8
    v_lshlrev_b32 v15, 2, v15
    v_accvgpr_write_b32 a237, v15
    v_lshlrev_b32 v15, 10, v7
    v_lshl_add_u32 v15, v8, 4, v15
    v_accvgpr_write_b32 a238, v15
    v_add_u32 v15, s42, v1
    v_accvgpr_write_b32 a239, v15
    v_xor_b32 v115, 240, v209
    buffer_load_dwordx4 v115, s[92:95], s50 offen offset:3072 lds
    v_lshlrev_b32 v15, 4, v13
    v_lshl_add_u32 v15, v8, 8, v15
    v_lshl_add_u32 v15, v11, 10, v15
    v_accvgpr_write_b32 a240, v15
    s_lshl_b32 s43, s3, 9
    s_add_u32 s43, s43, 110592
    v_lshlrev_b32 v15, 4, v7
    v_lshl_add_u32 v15, v8, 3, v15
    v_add_u32 v15, s43, v15
    v_accvgpr_write_b32 a241, v15
    v_cmp_eq_u32 vcc, v9, v8
    v_lshrrev_b32 v16, 3, v7
    v_lshl_add_u32 v16, v16, 2, v12
    s_add_u32 m0, s49, 16384
    s_add_u32 s50, s48, 16384
    v_xor_b32 v114, 0, v209
    buffer_load_dwordx4 v114, s[92:95], s50 offen offset:0 lds
    v_lshl_add_u32 v16, v8, 4, v16
    v_lshlrev_b32 v16, 4, v16
    v_add_u32 v16, 110592, v16
    v_mov_b32 v17, 126976
    v_cndmask_b32 v15, v17, v16, vcc
    v_accvgpr_write_b32 a242, v15
    v_lshlrev_b32 v16, 6, v8
    v_add_u32 v16, s42, v16
    v_add_u32 v16, 15360, v16
    v_cndmask_b32 v15, v17, v16, vcc
    v_accvgpr_write_b32 a243, v15
    v_lshl_add_u32 v15, v13, 2, v14
    v_lshlrev_b32 v15, 1, v15
    v_xor_b32 v115, 16, v209
    buffer_load_dwordx4 v115, s[92:95], s50 offen offset:1024 lds
    v_add_u32 v15, s42, v15
    v_add_u32 v15, 15360, v15
    v_accvgpr_write_b32 a244, v15
    v_lshl_add_u32 v16, v10, 2, v12
    v_cmp_eq_u32 vcc, v11, v8
    s_nop 1
    v_cndmask_b32 v17, 0, 1, vcc
    v_and_b32 v18, v17, v9
    v_sub_u32 v17, v17, v18
    v_and_b32 v28, 1, v16
    v_lshlrev_b32 v28, 4, v28
    v_mov_b32 v29, 0x3f80
    v_lshlrev_b32 v28, v28, v29
    v_cmp_ne_u32 vcc, 0, v17
    v_xor_b32 v114, 32, v209
    buffer_load_dwordx4 v114, s[92:95], s50 offen offset:2048 lds
    v_cndmask_b32 v28, 0, v28, vcc
    v_lshrrev_b32 v29, 1, v16
    v_cmp_eq_u32 vcc, 0, v29
    s_nop 1
    v_cndmask_b32 v20, 0, v28, vcc
    v_cmp_eq_u32 vcc, 1, v29
    s_nop 1
    v_cndmask_b32 v21, 0, v28, vcc
    v_cmp_eq_u32 vcc, 2, v29
    s_nop 1
    v_cndmask_b32 v22, 0, v28, vcc
    v_cmp_eq_u32 vcc, 3, v29
    s_nop 1
    v_cndmask_b32 v23, 0, v28, vcc
    v_and_b32 v28, 1, v16
    v_lshlrev_b32 v28, 4, v28
    v_mov_b32 v29, 0x3f80
    v_xor_b32 v115, 48, v209
    buffer_load_dwordx4 v115, s[92:95], s50 offen offset:3072 lds
    v_lshlrev_b32 v28, v28, v29
    v_cmp_ne_u32 vcc, 0, v18
    s_nop 1
    v_cndmask_b32 v28, 0, v28, vcc
    v_lshrrev_b32 v29, 1, v16
    v_cmp_eq_u32 vcc, 0, v29
    s_nop 1
    v_cndmask_b32 v24, 0, v28, vcc
    v_cmp_eq_u32 vcc, 1, v29
    s_nop 1
    v_cndmask_b32 v25, 0, v28, vcc
    v_cmp_eq_u32 vcc, 2, v29
    s_nop 1
    v_cndmask_b32 v26, 0, v28, vcc
    v_cmp_eq_u32 vcc, 3, v29
    s_nop 1
    v_cndmask_b32 v27, 0, v28, vcc
    v_accvgpr_write_b32 a248, v20
    v_accvgpr_write_b32 a249, v21
    v_accvgpr_write_b32 a250, v22
    v_accvgpr_write_b32 a251, v23
    v_accvgpr_write_b32 a252, v24
    v_accvgpr_write_b32 a253, v25
    v_accvgpr_write_b32 a254, v26
    v_accvgpr_write_b32 a255, v27
    s_mul_i32 s42, s17, 7
    s_and_b32 s42, s42, -4
    s_lshr_b32 s43, s31, 1
    s_mul_i32 s43, s43, 7
    s_add_u32 s43, s43, 100
    v_and_b32 v6, 63, v0
    v_add_u32 v8, s42, v6
    v_min_u32 v8, 111, v8
    v_add_u32 v9, s43, v6
    v_cmp_lt_u32 vcc, 11, v6
    s_nop 1
    v_cndmask_b32 v8, v8, v9, vcc
    v_lshlrev_b32 v8, 7, v8
    v_add_u32 v8, 7774208, v8
    v_accvgpr_write_b32 a245, v8
    s_and_b32 s42, s29, 1
    s_lshl_b32 s42, s42, 5
    s_lshr_b32 s43, s29, 1
    s_add_u32 s42, s42, s43
    s_add_u32 s42, s42, 192
    s_lshl_b32 s42, s42, 7
    s_add_u32 s98, s42, 7831552
    s_add_u32 s99, s98, 1024
    s_add_u32 s100, s98, 2048
    s_add_u32 s101, s98, 3072
    s_waitcnt vmcnt(28)
    s_and_b32 s5, s35, 1
    s_cmp_eq_u32 s5, 1
    s_cbranch_scc1 L_unit_sel
    v_mfma_f32_32x32x16_bf16 v[96:111], v[40:43], v[44:47], 0
    v_cmp_ne_u32 vcc, 0, v204
    s_nop 10
    v_cvt_pk_bf16_f32 v216, v96, v97
    v_cvt_pk_bf16_f32 v217, v98, v99
    v_cvt_pk_bf16_f32 v218, v100, v101
    v_cvt_pk_bf16_f32 v219, v102, v103
    v_cvt_pk_bf16_f32 v220, v104, v105
    v_cvt_pk_bf16_f32 v221, v106, v107
    v_cvt_pk_bf16_f32 v222, v108, v109
    v_cvt_pk_bf16_f32 v223, v110, v111
    v_cndmask_b32 v216, v216, 0, vcc
    v_cndmask_b32 v220, 0, v220, vcc
    v_cndmask_b32 v217, v217, 0, vcc
    v_cndmask_b32 v221, 0, v221, vcc
    v_cndmask_b32 v218, v218, 0, vcc
    v_cndmask_b32 v222, 0, v222, vcc
    v_cndmask_b32 v219, v219, 0, vcc
    v_cndmask_b32 v223, 0, v223, vcc
L_unit_sel:
    s_nop 1
    v_mfma_f32_32x32x16_bf16 v[96:111], v[64:67], v[216:219], 0
    v_mfma_f32_32x32x16_bf16 v[96:111], v[68:71], v[220:223], v[96:111]
    v_mov_b32 v229, 0
    s_mov_b64 exec, s[36:37]
    buffer_store_dword v229, v208, s[8:11], 0 offen sc1
    s_mov_b64 exec, -1
    v_lshlrev_b32 v72, 16, v160
    v_and_b32 v73, 0xffff0000, v160
    v_lshlrev_b32 v74, 16, v161
    v_and_b32 v75, 0xffff0000, v161
    v_lshlrev_b32 v76, 16, v162
    v_and_b32 v77, 0xffff0000, v162
    v_lshlrev_b32 v78, 16, v163
    v_and_b32 v79, 0xffff0000, v163
    v_cvt_pk_bf16_f32 v48, v96, v97
    v_cvt_pk_bf16_f32 v49, v98, v99
    v_cvt_pk_bf16_f32 v50, v100, v101
    v_cvt_pk_bf16_f32 v51, v102, v103
    buffer_store_dwordx4 v[48:51], v209, s[8:11], s52 offen sc1
    v_cvt_pk_bf16_f32 v52, v104, v105
    v_cvt_pk_bf16_f32 v53, v106, v107
    v_cvt_pk_bf16_f32 v54, v108, v109
    v_cvt_pk_bf16_f32 v55, v110, v111
    buffer_store_dwordx4 v[52:55], v209, s[8:11], s53 offen sc1
    v_pk_add_f32 v[228:229], v[72:73], v[74:75]
    v_pk_mul_f32 v[230:231], v[72:73], v[72:73]
    v_pk_fma_f32 v[230:231], v[74:75], v[74:75], v[230:231]
    v_pk_add_f32 v[228:229], v[228:229], v[76:77]
    v_pk_fma_f32 v[230:231], v[76:77], v[76:77], v[230:231]
    v_pk_add_f32 v[228:229], v[228:229], v[78:79]
    v_pk_fma_f32 v[230:231], v[78:79], v[78:79], v[230:231]
    v_add_f32 v224, v228, v229
    v_add_f32 v226, v230, v231
    v_lshlrev_b32 v80, 16, v164
    v_and_b32 v81, 0xffff0000, v164
    v_lshlrev_b32 v82, 16, v165
    v_and_b32 v83, 0xffff0000, v165
    v_lshlrev_b32 v84, 16, v166
    v_and_b32 v85, 0xffff0000, v166
    v_lshlrev_b32 v86, 16, v167
    v_and_b32 v87, 0xffff0000, v167
    v_pk_add_f32 v[228:229], v[80:81], v[82:83]
    v_pk_mul_f32 v[230:231], v[80:81], v[80:81]
    v_pk_fma_f32 v[230:231], v[82:83], v[82:83], v[230:231]
    v_pk_add_f32 v[228:229], v[228:229], v[84:85]
    v_pk_fma_f32 v[230:231], v[84:85], v[84:85], v[230:231]
    v_pk_add_f32 v[228:229], v[228:229], v[86:87]
    v_pk_fma_f32 v[230:231], v[86:87], v[86:87], v[230:231]
    v_add_f32 v225, v228, v229
    v_add_f32 v227, v230, v231
    v_pk_add_f32 v[228:229], v[96:97], v[98:99]
    v_permlane32_swap_b32 v224, v225
    v_permlane32_swap_b32 v226, v227
    v_add_f32 v224, v224, v225
    v_add_f32 v226, v226, v227
    v_pk_add_f32 v[228:229], v[228:229], v[100:101]
    v_pk_add_f32 v[228:229], v[228:229], v[102:103]
    v_permlane16_swap_b32 v224, v226
    v_add_f32 v224, v224, v226
    v_pk_add_f32 v[228:229], v[228:229], v[104:105]
    s_nop 0
    v_add_f32_dpp v224, v224, v224 row_ror:8 row_mask:0xf bank_mask:0xf
    v_pk_add_f32 v[228:229], v[228:229], v[106:107]
    s_nop 0
    v_add_f32_dpp v224, v224, v224 row_ror:4 row_mask:0xf bank_mask:0xf
    v_pk_add_f32 v[228:229], v[228:229], v[108:109]
    s_nop 0
    v_add_f32_dpp v224, v224, v224 row_ror:2 row_mask:0xf bank_mask:0xf
    v_pk_add_f32 v[228:229], v[228:229], v[110:111]
    s_nop 0
    v_add_f32_dpp v224, v224, v224 row_ror:1 row_mask:0xf bank_mask:0xf
    v_add_f32 v228, v228, v229
    v_mov_b32 v225, v224
    v_mov_b32 v229, v228
    v_lshlrev_b32 v230, 2, v202
    v_permlane16_swap_b32 v224, v225
    v_permlane32_swap_b32 v228, v229
    v_mul_f32 v224, 0x3b000000, v224
    v_mul_f32 v225, 0x3b000000, v225
    v_add_f32 v228, v228, v229
    buffer_store_dword v228, v230, s[8:11], s76 offen sc1
    v_fma_f32 v225, -v224, v224, v225
    v_max_f32 v225, 0, v225
    v_add_f32 v225, 0x3727c5ac, v225
    v_rsq_f32 v225, v225
    v_and_b32 v226, 7, v201
    v_lshlrev_b32 v226, 4, v226
    v_lshl_add_u32 v226, v203, 3, v226
    s_lshl_b32 s4, s2, 2
    s_add_u32 s4, s4, s3
    s_lshl_b32 s4, s4, 7
    s_add_u32 s4, s4, 7929856
    buffer_store_dwordx2 v[224:225], v226, s[8:11], s4 offen sc1
    s_add_u32 m0, s49, 20480
    s_add_u32 s50, s48, 20480
    v_xor_b32 v114, 64, v209
    buffer_load_dwordx4 v114, s[92:95], s50 offen offset:0 lds
    v_xor_b32 v115, 80, v209
    buffer_load_dwordx4 v115, s[92:95], s50 offen offset:1024 lds
    v_xor_b32 v114, 96, v209
    buffer_load_dwordx4 v114, s[92:95], s50 offen offset:2048 lds
    v_xor_b32 v115, 112, v209
    buffer_load_dwordx4 v115, s[92:95], s50 offen offset:3072 lds
    s_add_u32 m0, s49, 24576
    s_add_u32 s50, s48, 24576
    v_xor_b32 v114, 128, v209
    buffer_load_dwordx4 v114, s[92:95], s50 offen offset:0 lds
    v_xor_b32 v115, 144, v209
    buffer_load_dwordx4 v115, s[92:95], s50 offen offset:1024 lds
    v_xor_b32 v114, 160, v209
    buffer_load_dwordx4 v114, s[92:95], s50 offen offset:2048 lds
    v_xor_b32 v115, 176, v209
    buffer_load_dwordx4 v115, s[92:95], s50 offen offset:3072 lds
    s_add_u32 m0, s49, 28672
    s_add_u32 s50, s48, 28672
    v_xor_b32 v114, 192, v209
    buffer_load_dwordx4 v114, s[92:95], s50 offen offset:0 lds
    v_xor_b32 v115, 208, v209
    buffer_load_dwordx4 v115, s[92:95], s50 offen offset:1024 lds
    v_xor_b32 v114, 224, v209
    buffer_load_dwordx4 v114, s[92:95], s50 offen offset:2048 lds
    v_xor_b32 v115, 240, v209
    buffer_load_dwordx4 v115, s[92:95], s50 offen offset:3072 lds
    s_mov_b64 s[4:5], s[62:63]
    s_and_b32 s42, s17, 1
    s_lshl_b32 s42, s42, 5
    s_lshr_b32 s43, s17, 1
    s_add_u32 s42, s42, s43
    s_lshl_b32 s43, s3, 3
    s_add_u32 s42, s42, s43
    s_lshl_b32 s42, s42, 7
    s_add_u32 s42, s42, 7831552
    s_add_u32 s43, s42, 8192
    s_add_u32 s46, s42, 16384
    s_lshl_b32 s34, s2, 7
    s_add_u32 s34, s34, 7831552
    s_waitcnt vmcnt(12)
    s_barrier
    s_cmp_lg_u32 s3, 0
    s_cbranch_scc1 L_pub_1
    v_mov_b32 v8, 0
    v_mov_b32 v9, s60
    s_mov_b64 exec, 1
    buffer_store_dword v9, v8, s[8:11], s34 offen sc1
    s_mov_b64 exec, -1
L_pub_1:
    s_waitcnt vmcnt(0)
    v_accvgpr_read_b32 v16, a238
    v_and_b32 v17, 0xf0, v1
    s_lshl_b32 s35, s3, 15
    v_xor_b32 v16, v16, v17
    v_add_u32 v16, s35, v16
    v_xor_b32 v17, 32, v16
    v_xor_b32 v18, 64, v16
    v_xor_b32 v19, 96, v16
    v_xor_b32 v20, 128, v16
    v_xor_b32 v21, 160, v16
    v_xor_b32 v22, 192, v16
    v_xor_b32 v23, 224, v16
    v_lshrrev_b32 v24, 1, v116
    v_and_b32 v24, 7, v24
    v_lshrrev_b32 v25, 9, v1
    v_xor_b32 v24, v24, v25
    v_lshlrev_b32 v24, 4, v24
    v_lshl_add_u32 v24, v116, 7, v24
    v_add_u32 v24, s91, v24
    s_cmp_lt_u32 s2, 112
    s_cselect_b32 s35, 0, s35
    s_cselect_b32 s36, 0, 0
    s_cselect_b32 s35, s35, s36
    v_xor_b32 v25, s35, v24
    ds_read_b128 a[0:3], v25
    s_cmp_lt_u32 s2, 112
    s_cselect_b32 s35, 4096, s35
    s_cselect_b32 s36, 0, 32
    s_cselect_b32 s35, s35, s36
    v_xor_b32 v26, s35, v24
    ds_read_b128 a[4:7], v26
    s_cmp_lt_u32 s2, 112
    s_cselect_b32 s35, 32, s35
    s_cselect_b32 s36, 0, 64
    s_cselect_b32 s35, s35, s36
    v_xor_b32 v25, s35, v24
    ds_read_b128 a[8:11], v25
    s_cmp_lt_u32 s2, 112
    s_cselect_b32 s35, 4128, s35
    s_cselect_b32 s36, 0, 96
    s_cselect_b32 s35, s35, s36
    v_xor_b32 v26, s35, v24
    ds_read_b128 a[12:15], v26
    s_cmp_lt_u32 s2, 112
    s_cselect_b32 s35, 64, s35
    s_cselect_b32 s36, 0, 4096
    s_cselect_b32 s35, s35, s36
    v_xor_b32 v25, s35, v24
    ds_read_b128 a[16:19], v25
    s_cmp_lt_u32 s2, 112
    s_cselect_b32 s35, 4160, s35
    s_cselect_b32 s36, 0, 4128
    s_cselect_b32 s35, s35, s36
    v_xor_b32 v26, s35, v24
    ds_read_b128 a[20:23], v26
    s_cmp_lt_u32 s2, 112
    s_cselect_b32 s35, 96, s35
    s_cselect_b32 s36, 0, 4160
    s_cselect_b32 s35, s35, s36
    v_xor_b32 v25, s35, v24
    ds_read_b128 a[24:27], v25
    s_cmp_lt_u32 s2, 112
    s_cselect_b32 s35, 4192, s35
    s_cselect_b32 s36, 0, 4192
    s_cselect_b32 s35, s35, s36
    v_xor_b32 v26, s35, v24
    ds_read_b128 a[28:31], v26
    ds_read_b128 v[128:131], v16 offset:0
    ds_read_b128 v[132:135], v17 offset:0
    ds_read_b128 v[136:139], v18 offset:0
    ds_read_b128 v[140:143], v19 offset:0
    ds_read_b128 v[144:147], v20 offset:0
    ds_read_b128 v[148:151], v21 offset:0
    s_waitcnt lgkmcnt(13)
    ds_read_b128 v[152:155], v22 offset:0
    s_waitcnt lgkmcnt(13)
    ds_read_b128 v[156:159], v23 offset:0
    s_waitcnt lgkmcnt(13)
    ds_read_b128 v[160:163], v16 offset:256
    s_waitcnt lgkmcnt(13)
    ds_read_b128 v[164:167], v17 offset:256
    s_waitcnt lgkmcnt(13)
    ds_read_b128 v[168:171], v18 offset:256
    s_waitcnt lgkmcnt(13)
    ds_read_b128 v[172:175], v19 offset:256
    s_mov_b32 s54, 0
    s_waitcnt lgkmcnt(13)
    s_atomic_add s54, s[4:5], s42 glc
    s_mov_b32 s55, 0
    s_waitcnt lgkmcnt(12)
    s_atomic_add s55, s[4:5], s43 glc
    s_mov_b32 s48, 0
    s_waitcnt lgkmcnt(11)
    s_atomic_add s48, s[4:5], s46 glc
    s_waitcnt lgkmcnt(10)
    ds_read_b128 v[176:179], v20 offset:256
    s_waitcnt lgkmcnt(10)
    ds_read_b128 v[180:183], v21 offset:256
    s_waitcnt lgkmcnt(10)
    ds_read_b128 v[184:187], v22 offset:256
    s_waitcnt lgkmcnt(10)
    ds_read_b128 v[188:191], v23 offset:256
    s_waitcnt lgkmcnt(10)
    ds_read_b128 v[192:195], v16 offset:512
    s_waitcnt lgkmcnt(10)
    ds_read_b128 v[196:199], v17 offset:512
    s_waitcnt lgkmcnt(10)
    ds_read_b128 v[200:203], v18 offset:512
    s_waitcnt lgkmcnt(10)
    ds_read_b128 v[204:207], v19 offset:512
    s_waitcnt lgkmcnt(10)
    ds_read_b128 v[208:211], v20 offset:512
    s_waitcnt lgkmcnt(10)
    ds_read_b128 v[212:215], v21 offset:512
    s_waitcnt lgkmcnt(10)
    ds_read_b128 v[216:219], v22 offset:512
    s_waitcnt lgkmcnt(10)
    ds_read_b128 v[220:223], v23 offset:512
    s_waitcnt lgkmcnt(10)
    ds_read_b128 v[224:227], v16 offset:768
    s_waitcnt lgkmcnt(10)
    ds_read_b128 v[228:231], v17 offset:768
    s_waitcnt lgkmcnt(10)
    ds_read_b128 v[232:235], v18 offset:768
    s_waitcnt lgkmcnt(10)
    ds_read_b128 v[236:239], v19 offset:768
    s_waitcnt lgkmcnt(10)
    ds_read_b128 v[240:243], v20 offset:768
    s_waitcnt lgkmcnt(10)
    ds_read_b128 v[244:247], v21 offset:768
    s_waitcnt lgkmcnt(10)
    ds_read_b128 v[248:251], v22 offset:768
    s_waitcnt lgkmcnt(10)
    ds_read_b128 v[252:255], v23 offset:768
    s_cmp_lt_u32 s2, 112
    s_cbranch_scc0 L_ncd_wd
    s_lshl_b32 s35, s57, 2
    s_add_u32 s35, s35, s3
    s_lshl_b32 s36, s56, 17
    s_lshl_b32 s35, s35, 11
    s_add_u32 s36, s36, s35
    s_add_u32 s64, s36, 2097152
    s_add_u32 s65, s36, 2097664
    s_add_u32 s66, s36, 2129920
    s_add_u32 s67, s36, 2130432
    s_add_u32 s68, s36, 2162688
    s_add_u32 s69, s36, 2163200
    s_add_u32 s70, s36, 2195456
    s_add_u32 s71, s36, 2195968
    s_mul_i32 s35, s57, 112
    s_lshl_b32 s36, s56, 2
    s_add_u32 s35, s35, s36
    s_lshl_b32 s35, s35, 7
    s_add_u32 s77, s35, 38469632
    s_branch L_ncd_go
L_ncd_wd:
    s_mov_b32 s77, 2147479552
    s_lshl_b32 s35, s56, 2
    s_add_u32 s35, s35, 0
    s_mul_i32 s36, s35, 147
    s_lshr_b32 s36, s36, 10
    s_mul_i32 s37, s36, 7
    s_sub_u32 s37, s35, s37
    s_lshr_b32 s35, s36, 2
    s_and_b32 s36, s36, 3
    s_lshl_b32 s37, s37, 13
    s_lshr_b32 s64, s36, 1
    s_lshl_b32 s64, s64, 12
    s_add_u32 s37, s37, s64
    s_and_b32 s36, s36, 1
    s_lshl_b32 s36, s36, 9
    s_add_u32 s37, s37, s36
    s_and_b32 s36, s35, 1
    s_lshl_b32 s36, s36, 11
    s_add_u32 s37, s37, s36
    s_lshl_b32 s36, s57, 2
    s_add_u32 s36, s36, s35
    s_mul_i32 s36, s36, 57344
    s_add_u32 s36, s36, s37
    s_add_u32 s64, s36, 5767168
    s_xor_b32 s36, s36, 2048
    s_add_u32 s66, s36, 5767168
    s_lshl_b32 s35, s56, 2
    s_add_u32 s35, s35, 1
    s_mul_i32 s36, s35, 147
    s_lshr_b32 s36, s36, 10
    s_mul_i32 s37, s36, 7
    s_sub_u32 s37, s35, s37
    s_lshr_b32 s35, s36, 2
    s_and_b32 s36, s36, 3
    s_lshl_b32 s37, s37, 13
    s_lshr_b32 s65, s36, 1
    s_lshl_b32 s65, s65, 12
    s_add_u32 s37, s37, s65
    s_and_b32 s36, s36, 1
    s_lshl_b32 s36, s36, 9
    s_add_u32 s37, s37, s36
    s_and_b32 s36, s35, 1
    s_lshl_b32 s36, s36, 11
    s_add_u32 s37, s37, s36
    s_lshl_b32 s36, s57, 2
    s_add_u32 s36, s36, s35
    s_mul_i32 s36, s36, 57344
    s_add_u32 s36, s36, s37
    s_add_u32 s65, s36, 5767168
    s_xor_b32 s36, s36, 2048
    s_add_u32 s67, s36, 5767168
    s_lshl_b32 s35, s56, 2
    s_add_u32 s35, s35, 2
    s_mul_i32 s36, s35, 147
    s_lshr_b32 s36, s36, 10
    s_mul_i32 s37, s36, 7
    s_sub_u32 s37, s35, s37
    s_lshr_b32 s35, s36, 2
    s_and_b32 s36, s36, 3
    s_lshl_b32 s37, s37, 13
    s_lshr_b32 s68, s36, 1
    s_lshl_b32 s68, s68, 12
    s_add_u32 s37, s37, s68
    s_and_b32 s36, s36, 1
    s_lshl_b32 s36, s36, 9
    s_add_u32 s37, s37, s36
    s_and_b32 s36, s35, 1
    s_lshl_b32 s36, s36, 11
    s_add_u32 s37, s37, s36
    s_lshl_b32 s36, s57, 2
    s_add_u32 s36, s36, s35
    s_mul_i32 s36, s36, 57344
    s_add_u32 s36, s36, s37
    s_add_u32 s68, s36, 5767168
    s_xor_b32 s36, s36, 2048
    s_add_u32 s70, s36, 5767168
    s_lshl_b32 s35, s56, 2
    s_add_u32 s35, s35, 3
    s_mul_i32 s36, s35, 147
    s_lshr_b32 s36, s36, 10
    s_mul_i32 s37, s36, 7
    s_sub_u32 s37, s35, s37
    s_lshr_b32 s35, s36, 2
    s_and_b32 s36, s36, 3
    s_lshl_b32 s37, s37, 13
    s_lshr_b32 s69, s36, 1
    s_lshl_b32 s69, s69, 12
    s_add_u32 s37, s37, s69
    s_and_b32 s36, s36, 1
    s_lshl_b32 s36, s36, 9
    s_add_u32 s37, s37, s36
    s_and_b32 s36, s35, 1
    s_lshl_b32 s36, s36, 11
    s_add_u32 s37, s37, s36
    s_lshl_b32 s36, s57, 2
    s_add_u32 s36, s36, s35
    s_mul_i32 s36, s36, 57344
    s_add_u32 s36, s36, s37
    s_add_u32 s69, s36, 5767168
    s_xor_b32 s36, s36, 2048
    s_add_u32 s71, s36, 5767168
L_ncd_go:
    s_waitcnt lgkmcnt(0)
    s_xor_b32 s54, s54, s60
    s_xor_b32 s55, s55, s60
    s_or_b32 s54, s54, s55
    s_xor_b32 s48, s48, s60
    s_or_b32 s54, s54, s48
    s_cmp_eq_u32 s54, 0
    s_cbranch_scc1 L_ok_3
    s_mov_b32 s41, 65536
L_spin_2:
    s_mov_b32 s54, 0
    s_atomic_add s54, s[4:5], s42 glc
    s_mov_b32 s55, 0
    s_atomic_add s55, s[4:5], s43 glc
    s_mov_b32 s48, 0
    s_atomic_add s48, s[4:5], s46 glc
    s_waitcnt lgkmcnt(0)
    s_xor_b32 s54, s54, s60
    s_xor_b32 s55, s55, s60
    s_or_b32 s54, s54, s55
    s_xor_b32 s48, s48, s60
    s_or_b32 s54, s54, s48
    s_cmp_eq_u32 s54, 0
    s_cbranch_scc1 L_ok_3
    s_sub_u32 s41, s41, 1
    s_cbranch_scc0 L_spin_2
L_ok_3:
    s_barrier
    s_add_u32 s47, s20, 8978432
    s_mul_i32 s46, s3, 3072
    s_mul_i32 s52, s17, 98304
    s_add_u32 s52, s52, s46
    s_add_u32 m0, s46, 0
    s_add_u32 s40, s52, 0
    buffer_load_dwordx4 v1, s[8:11], s40 offen offset:0 sc1 lds
    buffer_load_dwordx4 v1, s[8:11], s40 offen offset:1024 sc1 lds
    buffer_load_dwordx4 v1, s[8:11], s40 offen offset:2048 sc1 lds
    s_lshl_b32 s47, s18, 9
    s_add_u32 s80, s47, 7831552
    s_add_u32 s81, s80, 128
    s_add_u32 s82, s80, 256
    s_add_u32 s83, s80, 384
    s_add_u32 m0, s46, 12288
    s_add_u32 s40, s52, 12288
    buffer_load_dwordx4 v1, s[8:11], s40 offen offset:0 sc1 lds
    s_lshl_b32 s47, s18, 11
    s_add_u32 s47, s47, 7929856
    s_mov_b32 s54, 0
    s_atomic_add s54, s[4:5], s80 glc
    s_mov_b32 s55, 0
    s_atomic_add s55, s[4:5], s81 glc
    s_mov_b32 s48, 0
    s_atomic_add s48, s[4:5], s82 glc
    s_mov_b32 s49, 0
    s_atomic_add s49, s[4:5], s83 glc
    v_and_b32 v10, 0x1e0, v1
    buffer_load_dwordx4 v1, s[8:11], s40 offen offset:1024 sc1 lds
    v_lshlrev_b32 v10, 2, v10
    v_and_b32 v11, 16, v1
    v_lshrrev_b32 v11, 1, v11
    v_add_u32 v10, v10, v11
    v_mfma_f32_32x32x16_bf16 v[64:79], a[0:3], a[32:35], 0
    v_mfma_f32_32x32x16_bf16 v[64:79], a[4:7], a[36:39], v[64:79]
    v_mfma_f32_32x32x16_bf16 v[80:95], a[8:11], a[32:35], 0
    v_mfma_f32_32x32x16_bf16 v[80:95], a[12:15], a[36:39], v[80:95]
    v_mfma_f32_32x32x16_bf16 v[96:111], a[16:19], a[32:35], 0
    v_mfma_f32_32x32x16_bf16 v[96:111], a[20:23], a[36:39], v[96:111]
    v_mfma_f32_32x32x16_bf16 v[112:127], a[24:27], a[32:35], 0
    buffer_load_dwordx4 v1, s[8:11], s40 offen offset:2048 sc1 lds
    v_mfma_f32_32x32x16_bf16 v[112:127], a[28:31], a[36:39], v[112:127]
    s_nop 4
    v_pk_add_f32 v[16:17], v[64:65], v[66:67]
    v_pk_add_f32 v[16:17], v[16:17], v[68:69]
    v_pk_add_f32 v[16:17], v[16:17], v[70:71]
    v_pk_add_f32 v[16:17], v[16:17], v[72:73]
    v_pk_add_f32 v[16:17], v[16:17], v[74:75]
    v_pk_add_f32 v[16:17], v[16:17], v[76:77]
    v_pk_add_f32 v[16:17], v[16:17], v[78:79]
    v_add_f32 v20, v16, v17
    v_pk_add_f32 v[16:17], v[80:81], v[82:83]
    v_pk_add_f32 v[16:17], v[16:17], v[84:85]
    s_add_u32 m0, s46, 24576
    s_add_u32 s40, s52, 24576
    buffer_load_dwordx4 v1, s[8:11], s40 offen offset:0 sc1 lds
    v_pk_add_f32 v[16:17], v[16:17], v[86:87]
    v_pk_add_f32 v[16:17], v[16:17], v[88:89]
    v_pk_add_f32 v[16:17], v[16:17], v[90:91]
    v_pk_add_f32 v[16:17], v[16:17], v[92:93]
    v_pk_add_f32 v[16:17], v[16:17], v[94:95]
    v_add_f32 v21, v16, v17
    v_pk_add_f32 v[16:17], v[96:97], v[98:99]
    v_pk_add_f32 v[16:17], v[16:17], v[100:101]
    v_pk_add_f32 v[16:17], v[16:17], v[102:103]
    v_pk_add_f32 v[16:17], v[16:17], v[104:105]
    v_pk_add_f32 v[16:17], v[16:17], v[106:107]
    buffer_load_dwordx4 v1, s[8:11], s40 offen offset:1024 sc1 lds
    v_pk_add_f32 v[16:17], v[16:17], v[108:109]
    v_pk_add_f32 v[16:17], v[16:17], v[110:111]
    v_add_f32 v22, v16, v17
    v_pk_add_f32 v[16:17], v[112:113], v[114:115]
    v_pk_add_f32 v[16:17], v[16:17], v[116:117]
    v_pk_add_f32 v[16:17], v[16:17], v[118:119]
    v_pk_add_f32 v[16:17], v[16:17], v[120:121]
    v_pk_add_f32 v[16:17], v[16:17], v[122:123]
    v_pk_add_f32 v[16:17], v[16:17], v[124:125]
    v_pk_add_f32 v[16:17], v[16:17], v[126:127]
    v_add_f32 v23, v16, v17
    buffer_load_dwordx4 v1, s[8:11], s40 offen offset:2048 sc1 lds
    v_permlane32_swap_b32 v20, v21
    v_permlane32_swap_b32 v22, v23
    v_add_f32 v20, v20, v21
    v_add_f32 v22, v22, v23
    v_add_u32 v19, s91, v4
    ds_write2st64_b32 v19, v20, v22 offset0:0 offset1:1
    v_cvt_pk_bf16_f32 v32, v64, v65
    v_cvt_pk_bf16_f32 v33, v66, v67
    v_cvt_pk_bf16_f32 v34, v68, v69
    v_cvt_pk_bf16_f32 v35, v70, v71
    v_cvt_pk_bf16_f32 v36, v72, v73
    s_add_u32 m0, s46, 36864
    s_add_u32 s40, s52, 36864
    buffer_load_dwordx4 v1, s[8:11], s40 offen offset:0 sc1 lds
    v_cvt_pk_bf16_f32 v37, v74, v75
    v_cvt_pk_bf16_f32 v38, v76, v77
    v_cvt_pk_bf16_f32 v39, v78, v79
    v_cvt_pk_bf16_f32 v40, v80, v81
    v_cvt_pk_bf16_f32 v41, v82, v83
    v_cvt_pk_bf16_f32 v42, v84, v85
    v_cvt_pk_bf16_f32 v43, v86, v87
    v_cvt_pk_bf16_f32 v44, v88, v89
    v_cvt_pk_bf16_f32 v45, v90, v91
    v_cvt_pk_bf16_f32 v46, v92, v93
    v_cvt_pk_bf16_f32 v47, v94, v95
    buffer_load_dwordx4 v1, s[8:11], s40 offen offset:1024 sc1 lds
    v_cvt_pk_bf16_f32 v48, v96, v97
    v_cvt_pk_bf16_f32 v49, v98, v99
    v_cvt_pk_bf16_f32 v50, v100, v101
    v_cvt_pk_bf16_f32 v51, v102, v103
    v_cvt_pk_bf16_f32 v52, v104, v105
    v_cvt_pk_bf16_f32 v53, v106, v107
    v_cvt_pk_bf16_f32 v54, v108, v109
    v_cvt_pk_bf16_f32 v55, v110, v111
    v_cvt_pk_bf16_f32 v56, v112, v113
    v_cvt_pk_bf16_f32 v57, v114, v115
    v_cvt_pk_bf16_f32 v58, v116, v117
    buffer_load_dwordx4 v1, s[8:11], s40 offen offset:2048 sc1 lds
    v_cvt_pk_bf16_f32 v59, v118, v119
    v_cvt_pk_bf16_f32 v60, v120, v121
    v_cvt_pk_bf16_f32 v61, v122, v123
    v_cvt_pk_bf16_f32 v62, v124, v125
    v_cvt_pk_bf16_f32 v63, v126, v127
    v_accvgpr_write_b32 a40, v32
    v_accvgpr_write_b32 a41, v33
    v_accvgpr_write_b32 a42, v34
    v_accvgpr_write_b32 a43, v35
    v_accvgpr_write_b32 a44, v36
    v_accvgpr_write_b32 a45, v37
    s_add_u32 m0, s46, 49152
    s_add_u32 s40, s52, 49152
    buffer_load_dwordx4 v1, s[8:11], s40 offen offset:0 sc1 lds
    v_accvgpr_write_b32 a46, v38
    v_accvgpr_write_b32 a47, v39
    v_accvgpr_write_b32 a48, v40
    v_accvgpr_write_b32 a49, v41
    v_accvgpr_write_b32 a50, v42
    v_accvgpr_write_b32 a51, v43
    v_accvgpr_write_b32 a52, v44
    v_accvgpr_write_b32 a53, v45
    v_accvgpr_write_b32 a54, v46
    v_accvgpr_write_b32 a55, v47
    v_accvgpr_write_b32 a56, v48
    buffer_load_dwordx4 v1, s[8:11], s40 offen offset:1024 sc1 lds
    v_accvgpr_write_b32 a57, v49
    v_accvgpr_write_b32 a58, v50
    v_accvgpr_write_b32 a59, v51
    v_accvgpr_write_b32 a60, v52
    v_accvgpr_write_b32 a61, v53
    v_accvgpr_write_b32 a62, v54
    v_accvgpr_write_b32 a63, v55
    v_accvgpr_write_b32 a64, v56
    v_accvgpr_write_b32 a65, v57
    v_accvgpr_write_b32 a66, v58
    v_accvgpr_write_b32 a67, v59
    v_accvgpr_write_b32 a68, v60
    v_accvgpr_write_b32 a69, v61
    v_accvgpr_write_b32 a70, v62
    v_accvgpr_write_b32 a71, v63
    s_and_b32 s35, s3, 1
    s_lshl_b32 s35, s35, 8
    v_add_u32 v12, s35, v4
    v_add_u32 v13, 131072, v12
    s_waitcnt lgkmcnt(0)
    v_accvgpr_read_b32 v9, a240
    s_xor_b32 s54, s54, s60
    s_xor_b32 s55, s55, s60
    s_or_b32 s54, s54, s55
    s_xor_b32 s48, s48, s60
    s_or_b32 s54, s54, s48
    s_xor_b32 s49, s49, s60
    s_or_b32 s54, s54, s49
    s_cmp_eq_u32 s54, 0
    s_cbranch_scc1 L_ok_5
    s_mov_b32 s41, 65536
L_spin_4:
    s_mov_b32 s54, 0
    s_atomic_add s54, s[4:5], s80 glc
    s_mov_b32 s55, 0
    s_atomic_add s55, s[4:5], s81 glc
    s_mov_b32 s48, 0
    s_atomic_add s48, s[4:5], s82 glc
    s_mov_b32 s49, 0
    s_atomic_add s49, s[4:5], s83 glc
    s_waitcnt lgkmcnt(0)
    s_xor_b32 s54, s54, s60
    s_xor_b32 s55, s55, s60
    s_or_b32 s54, s54, s55
    s_xor_b32 s48, s48, s60
    s_or_b32 s54, s54, s48
    s_xor_b32 s49, s49, s60
    s_or_b32 s54, s54, s49
    s_cmp_eq_u32 s54, 0
    s_cbranch_scc1 L_ok_5
    s_sub_u32 s41, s41, 1
    s_cbranch_scc0 L_spin_4
L_ok_5:
    s_mov_b32 s54, 0
    s_atomic_add s54, s[4:5], s98 glc
    s_mov_b32 s55, 0
    s_atomic_add s55, s[4:5], s99 glc
    s_mov_b32 s48, 0
    s_atomic_add s48, s[4:5], s100 glc
    s_mov_b32 s49, 0
    s_atomic_add s49, s[4:5], s101 glc
    s_waitcnt vmcnt(11)
    s_barrier
    ds_read_b128 v[64:67], v1 offset:0
    ds_read_b128 v[68:71], v1 offset:1024
    ds_read_b128 v[72:75], v1 offset:2048
    ds_read_b128 v[76:79], v1 offset:3072
    ds_read_b128 v[80:83], v1 offset:4096
    ds_read_b128 v[84:87], v1 offset:5120
    ds_read_b128 v[88:91], v1 offset:6144
    s_waitcnt lgkmcnt(6)
    v_mfma_f32_32x32x16_bf16 v[16:31], v[64:67], v[128:131], 0
    ds_read_b128 v[92:95], v1 offset:7168
    buffer_load_dwordx4 v1, s[8:11], s40 offen offset:2048 sc1 lds
    ds_read2st64_b32 v[104:105], v13 offset0:0 offset1:32
    ds_read2st64_b32 v[106:107], v13 offset0:64 offset1:96
    buffer_load_dwordx2 v[14:15], v10, s[8:11], s47 offen sc1
    s_waitcnt lgkmcnt(8)
    v_mfma_f32_32x32x16_bf16 v[32:47], v[128:131], v[68:71], 0
    ds_read_b128 v[64:67], v1 offset:8192
    s_lshl_b32 s42, s17, 11
    s_waitcnt lgkmcnt(8)
    v_mfma_f32_32x32x16_bf16 v[16:31], v[72:75], v[132:135], v[16:31]
    ds_read_b128 v[68:71], v1 offset:9216
    s_add_u32 m0, s46, 61440
    s_add_u32 s40, s52, 61440
    buffer_load_dwordx4 v1, s[8:11], s40 offen offset:0 sc1 lds
    s_waitcnt lgkmcnt(8)
    v_mfma_f32_32x32x16_bf16 v[32:47], v[132:135], v[76:79], v[32:47]
    ds_read_b128 v[72:75], v1 offset:10240
    s_add_u32 s43, s42, 38535168
    buffer_load_dwordx4 v[96:99], v1, s[8:11], s43 offen sc1
    buffer_load_dwordx4 v[100:103], v1, s[8:11], s43 offen offset:1024 sc1
    s_waitcnt lgkmcnt(8)
    v_mfma_f32_32x32x16_bf16 v[16:31], v[80:83], v[136:139], v[16:31]
    ds_read_b128 v[76:79], v1 offset:11264
    buffer_load_dwordx4 v1, s[8:11], s40 offen offset:1024 sc1 lds
    s_waitcnt vmcnt(14)
    s_barrier
    s_waitcnt lgkmcnt(8)
    v_mfma_f32_32x32x16_bf16 v[32:47], v[136:139], v[84:87], v[32:47]
    ds_read_b128 v[80:83], v1 offset:12288
    s_waitcnt lgkmcnt(5)
    v_pk_add_f32 v[104:105], v[104:105], v[106:107]
    v_add_f32 v13, v104, v105
    s_add_u32 s43, s42, 38567936
    buffer_load_dwordx4 v[104:107], v1, s[8:11], s43 offen sc1
    buffer_load_dwordx4 v[108:111], v1, s[8:11], s43 offen offset:1024 sc1
    v_mfma_f32_32x32x16_bf16 v[16:31], v[88:91], v[140:143], v[16:31]
    ds_read_b128 v[84:87], v1 offset:13312
    buffer_load_dwordx4 v1, s[8:11], s40 offen offset:2048 sc1 lds
    v_mfma_f32_32x32x16_bf16 v[32:47], v[140:143], v[92:95], v[32:47]
    ds_read_b128 v[88:91], v1 offset:14336
    s_add_u32 s43, s42, 38600704
    buffer_load_dwordx4 v[120:123], v1, s[8:11], s43 offen sc1
    buffer_load_dwordx4 v[124:127], v1, s[8:11], s43 offen offset:1024 sc1
    s_waitcnt lgkmcnt(6)
    v_mfma_f32_32x32x16_bf16 v[16:31], v[64:67], v[144:147], v[16:31]
    ds_read_b128 v[92:95], v1 offset:15360
    s_add_u32 m0, s46, 73728
    s_add_u32 s40, s52, 73728
    buffer_load_dwordx4 v1, s[8:11], s40 offen offset:0 sc1 lds
    s_waitcnt lgkmcnt(6)
    v_mfma_f32_32x32x16_bf16 v[32:47], v[144:147], v[68:71], v[32:47]
    ds_read_b128 v[64:67], v1 offset:16384
    s_waitcnt lgkmcnt(6)
    v_mfma_f32_32x32x16_bf16 v[16:31], v[72:75], v[148:151], v[16:31]
    ds_read_b128 v[68:71], v1 offset:17408
    buffer_load_dwordx4 v1, s[8:11], s40 offen offset:1024 sc1 lds
    s_waitcnt lgkmcnt(6)
    v_mfma_f32_32x32x16_bf16 v[32:47], v[148:151], v[76:79], v[32:47]
    ds_read_b128 v[72:75], v1 offset:18432
    s_waitcnt lgkmcnt(6)
    v_mfma_f32_32x32x16_bf16 v[16:31], v[80:83], v[152:155], v[16:31]
    ds_read_b128 v[76:79], v1 offset:19456
    buffer_load_dwordx4 v1, s[8:11], s40 offen offset:2048 sc1 lds
    s_waitcnt lgkmcnt(6)
    v_mfma_f32_32x32x16_bf16 v[32:47], v[152:155], v[84:87], v[32:47]
    ds_read_b128 v[80:83], v1 offset:20480
    s_waitcnt lgkmcnt(6)
    v_mfma_f32_32x32x16_bf16 v[16:31], v[88:91], v[156:159], v[16:31]
    ds_read_b128 v[84:87], v1 offset:21504
    s_add_u32 m0, s46, 86016
    s_add_u32 s40, s52, 86016
    buffer_load_dwordx4 v1, s[8:11], s40 offen offset:0 sc1 lds
    s_waitcnt lgkmcnt(6)
    v_mfma_f32_32x32x16_bf16 v[32:47], v[156:159], v[92:95], v[32:47]
    ds_read_b128 v[88:91], v1 offset:22528
    s_waitcnt lgkmcnt(6)
    v_mfma_f32_32x32x16_bf16 v[16:31], v[64:67], v[160:163], v[16:31]
    ds_read_b128 v[92:95], v1 offset:23552
    buffer_load_dwordx4 v1, s[8:11], s40 offen offset:1024 sc1 lds
    s_waitcnt vmcnt(21)
    s_barrier
    s_waitcnt lgkmcnt(6)
    v_mfma_f32_32x32x16_bf16 v[32:47], v[160:163], v[68:71], v[32:47]
    ds_read_b128 v[64:67], v1 offset:24576
    s_waitcnt lgkmcnt(6)
    v_mfma_f32_32x32x16_bf16 v[16:31], v[72:75], v[164:167], v[16:31]
    ds_read_b128 v[68:71], v1 offset:25600
    buffer_load_dwordx4 v1, s[8:11], s40 offen offset:2048 sc1 lds
    s_waitcnt lgkmcnt(6)
    v_mfma_f32_32x32x16_bf16 v[32:47], v[164:167], v[76:79], v[32:47]
    ds_read_b128 v[72:75], v1 offset:26624
    buffer_store_dword v13, v12, s[8:11], s77 offen sc1
    s_waitcnt lgkmcnt(6)
    v_mfma_f32_32x32x16_bf16 v[16:31], v[80:83], v[168:171], v[16:31]
    ds_read_b128 v[76:79], v1 offset:27648
    s_waitcnt vmcnt(13)
    v_add_f32 v96, v96, v100
    v_add_f32 v97, v97, v101
    s_waitcnt lgkmcnt(6)
    v_mfma_f32_32x32x16_bf16 v[32:47], v[168:171], v[84:87], v[32:47]
    ds_read_b128 v[80:83], v1 offset:28672
    v_add_f32 v98, v98, v102
    v_add_f32 v99, v99, v103
    s_waitcnt lgkmcnt(6)
    v_mfma_f32_32x32x16_bf16 v[16:31], v[88:91], v[172:175], v[16:31]
    ds_read_b128 v[84:87], v1 offset:29696
    s_waitcnt vmcnt(10)
    v_add_f32 v104, v104, v108
    v_add_f32 v105, v105, v109
    s_waitcnt lgkmcnt(6)
    v_mfma_f32_32x32x16_bf16 v[32:47], v[172:175], v[92:95], v[32:47]
    ds_read_b128 v[88:91], v1 offset:30720
    v_add_f32 v106, v106, v110
    v_add_f32 v107, v107, v111
    s_waitcnt lgkmcnt(6)
    v_mfma_f32_32x32x16_bf16 v[16:31], v[64:67], v[176:179], v[16:31]
    ds_read_b128 v[92:95], v1 offset:31744
    s_waitcnt vmcnt(7)
    v_add_f32 v120, v120, v124
    v_add_f32 v121, v121, v125
    buffer_store_dwordx4 a[40:43], v9, s[72:75], s64 offen sc1
    s_waitcnt lgkmcnt(6)
    v_mfma_f32_32x32x16_bf16 v[32:47], v[176:179], v[68:71], v[32:47]
    ds_read_b128 v[64:67], v1 offset:32768
    v_add_f32 v122, v122, v126
    v_add_f32 v123, v123, v127
    s_waitcnt lgkmcnt(6)
    v_mfma_f32_32x32x16_bf16 v[16:31], v[72:75], v[180:183], v[16:31]
    ds_read_b128 v[68:71], v1 offset:33792
    v_permlane32_swap_b32 v96, v98
    v_permlane32_swap_b32 v97, v99
    s_waitcnt lgkmcnt(6)
    v_mfma_f32_32x32x16_bf16 v[32:47], v[180:183], v[76:79], v[32:47]
    ds_read_b128 v[72:75], v1 offset:34816
    v_permlane32_swap_b32 v104, v106
    v_permlane32_swap_b32 v105, v107
    s_waitcnt lgkmcnt(6)
    v_mfma_f32_32x32x16_bf16 v[16:31], v[80:83], v[184:187], v[16:31]
    ds_read_b128 v[76:79], v1 offset:35840
    s_barrier
    v_permlane32_swap_b32 v120, v122
    v_permlane32_swap_b32 v121, v123
    s_waitcnt lgkmcnt(6)
    v_mfma_f32_32x32x16_bf16 v[32:47], v[184:187], v[84:87], v[32:47]
    ds_read_b128 v[80:83], v1 offset:36864
    v_add_f32 v96, v96, v98
    v_add_f32 v97, v97, v99
    buffer_store_dwordx4 a[44:47], v9, s[72:75], s65 offen sc1
    s_waitcnt lgkmcnt(6)
    v_mfma_f32_32x32x16_bf16 v[16:31], v[88:91], v[188:191], v[16:31]
    ds_read_b128 v[84:87], v1 offset:37888
    v_add_f32 v104, v104, v106
    v_add_f32 v105, v105, v107
    s_waitcnt lgkmcnt(6)
    v_mfma_f32_32x32x16_bf16 v[32:47], v[188:191], v[92:95], v[32:47]
    ds_read_b128 v[88:91], v1 offset:38912
    v_add_f32 v120, v120, v122
    v_add_f32 v121, v121, v123
    s_waitcnt lgkmcnt(6)
    v_mfma_f32_32x32x16_bf16 v[16:31], v[64:67], v[192:195], v[16:31]
    ds_read_b128 v[92:95], v1 offset:39936
    v_lshrrev_b32 v6, 6, v1
    v_and_b32 v6, 7, v6
    s_waitcnt lgkmcnt(6)
    v_mfma_f32_32x32x16_bf16 v[32:47], v[192:195], v[68:71], v[32:47]
    ds_read_b128 v[64:67], v1 offset:40960
    v_and_b32 v7, 48, v1
    v_add_u32 v6, v6, v7
    s_waitcnt lgkmcnt(6)
    v_mfma_f32_32x32x16_bf16 v[16:31], v[72:75], v[196:199], v[16:31]
    ds_read_b128 v[68:71], v1 offset:41984
    v_lshlrev_b32 v6, 2, v6
    v_permlane16_swap_b32 v96, v97
    buffer_store_dwordx4 a[48:51], v9, s[72:75], s66 offen sc1
    s_waitcnt lgkmcnt(0)
    s_xor_b32 s54, s54, s60
    s_xor_b32 s55, s55, s60
    s_or_b32 s54, s54, s55
    s_xor_b32 s48, s48, s60
    s_or_b32 s54, s54, s48
    s_xor_b32 s49, s49, s60
    s_or_b32 s54, s54, s49
    s_cmp_eq_u32 s54, 0
    s_cbranch_scc1 L_ok_7
    s_mov_b32 s41, 65536
L_spin_6:
    s_mov_b32 s54, 0
    s_atomic_add s54, s[4:5], s98 glc
    s_mov_b32 s55, 0
    s_atomic_add s55, s[4:5], s99 glc
    s_mov_b32 s48, 0
    s_atomic_add s48, s[4:5], s100 glc
    s_mov_b32 s49, 0
    s_atomic_add s49, s[4:5], s101 glc
    s_waitcnt lgkmcnt(0)
    s_xor_b32 s54, s54, s60
    s_xor_b32 s55, s55, s60
    s_or_b32 s54, s54, s55
    s_xor_b32 s48, s48, s60
    s_or_b32 s54, s54, s48
    s_xor_b32 s49, s49, s60
    s_or_b32 s54, s54, s49
    s_cmp_eq_u32 s54, 0
    s_cbranch_scc1 L_ok_7
    s_sub_u32 s41, s41, 1
    s_cbranch_scc0 L_spin_6
L_ok_7:
    v_mfma_f32_32x32x16_bf16 v[32:47], v[196:199], v[76:79], v[32:47]
    ds_read_b128 v[72:75], v1 offset:43008
    v_permlane16_swap_b32 v104, v105
    v_permlane16_swap_b32 v120, v121
    v_mfma_f32_32x32x16_bf16 v[16:31], v[80:83], v[200:203], v[16:31]
    ds_read_b128 v[76:79], v1 offset:44032
    v_add_f32 v96, -v96, -v97
    v_add_f32 v104, -v104, -v105
    buffer_load_dwordx4 a[88:91], v1, s[8:11], s24 offen offset:0 sc1
    v_mfma_f32_32x32x16_bf16 v[32:47], v[200:203], v[84:87], v[32:47]
    ds_read_b128 v[80:83], v1 offset:45056
    v_add_f32 v120, -v120, -v121
    v_add_f32_dpp v96, v96, v96 row_ror:8 row_mask:0xf bank_mask:0xf
    v_mfma_f32_32x32x16_bf16 v[16:31], v[88:91], v[204:207], v[16:31]
    ds_read_b128 v[84:87], v1 offset:46080
    v_add_f32_dpp v104, v104, v104 row_ror:8 row_mask:0xf bank_mask:0xf
    v_add_f32_dpp v120, v120, v120 row_ror:8 row_mask:0xf bank_mask:0xf
    v_mfma_f32_32x32x16_bf16 v[32:47], v[204:207], v[92:95], v[32:47]
    ds_read_b128 v[88:91], v1 offset:47104
    ds_bpermute_b32 v96, v6, v96
    ds_bpermute_b32 v104, v6, v104
    buffer_store_dwordx4 a[52:55], v9, s[72:75], s67 offen sc1
    buffer_load_dwordx4 a[92:95], v1, s[8:11], s24 offen offset:1024 sc1
    v_mfma_f32_32x32x16_bf16 v[16:31], v[64:67], v[208:211], v[16:31]
    ds_read_b128 v[92:95], v1 offset:48128
    s_waitcnt vmcnt(7)
    s_barrier
    ds_bpermute_b32 v120, v6, v120
    v_mov_b32 v114, v14
    v_mfma_f32_32x32x16_bf16 v[32:47], v[208:211], v[68:71], v[32:47]
    ds_read_b128 v[64:67], v1 offset:49152
    v_mul_f32 v5, 0x3fb8aa3b, v15
    v_and_b32 v10, 0x7f, v4
    s_waitcnt lgkmcnt(9)
    v_mfma_f32_32x32x16_bf16 v[16:31], v[72:75], v[212:215], v[16:31]
    ds_read_b128 v[68:71], v1 offset:50176
    s_add_u32 s47, s27, 98304
    v_add_u32 v10, s47, v10
    buffer_load_dwordx4 a[96:99], v1, s[8:11], s24 offen offset:2048 sc1
    s_waitcnt lgkmcnt(9)
    v_mfma_f32_32x32x16_bf16 v[32:47], v[212:215], v[76:79], v[32:47]
    ds_read_b128 v[72:75], v1 offset:51200
    ds_write_b32 v10, v15 offset:12288
    v_cvt_pk_bf16_f32 v112, v114, v114
    s_waitcnt lgkmcnt(10)
    v_mfma_f32_32x32x16_bf16 v[16:31], v[80:83], v[216:219], v[16:31]
    ds_read_b128 v[76:79], v1 offset:52224
    v_cmp_gt_u32 vcc, 512, v1
    v_lshlrev_b32 v113, 16, v112
    buffer_store_dwordx4 a[56:59], v9, s[72:75], s68 offen sc1
    s_waitcnt lgkmcnt(10)
    v_mfma_f32_32x32x16_bf16 v[32:47], v[216:219], v[84:87], v[32:47]
    ds_read_b128 v[80:83], v1 offset:53248
    v_sub_f32 v113, v114, v113
    v_cvt_pk_bf16_f32 v113, v113, 0
    buffer_load_dwordx4 a[100:103], v1, s[8:11], s24 offen offset:3072 sc1
    s_waitcnt lgkmcnt(10)
    v_mfma_f32_32x32x16_bf16 v[16:31], v[88:91], v[220:223], v[16:31]
    ds_read_b128 v[84:87], v1 offset:54272
    v_cndmask_b32 v112, 0, v112, vcc
    v_cndmask_b32 v113, 0, v113, vcc
    s_waitcnt lgkmcnt(8)
    v_mfma_f32_32x32x16_bf16 v[32:47], v[220:223], v[92:95], v[32:47]
    ds_read_b128 v[88:91], v1 offset:55296
    v_mov_b32 v114, 0
    v_mov_b32 v115, 0
    s_waitcnt lgkmcnt(7)
    v_mfma_f32_32x32x16_bf16 v[16:31], v[64:67], v[224:227], v[16:31]
    ds_read_b128 v[92:95], v1 offset:56320
    v_mov_b32 v118, 0
    v_mov_b32 v119, 0
    s_add_u32 s61, s24, 4096
    buffer_load_dwordx4 a[104:107], v1, s[8:11], s61 offen offset:0 sc1
    s_waitcnt lgkmcnt(7)
    v_mfma_f32_32x32x16_bf16 v[32:47], v[224:227], v[68:71], v[32:47]
    ds_read_b128 v[64:67], v1 offset:57344
    buffer_store_dwordx4 a[60:63], v9, s[72:75], s69 offen sc1
    s_waitcnt lgkmcnt(7)
    v_mfma_f32_32x32x16_bf16 v[16:31], v[72:75], v[228:231], v[16:31]
    ds_read_b128 v[68:71], v1 offset:58368
    v_cmp_gt_u32 vcc, 512, v1
    v_cvt_pk_bf16_f32 v97, v96, v96
    v_lshlrev_b32 v97, 16, v97
    s_waitcnt lgkmcnt(6)
    v_mfma_f32_32x32x16_bf16 v[32:47], v[228:231], v[76:79], v[32:47]
    ds_read_b128 v[72:75], v1 offset:59392
    v_sub_f32 v97, v96, v97
    v_cvt_pk_bf16_f32 v96, v96, v97
    v_cndmask_b32 v96, 0, v96, vcc
    buffer_load_dwordx4 a[108:111], v1, s[8:11], s61 offen offset:1024 sc1
    s_waitcnt lgkmcnt(6)
    v_mfma_f32_32x32x16_bf16 v[16:31], v[80:83], v[232:235], v[16:31]
    ds_read_b128 v[76:79], v1 offset:60416
    v_accvgpr_write_b32 a246, v96
    v_cvt_pk_bf16_f32 v105, v104, v104
    v_lshlrev_b32 v105, 16, v105
    s_waitcnt lgkmcnt(6)
    v_mfma_f32_32x32x16_bf16 v[32:47], v[232:235], v[84:87], v[32:47]
    ds_read_b128 v[80:83], v1 offset:61440
    v_sub_f32 v105, v104, v105
    v_cvt_pk_bf16_f32 v104, v104, v105
    v_cndmask_b32 v104, 0, v104, vcc
    s_waitcnt lgkmcnt(6)
    v_mfma_f32_32x32x16_bf16 v[16:31], v[88:91], v[236:239], v[16:31]
    ds_read_b128 v[84:87], v1 offset:62464
    v_accvgpr_write_b32 a247, v104
    v_cvt_pk_bf16_f32 v121, v120, v120
    v_lshlrev_b32 v121, 16, v121
    buffer_store_dwordx4 a[64:67], v9, s[72:75], s70 offen sc1
    buffer_load_dwordx4 a[112:115], v1, s[8:11], s61 offen offset:2048 sc1
    s_waitcnt lgkmcnt(6)
    v_mfma_f32_32x32x16_bf16 v[32:47], v[236:239], v[92:95], v[32:47]
    ds_read_b128 v[88:91], v1 offset:63488
    v_sub_f32 v121, v120, v121
    v_cvt_pk_bf16_f32 v120, v120, v121
    v_cndmask_b32 v120, 0, v120, vcc
    s_waitcnt lgkmcnt(6)
    v_mfma_f32_32x32x16_bf16 v[16:31], v[64:67], v[240:243], v[16:31]
    ds_read_b128 v[92:95], v1 offset:64512
    v_accvgpr_write_b32 a231, v120
    v_accvgpr_read_b32 v8, a235
    s_waitcnt lgkmcnt(6)
    v_mfma_f32_32x32x16_bf16 v[32:47], v[240:243], v[68:71], v[32:47]
    buffer_load_dwordx4 a[116:119], v1, s[8:11], s61 offen offset:3072 sc1
    v_accvgpr_read_b32 v116, a246
    v_accvgpr_read_b32 v117, a246
    s_waitcnt lgkmcnt(5)
    v_mfma_f32_32x32x16_bf16 v[16:31], v[72:75], v[244:247], v[16:31]
    v_mfma_f32_32x32x16_bf16 v[16:31], v[116:119], v[112:115], v[16:31]
    s_waitcnt lgkmcnt(4)
    v_mfma_f32_32x32x16_bf16 v[32:47], v[244:247], v[76:79], v[32:47]
    buffer_store_dwordx4 a[68:71], v9, s[72:75], s71 offen sc1
    v_accvgpr_read_b32 v116, a247
    v_accvgpr_read_b32 v117, a247
    s_waitcnt lgkmcnt(3)
    v_mfma_f32_32x32x16_bf16 v[16:31], v[80:83], v[248:251], v[16:31]
    s_add_u32 s61, s24, 8192
    buffer_load_dwordx4 a[120:123], v1, s[8:11], s61 offen offset:0 sc1
    v_mfma_f32_32x32x16_bf16 v[32:47], v[112:115], v[116:119], v[32:47]
    s_waitcnt lgkmcnt(2)
    v_mfma_f32_32x32x16_bf16 v[32:47], v[248:251], v[84:87], v[32:47]
    v_accvgpr_read_b32 v116, a231
    v_accvgpr_read_b32 v117, a231
    s_waitcnt lgkmcnt(1)
    v_mfma_f32_32x32x16_bf16 v[16:31], v[88:91], v[252:255], v[16:31]
    v_mfma_f32_32x32x16_bf16 v[48:63], v[116:119], v[112:115], 0
    s_waitcnt lgkmcnt(0)
    v_mfma_f32_32x32x16_bf16 v[32:47], v[252:255], v[92:95], v[32:47]
    buffer_load_dwordx4 a[124:127], v1, s[8:11], s61 offen offset:1024 sc1
    s_barrier
    s_add_u32 s58, s23, s26
    ds_read_b128 v[112:115], v8 offset:12288
    ds_read_b128 v[116:119], v8 offset:12320
    ds_read_b128 v[120:123], v8 offset:12352
    ds_read_b128 v[124:127], v8 offset:12384
    s_nop 1
    v_max3_f32 v10, v16, v17, v18
    v_min3_f32 v11, v16, v17, v18
    v_max3_f32 v10, v10, v19, v20
    v_min3_f32 v11, v11, v19, v20
    v_max3_f32 v10, v10, v21, v22
    buffer_load_dwordx4 a[128:131], v1, s[8:11], s61 offen offset:2048 sc1
    v_min3_f32 v11, v11, v21, v22
    v_max3_f32 v10, v10, v23, v24
    v_min3_f32 v11, v11, v23, v24
    v_max3_f32 v10, v10, v25, v26
    v_min3_f32 v11, v11, v25, v26
    v_max3_f32 v10, v10, v27, v28
    v_min3_f32 v11, v11, v27, v28
    v_max3_f32 v10, v10, v29, v30
    v_min3_f32 v11, v11, v29, v30
    v_max_f32 v10, v10, v31
    buffer_load_dwordx4 a[132:135], v1, s[8:11], s61 offen offset:3072 sc1
    v_min_f32 v11, v11, v31
    v_mul_f32 v10, -v5, v10
    v_mul_f32 v11, v5, v11
    v_pk_fma_f32 v[96:97], v[16:17], v[4:5], v[10:11] op_sel:[0,1,1] op_sel_hi:[1,1,1] neg_lo:[0,1,0] neg_hi:[0,1,0]
    v_pk_fma_f32 v[16:17], v[16:17], v[4:5], v[10:11] op_sel:[0,1,0] op_sel_hi:[1,1,0]
    v_pk_fma_f32 v[98:99], v[18:19], v[4:5], v[10:11] op_sel:[0,1,1] op_sel_hi:[1,1,1] neg_lo:[0,1,0] neg_hi:[0,1,0]
    v_pk_fma_f32 v[18:19], v[18:19], v[4:5], v[10:11] op_sel:[0,1,0] op_sel_hi:[1,1,0]
    v_exp_f32 v16, v16
    v_exp_f32 v17, v17
    v_exp_f32 v96, v96
    s_add_u32 s61, s24, 12288
    buffer_load_dwordx4 a[136:139], v1, s[8:11], s61 offen offset:0 sc1
    v_exp_f32 v97, v97
    v_pk_fma_f32 v[100:101], v[20:21], v[4:5], v[10:11] op_sel:[0,1,1] op_sel_hi:[1,1,1] neg_lo:[0,1,0] neg_hi:[0,1,0]
    v_pk_fma_f32 v[20:21], v[20:21], v[4:5], v[10:11] op_sel:[0,1,0] op_sel_hi:[1,1,0]
    v_exp_f32 v18, v18
    v_exp_f32 v19, v19
    v_exp_f32 v98, v98
    v_exp_f32 v99, v99
    v_pk_fma_f32 v[102:103], v[22:23], v[4:5], v[10:11] op_sel:[0,1,1] op_sel_hi:[1,1,1] neg_lo:[0,1,0] neg_hi:[0,1,0]
    v_pk_fma_f32 v[22:23], v[22:23], v[4:5], v[10:11] op_sel:[0,1,0] op_sel_hi:[1,1,0]
    v_exp_f32 v20, v20
    buffer_load_dwordx4 a[140:143], v1, s[8:11], s61 offen offset:1024 sc1
    v_exp_f32 v21, v21
    v_exp_f32 v100, v100
    v_exp_f32 v101, v101
    v_pk_fma_f32 v[104:105], v[24:25], v[4:5], v[10:11] op_sel:[0,1,1] op_sel_hi:[1,1,1] neg_lo:[0,1,0] neg_hi:[0,1,0]
    v_pk_fma_f32 v[24:25], v[24:25], v[4:5], v[10:11] op_sel:[0,1,0] op_sel_hi:[1,1,0]
    v_exp_f32 v22, v22
    v_exp_f32 v23, v23
    v_exp_f32 v102, v102
    v_exp_f32 v103, v103
    v_pk_fma_f32 v[106:107], v[26:27], v[4:5], v[10:11] op_sel:[0,1,1] op_sel_hi:[1,1,1] neg_lo:[0,1,0] neg_hi:[0,1,0]
    buffer_load_dwordx4 a[144:147], v1, s[8:11], s61 offen offset:2048 sc1
    v_pk_fma_f32 v[26:27], v[26:27], v[4:5], v[10:11] op_sel:[0,1,0] op_sel_hi:[1,1,0]
    v_exp_f32 v24, v24
    v_exp_f32 v25, v25
    v_exp_f32 v104, v104
    v_exp_f32 v105, v105
    v_pk_fma_f32 v[108:109], v[28:29], v[4:5], v[10:11] op_sel:[0,1,1] op_sel_hi:[1,1,1] neg_lo:[0,1,0] neg_hi:[0,1,0]
    v_pk_fma_f32 v[28:29], v[28:29], v[4:5], v[10:11] op_sel:[0,1,0] op_sel_hi:[1,1,0]
    v_exp_f32 v26, v26
    v_exp_f32 v27, v27
    v_exp_f32 v106, v106
    buffer_load_dwordx4 a[148:151], v1, s[8:11], s61 offen offset:3072 sc1
    v_exp_f32 v107, v107
    v_pk_fma_f32 v[110:111], v[30:31], v[4:5], v[10:11] op_sel:[0,1,1] op_sel_hi:[1,1,1] neg_lo:[0,1,0] neg_hi:[0,1,0]
    v_pk_fma_f32 v[30:31], v[30:31], v[4:5], v[10:11] op_sel:[0,1,0] op_sel_hi:[1,1,0]
    v_exp_f32 v28, v28
    v_exp_f32 v29, v29
    v_exp_f32 v108, v108
    v_exp_f32 v109, v109
    v_exp_f32 v30, v30
    v_exp_f32 v31, v31
    v_exp_f32 v110, v110
    s_add_u32 s61, s24, 16384
    buffer_load_dwordx4 a[152:155], v1, s[8:11], s61 offen offset:0 sc1
    v_exp_f32 v111, v111
    v_pk_add_f32 v[12:13], v[16:17], v[18:19]
    v_pk_add_f32 v[14:15], v[96:97], v[98:99]
    v_pk_add_f32 v[12:13], v[12:13], v[20:21]
    v_pk_add_f32 v[14:15], v[14:15], v[100:101]
    v_pk_add_f32 v[12:13], v[12:13], v[22:23]
    v_pk_add_f32 v[14:15], v[14:15], v[102:103]
    v_pk_add_f32 v[12:13], v[12:13], v[24:25]
    v_pk_add_f32 v[14:15], v[14:15], v[104:105]
    v_pk_add_f32 v[12:13], v[12:13], v[26:27]
    buffer_load_dwordx4 a[156:159], v1, s[8:11], s61 offen offset:1024 sc1
    v_pk_add_f32 v[14:15], v[14:15], v[106:107]
    v_pk_add_f32 v[12:13], v[12:13], v[28:29]
    v_pk_add_f32 v[14:15], v[14:15], v[108:109]
    v_pk_add_f32 v[12:13], v[12:13], v[30:31]
    v_pk_add_f32 v[14:15], v[14:15], v[110:111]
    v_add_f32 v12, v12, v13
    v_add_f32 v14, v14, v15
    v_rcp_f32 v12, v12
    v_rcp_f32 v14, v14
    v_pk_mul_f32 v[16:17], v[16:17], v[12:13] op_sel_hi:[1,0]
    buffer_load_dwordx4 a[160:163], v1, s[8:11], s61 offen offset:2048 sc1
    v_pk_mul_f32 v[18:19], v[18:19], v[12:13] op_sel_hi:[1,0]
    v_pk_mul_f32 v[20:21], v[20:21], v[12:13] op_sel_hi:[1,0]
    v_pk_mul_f32 v[22:23], v[22:23], v[12:13] op_sel_hi:[1,0]
    v_cvt_pk_bf16_f32 v64, v16, v17
    v_cvt_pk_bf16_f32 v65, v18, v19
    v_cvt_pk_bf16_f32 v66, v20, v21
    v_cvt_pk_bf16_f32 v67, v22, v23
    v_pk_mul_f32 v[96:97], v[96:97], v[14:15] op_sel_hi:[1,0]
    v_pk_mul_f32 v[98:99], v[98:99], v[14:15] op_sel_hi:[1,0]
    v_pk_mul_f32 v[100:101], v[100:101], v[14:15] op_sel_hi:[1,0]
    buffer_load_dwordx4 a[164:167], v1, s[8:11], s61 offen offset:3072 sc1
    v_pk_mul_f32 v[102:103], v[102:103], v[14:15] op_sel_hi:[1,0]
    v_cvt_pk_bf16_f32 v72, v96, v97
    v_cvt_pk_bf16_f32 v73, v98, v99
    v_cvt_pk_bf16_f32 v74, v100, v101
    v_cvt_pk_bf16_f32 v75, v102, v103
    v_mfma_f32_32x32x16_bf16 v[80:95], v[64:67], a[248:251], 0
    v_pk_mul_f32 v[24:25], v[24:25], v[12:13] op_sel_hi:[1,0]
    v_pk_mul_f32 v[26:27], v[26:27], v[12:13] op_sel_hi:[1,0]
    v_pk_mul_f32 v[28:29], v[28:29], v[12:13] op_sel_hi:[1,0]
    v_pk_mul_f32 v[30:31], v[30:31], v[12:13] op_sel_hi:[1,0]
    s_add_u32 s61, s24, 20480
    buffer_load_dwordx4 a[168:171], v1, s[8:11], s61 offen offset:0 sc1
    v_cvt_pk_bf16_f32 v68, v24, v25
    v_cvt_pk_bf16_f32 v69, v26, v27
    v_cvt_pk_bf16_f32 v70, v28, v29
    v_cvt_pk_bf16_f32 v71, v30, v31
    s_nop 1
    v_mfma_f32_32x32x16_bf16 v[80:95], v[68:71], a[252:255], v[80:95]
    v_pk_mul_f32 v[104:105], v[104:105], v[14:15] op_sel_hi:[1,0]
    v_pk_mul_f32 v[106:107], v[106:107], v[14:15] op_sel_hi:[1,0]
    v_pk_mul_f32 v[108:109], v[108:109], v[14:15] op_sel_hi:[1,0]
    v_pk_mul_f32 v[110:111], v[110:111], v[14:15] op_sel_hi:[1,0]
    v_cvt_pk_bf16_f32 v76, v104, v105
    buffer_load_dwordx4 a[172:175], v1, s[8:11], s61 offen offset:1024 sc1
    v_cvt_pk_bf16_f32 v77, v106, v107
    v_cvt_pk_bf16_f32 v78, v108, v109
    v_cvt_pk_bf16_f32 v79, v110, v111
    v_mfma_f32_32x32x16_bf16 v[16:31], v[72:75], a[248:251], 0
    s_waitcnt lgkmcnt(3)
    v_pk_mul_f32 v[32:33], v[32:33], v[112:113]
    v_pk_mul_f32 v[34:35], v[34:35], v[114:115]
    s_waitcnt lgkmcnt(2)
    v_pk_mul_f32 v[36:37], v[36:37], v[116:117]
    v_pk_mul_f32 v[38:39], v[38:39], v[118:119]
    s_waitcnt lgkmcnt(1)
    v_pk_mul_f32 v[40:41], v[40:41], v[120:121]
    v_pk_mul_f32 v[42:43], v[42:43], v[122:123]
    buffer_load_dwordx4 a[176:179], v1, s[8:11], s61 offen offset:2048 sc1
    s_waitcnt lgkmcnt(0)
    v_pk_mul_f32 v[44:45], v[44:45], v[124:125]
    v_pk_mul_f32 v[46:47], v[46:47], v[126:127]
    v_mfma_f32_32x32x16_bf16 v[16:31], v[76:79], a[252:255], v[16:31]
    v_cvt_pk_bf16_f32 v32, v32, v33
    v_cvt_pk_bf16_f32 v33, v34, v35
    v_cvt_pk_bf16_f32 v34, v36, v37
    v_cvt_pk_bf16_f32 v35, v38, v39
    v_cvt_pk_bf16_f32 v36, v40, v41
    v_cvt_pk_bf16_f32 v37, v42, v43
    v_cvt_pk_bf16_f32 v38, v44, v45
    buffer_load_dwordx4 a[180:183], v1, s[8:11], s61 offen offset:3072 sc1
    v_cvt_pk_bf16_f32 v39, v46, v47
    v_cvt_pk_bf16_f32 v64, v80, v81
    v_cvt_pk_bf16_f32 v65, v82, v83
    v_cvt_pk_bf16_f32 v66, v84, v85
    v_cvt_pk_bf16_f32 v67, v86, v87
    v_cvt_pk_bf16_f32 v68, v88, v89
    v_cvt_pk_bf16_f32 v69, v90, v91
    v_cvt_pk_bf16_f32 v70, v92, v93
    v_cvt_pk_bf16_f32 v71, v94, v95
    v_mfma_f32_32x32x16_bf16 v[112:127], v[64:67], v[32:35], 0
    s_add_u32 s61, s24, 24576
    buffer_load_dwordx4 a[184:187], v1, s[8:11], s61 offen offset:0 sc1
    v_pk_add_f32 v[8:9], v[80:81], v[82:83]
    v_pk_add_f32 v[8:9], v[8:9], v[84:85]
    v_pk_add_f32 v[8:9], v[8:9], v[86:87]
    v_pk_add_f32 v[8:9], v[8:9], v[88:89]
    v_pk_add_f32 v[8:9], v[8:9], v[90:91]
    v_pk_add_f32 v[8:9], v[8:9], v[92:93]
    v_pk_add_f32 v[8:9], v[8:9], v[94:95]
    v_mfma_f32_32x32x16_bf16 v[112:127], v[68:71], v[36:39], v[112:127]
    v_cvt_pk_bf16_f32 v72, v16, v17
    v_cvt_pk_bf16_f32 v73, v18, v19
    buffer_load_dwordx4 a[188:191], v1, s[8:11], s61 offen offset:1024 sc1
    v_cvt_pk_bf16_f32 v74, v20, v21
    v_cvt_pk_bf16_f32 v75, v22, v23
    v_cvt_pk_bf16_f32 v76, v24, v25
    v_cvt_pk_bf16_f32 v77, v26, v27
    v_cvt_pk_bf16_f32 v78, v28, v29
    v_cvt_pk_bf16_f32 v79, v30, v31
    v_mfma_f32_32x32x16_bf16 v[96:111], v[72:75], v[32:35], 0
    v_pk_add_f32 v[40:41], v[16:17], v[18:19]
    v_pk_add_f32 v[40:41], v[40:41], v[20:21]
    v_pk_add_f32 v[40:41], v[40:41], v[22:23]
    buffer_load_dwordx4 a[192:195], v1, s[8:11], s61 offen offset:2048 sc1
    v_pk_add_f32 v[40:41], v[40:41], v[24:25]
    v_pk_add_f32 v[40:41], v[40:41], v[26:27]
    v_pk_add_f32 v[40:41], v[40:41], v[28:29]
    v_pk_add_f32 v[40:41], v[40:41], v[30:31]
    v_mfma_f32_32x32x16_bf16 v[96:111], v[76:79], v[36:39], v[96:111]
    v_add_f32 v8, v8, v9
    v_add_f32 v9, v40, v41
    v_accvgpr_read_b32 v6, a233
    v_and_b32 v7, 0x100, v1
    v_permlane32_swap_b32 v8, v9
    v_cmp_ne_u32 vcc, 0, v7
    v_add_f32 v8, v8, v9
    v_accvgpr_read_b32 v7, a232
    ds_write_b32 v6, v8 offset:4096
    v_cndmask_b32 v16, v112, v120, vcc
    v_cndmask_b32 v17, v113, v121, vcc
    v_cndmask_b32 v18, v114, v122, vcc
    v_cndmask_b32 v19, v115, v123, vcc
    v_cndmask_b32 v20, v116, v124, vcc
    v_cndmask_b32 v21, v117, v125, vcc
    v_cndmask_b32 v22, v118, v126, vcc
    v_cndmask_b32 v23, v119, v127, vcc
    ds_write_b128 v7, v[16:19]
    ds_write_b128 v7, v[20:23] offset:512
    v_cndmask_b32 v24, v96, v104, vcc
    v_cndmask_b32 v25, v97, v105, vcc
    v_cndmask_b32 v26, v98, v106, vcc
    v_cndmask_b32 v27, v99, v107, vcc
    v_cndmask_b32 v28, v100, v108, vcc
    v_cndmask_b32 v29, v101, v109, vcc
    v_cndmask_b32 v30, v102, v110, vcc
    v_cndmask_b32 v31, v103, v111, vcc
    ds_write_b128 v7, v[24:27] offset:2048
    ds_write_b128 v7, v[28:31] offset:2560
    s_lshl_b32 s42, s3, 10
    s_add_u32 s42, s42, 98304
    v_add_u32 v7, s42, v1
    v_add_u32 v8, 102400, v4
    v_accvgpr_read_b32 v6, a241
    s_lshl_b32 s42, s17, 4
    s_add_u32 s42, s42, s16
    s_lshl_b32 s52, s42, 8
    s_add_u32 s52, s52, 23658496
    s_lshl_b32 s42, s42, 11
    s_add_u32 s42, s42, 21450752
    s_lshl_b32 s43, s3, 4
    s_mov_b64 s[34:35], 0xffff
    s_lshl_b64 s[34:35], s[34:35], s43
    s_waitcnt vmcnt(19)
    s_waitcnt lgkmcnt(0)
    s_barrier
    ds_read_b128 v[64:67], v7 offset:0
    ds_read_b128 v[68:71], v7 offset:16384
    ds_read_b128 v[72:75], v7 offset:32768
    ds_read_b128 v[76:79], v7 offset:49152
    ds_read2st64_b32 v[80:81], v8 offset0:0 offset1:64
    ds_read2st64_b32 v[82:83], v8 offset0:128 offset1:192
    ds_read_b128 v[96:99], v2 offset:0
    ds_read_b128 v[100:103], v2 offset:1024
    ds_read_b128 v[104:107], v2 offset:2048
    ds_read_b128 v[108:111], v2 offset:3072
    ds_read_b128 v[112:115], v2 offset:4096
    ds_read_b128 v[116:119], v2 offset:5120
    ds_read_b128 v[120:123], v2 offset:6144
    s_cmp_lg_u32 s3, 0
    s_cbranch_scc1 L_pub_8
    v_mov_b32 v8, 0
    v_mov_b32 v9, s60
    s_mov_b64 exec, 1
    buffer_store_dword v9, v8, s[8:11], s38 offen sc1
    s_mov_b64 exec, -1
L_pub_8:
    s_waitcnt lgkmcnt(11)
    v_pk_add_f32 v[64:65], v[64:65], v[68:69]
    v_pk_add_f32 v[66:67], v[66:67], v[70:71]
    s_waitcnt lgkmcnt(9)
    v_pk_add_f32 v[72:73], v[72:73], v[76:77]
    v_pk_add_f32 v[74:75], v[74:75], v[78:79]
    v_pk_add_f32 v[64:65], v[64:65], v[72:73]
    v_pk_add_f32 v[66:67], v[66:67], v[74:75]
    v_cvt_pk_bf16_f32 v64, v64, v65
    v_cvt_pk_bf16_f32 v65, v66, v67
    buffer_store_dwordx2 v[64:65], v6, s[8:11], s42 offen sc1
    s_waitcnt lgkmcnt(7)
    v_pk_add_f32 v[80:81], v[80:81], v[82:83]
    v_add_f32 v80, v80, v81
    s_mov_b64 exec, s[34:35]
    buffer_store_dword v80, v4, s[8:11], s52 offen sc1
    s_mov_b64 exec, -1
    s_lshl_b32 s42, s3, 4
    s_add_u32 s42, s42, s17
    s_lshl_b32 s42, s42, 7
    s_add_u32 s52, s42, 7602176
    s_waitcnt lgkmcnt(6)
    v_mfma_f32_32x32x16_bf16 v[48:63], v[96:99], v[128:131], v[48:63]
    ds_read_b128 v[124:127], v2 offset:7168
    s_waitcnt lgkmcnt(6)
    v_mfma_f32_32x32x16_bf16 v[48:63], v[100:103], v[132:135], v[48:63]
    ds_read_b128 v[96:99], v2 offset:8192
    s_waitcnt lgkmcnt(6)
    v_mfma_f32_32x32x16_bf16 v[48:63], v[104:107], v[136:139], v[48:63]
    ds_read_b128 v[100:103], v2 offset:9216
    s_waitcnt lgkmcnt(6)
    v_mfma_f32_32x32x16_bf16 v[48:63], v[108:111], v[140:143], v[48:63]
    ds_read_b128 v[104:107], v2 offset:10240
    s_waitcnt lgkmcnt(6)
    v_mfma_f32_32x32x16_bf16 v[48:63], v[112:115], v[144:147], v[48:63]
    ds_read_b128 v[108:111], v2 offset:11264
    s_waitcnt lgkmcnt(6)
    v_mfma_f32_32x32x16_bf16 v[48:63], v[116:119], v[148:151], v[48:63]
    ds_read_b128 v[112:115], v2 offset:12288
    s_waitcnt lgkmcnt(6)
    v_mfma_f32_32x32x16_bf16 v[48:63], v[120:123], v[152:155], v[48:63]
    ds_read_b128 v[116:119], v2 offset:13312
    s_waitcnt lgkmcnt(6)
    v_mfma_f32_32x32x16_bf16 v[48:63], v[124:127], v[156:159], v[48:63]
    ds_read_b128 v[120:123], v2 offset:14336
    s_waitcnt lgkmcnt(6)
    v_mfma_f32_32x32x16_bf16 v[48:63], v[96:99], v[160:163], v[48:63]
    ds_read_b128 v[124:127], v2 offset:15360
    s_waitcnt lgkmcnt(6)
    v_mfma_f32_32x32x16_bf16 v[48:63], v[100:103], v[164:167], v[48:63]
    ds_read_b128 v[96:99], v2 offset:16384
    s_waitcnt lgkmcnt(6)
    v_mfma_f32_32x32x16_bf16 v[48:63], v[104:107], v[168:171], v[48:63]
    ds_read_b128 v[100:103], v2 offset:17408
    s_waitcnt lgkmcnt(6)
    v_mfma_f32_32x32x16_bf16 v[48:63], v[108:111], v[172:175], v[48:63]
    ds_read_b128 v[104:107], v2 offset:18432
    s_waitcnt lgkmcnt(6)
    v_mfma_f32_32x32x16_bf16 v[48:63], v[112:115], v[176:179], v[48:63]
    ds_read_b128 v[108:111], v2 offset:19456
    s_waitcnt lgkmcnt(6)
    v_mfma_f32_32x32x16_bf16 v[48:63], v[116:119], v[180:183], v[48:63]
    ds_read_b128 v[112:115], v2 offset:20480
    s_waitcnt lgkmcnt(6)
    v_mfma_f32_32x32x16_bf16 v[48:63], v[120:123], v[184:187], v[48:63]
    ds_read_b128 v[116:119], v2 offset:21504
    s_waitcnt lgkmcnt(6)
    v_mfma_f32_32x32x16_bf16 v[48:63], v[124:127], v[188:191], v[48:63]
    ds_read_b128 v[120:123], v2 offset:22528
    s_waitcnt lgkmcnt(6)
    v_mfma_f32_32x32x16_bf16 v[48:63], v[96:99], v[192:195], v[48:63]
    ds_read_b128 v[124:127], v2 offset:23552
    s_waitcnt lgkmcnt(6)
    v_mfma_f32_32x32x16_bf16 v[48:63], v[100:103], v[196:199], v[48:63]
    ds_read_b128 v[96:99], v2 offset:24576
    s_waitcnt lgkmcnt(6)
    v_mfma_f32_32x32x16_bf16 v[48:63], v[104:107], v[200:203], v[48:63]
    ds_read_b128 v[100:103], v2 offset:25600
    s_waitcnt lgkmcnt(6)
    v_mfma_f32_32x32x16_bf16 v[48:63], v[108:111], v[204:207], v[48:63]
    ds_read_b128 v[104:107], v2 offset:26624
    s_waitcnt lgkmcnt(6)
    v_mfma_f32_32x32x16_bf16 v[48:63], v[112:115], v[208:211], v[48:63]
    ds_read_b128 v[108:111], v2 offset:27648
    s_waitcnt lgkmcnt(6)
    v_mfma_f32_32x32x16_bf16 v[48:63], v[116:119], v[212:215], v[48:63]
    ds_read_b128 v[112:115], v2 offset:28672
    s_waitcnt lgkmcnt(6)
    v_mfma_f32_32x32x16_bf16 v[48:63], v[120:123], v[216:219], v[48:63]
    ds_read_b128 v[116:119], v2 offset:29696
    s_waitcnt lgkmcnt(6)
    v_mfma_f32_32x32x16_bf16 v[48:63], v[124:127], v[220:223], v[48:63]
    ds_read_b128 v[120:123], v2 offset:30720
    s_waitcnt lgkmcnt(6)
    v_mfma_f32_32x32x16_bf16 v[48:63], v[96:99], v[224:227], v[48:63]
    ds_read_b128 v[124:127], v2 offset:31744
    s_waitcnt lgkmcnt(0)
    s_waitcnt vmcnt(0)
    s_barrier
    s_mov_b32 s19, 1
    s_atomic_add s19, s[4:5], s52
    v_mfma_f32_32x32x16_bf16 v[48:63], v[100:103], v[228:231], v[48:63]
    buffer_load_dwordx4 a[196:199], v1, s[8:11], s61 offen offset:3072 sc1
    v_mfma_f32_32x32x16_bf16 v[48:63], v[104:107], v[232:235], v[48:63]
    v_mfma_f32_32x32x16_bf16 v[48:63], v[108:111], v[236:239], v[48:63]
    s_add_u32 s61, s24, 28672
    buffer_load_dwordx4 a[200:203], v1, s[8:11], s61 offen offset:0 sc1
    v_mfma_f32_32x32x16_bf16 v[48:63], v[112:115], v[240:243], v[48:63]
    v_mfma_f32_32x32x16_bf16 v[48:63], v[116:119], v[244:247], v[48:63]
    buffer_load_dwordx4 a[204:207], v1, s[8:11], s61 offen offset:1024 sc1
    v_mfma_f32_32x32x16_bf16 v[48:63], v[120:123], v[248:251], v[48:63]
    v_mfma_f32_32x32x16_bf16 v[48:63], v[124:127], v[252:255], v[48:63]
    buffer_load_dwordx4 a[208:211], v1, s[8:11], s61 offen offset:2048 sc1
    v_accvgpr_read_b32 v7, a245
    s_mov_b32 s96, 0x11111
    s_lshl_b32 s96, s96, s3
    s_and_b32 s96, s96, 0x7ffff
    s_mov_b32 s97, 0
    v_accvgpr_write_b32 a72, 0
    s_mov_b64 exec, s[96:97]
    buffer_atomic_add a72, v7, s[8:11], 0 offen sc0 sc1
    s_mov_b64 exec, -1
    s_nop 1
    v_max3_f32 v10, v48, v49, v50
    v_min3_f32 v11, v48, v49, v50
    v_max3_f32 v10, v10, v51, v52
    buffer_load_dwordx4 a[212:215], v1, s[8:11], s61 offen offset:3072 sc1
    v_min3_f32 v11, v11, v51, v52
    v_max3_f32 v10, v10, v53, v54
    v_min3_f32 v11, v11, v53, v54
    v_max3_f32 v10, v10, v55, v56
    v_min3_f32 v11, v11, v55, v56
    v_max3_f32 v10, v10, v57, v58
    v_min3_f32 v11, v11, v57, v58
    v_max3_f32 v10, v10, v59, v60
    v_min3_f32 v11, v11, v59, v60
    v_max3_f32 v10, v10, v61, v62
    v_min3_f32 v11, v11, v61, v62
    v_max_f32 v10, v10, v63
    v_min_f32 v11, v11, v63
    v_mul_f32 v10, -v5, v10
    v_mul_f32 v11, v5, v11
    v_pk_fma_f32 v[96:97], v[48:49], v[4:5], v[10:11] op_sel:[0,1,1] op_sel_hi:[1,1,1] neg_lo:[0,1,0] neg_hi:[0,1,0]
    v_pk_fma_f32 v[48:49], v[48:49], v[4:5], v[10:11] op_sel:[0,1,0] op_sel_hi:[1,1,0]
    v_pk_fma_f32 v[98:99], v[50:51], v[4:5], v[10:11] op_sel:[0,1,1] op_sel_hi:[1,1,1] neg_lo:[0,1,0] neg_hi:[0,1,0]
    v_pk_fma_f32 v[50:51], v[50:51], v[4:5], v[10:11] op_sel:[0,1,0] op_sel_hi:[1,1,0]
    v_exp_f32 v48, v48
    v_exp_f32 v49, v49
    v_exp_f32 v96, v96
    v_exp_f32 v97, v97
    v_pk_fma_f32 v[100:101], v[52:53], v[4:5], v[10:11] op_sel:[0,1,1] op_sel_hi:[1,1,1] neg_lo:[0,1,0] neg_hi:[0,1,0]
    v_pk_fma_f32 v[52:53], v[52:53], v[4:5], v[10:11] op_sel:[0,1,0] op_sel_hi:[1,1,0]
    v_exp_f32 v50, v50
    v_exp_f32 v51, v51
    v_exp_f32 v98, v98
    v_exp_f32 v99, v99
    v_pk_fma_f32 v[102:103], v[54:55], v[4:5], v[10:11] op_sel:[0,1,1] op_sel_hi:[1,1,1] neg_lo:[0,1,0] neg_hi:[0,1,0]
    v_pk_fma_f32 v[54:55], v[54:55], v[4:5], v[10:11] op_sel:[0,1,0] op_sel_hi:[1,1,0]
    v_exp_f32 v52, v52
    v_exp_f32 v53, v53
    v_exp_f32 v100, v100
    v_exp_f32 v101, v101
    v_pk_fma_f32 v[104:105], v[56:57], v[4:5], v[10:11] op_sel:[0,1,1] op_sel_hi:[1,1,1] neg_lo:[0,1,0] neg_hi:[0,1,0]
    v_pk_fma_f32 v[56:57], v[56:57], v[4:5], v[10:11] op_sel:[0,1,0] op_sel_hi:[1,1,0]
    v_exp_f32 v54, v54
    v_exp_f32 v55, v55
    v_exp_f32 v102, v102
    v_exp_f32 v103, v103
    v_pk_fma_f32 v[106:107], v[58:59], v[4:5], v[10:11] op_sel:[0,1,1] op_sel_hi:[1,1,1] neg_lo:[0,1,0] neg_hi:[0,1,0]
    v_pk_fma_f32 v[58:59], v[58:59], v[4:5], v[10:11] op_sel:[0,1,0] op_sel_hi:[1,1,0]
    v_exp_f32 v56, v56
    v_exp_f32 v57, v57
    v_exp_f32 v104, v104
    v_exp_f32 v105, v105
    v_pk_fma_f32 v[108:109], v[60:61], v[4:5], v[10:11] op_sel:[0,1,1] op_sel_hi:[1,1,1] neg_lo:[0,1,0] neg_hi:[0,1,0]
    v_pk_fma_f32 v[60:61], v[60:61], v[4:5], v[10:11] op_sel:[0,1,0] op_sel_hi:[1,1,0]
    v_exp_f32 v58, v58
    v_exp_f32 v59, v59
    v_exp_f32 v106, v106
    v_exp_f32 v107, v107
    v_pk_fma_f32 v[110:111], v[62:63], v[4:5], v[10:11] op_sel:[0,1,1] op_sel_hi:[1,1,1] neg_lo:[0,1,0] neg_hi:[0,1,0]
    v_pk_fma_f32 v[62:63], v[62:63], v[4:5], v[10:11] op_sel:[0,1,0] op_sel_hi:[1,1,0]
    v_exp_f32 v60, v60
    v_exp_f32 v61, v61
    s_mov_b32 s54, 0
    s_atomic_add s54, s[4:5], s52 glc
    v_exp_f32 v108, v108
    v_exp_f32 v109, v109
    v_exp_f32 v62, v62
    v_exp_f32 v63, v63
    v_exp_f32 v110, v110
    v_exp_f32 v111, v111
    v_pk_add_f32 v[12:13], v[48:49], v[50:51]
    v_pk_add_f32 v[14:15], v[96:97], v[98:99]
    v_pk_add_f32 v[12:13], v[12:13], v[52:53]
    v_pk_add_f32 v[14:15], v[14:15], v[100:101]
    v_pk_add_f32 v[12:13], v[12:13], v[54:55]
    v_pk_add_f32 v[14:15], v[14:15], v[102:103]
    v_pk_add_f32 v[12:13], v[12:13], v[56:57]
    v_pk_add_f32 v[14:15], v[14:15], v[104:105]
    v_pk_add_f32 v[12:13], v[12:13], v[58:59]
    v_pk_add_f32 v[14:15], v[14:15], v[106:107]
    v_pk_add_f32 v[12:13], v[12:13], v[60:61]
    v_pk_add_f32 v[14:15], v[14:15], v[108:109]
    v_pk_add_f32 v[12:13], v[12:13], v[62:63]
    v_pk_add_f32 v[14:15], v[14:15], v[110:111]
    v_add_f32 v12, v12, v13
    v_add_f32 v14, v14, v15
    v_rcp_f32 v12, v12
    v_rcp_f32 v14, v14
    v_pk_mul_f32 v[48:49], v[48:49], v[12:13] op_sel_hi:[1,0]
    v_pk_mul_f32 v[50:51], v[50:51], v[12:13] op_sel_hi:[1,0]
    v_pk_mul_f32 v[52:53], v[52:53], v[12:13] op_sel_hi:[1,0]
    v_pk_mul_f32 v[54:55], v[54:55], v[12:13] op_sel_hi:[1,0]
    v_cvt_pk_bf16_f32 v112, v48, v49
    v_cvt_pk_bf16_f32 v113, v50, v51
    v_cvt_pk_bf16_f32 v114, v52, v53
    v_cvt_pk_bf16_f32 v115, v54, v55
    v_pk_mul_f32 v[56:57], v[56:57], v[12:13] op_sel_hi:[1,0]
    v_pk_mul_f32 v[58:59], v[58:59], v[12:13] op_sel_hi:[1,0]
    v_pk_mul_f32 v[60:61], v[60:61], v[12:13] op_sel_hi:[1,0]
    v_pk_mul_f32 v[62:63], v[62:63], v[12:13] op_sel_hi:[1,0]
    v_cvt_pk_bf16_f32 v116, v56, v57
    v_cvt_pk_bf16_f32 v117, v58, v59
    v_cvt_pk_bf16_f32 v118, v60, v61
    v_cvt_pk_bf16_f32 v119, v62, v63
    v_pk_mul_f32 v[96:97], v[96:97], v[14:15] op_sel_hi:[1,0]
    v_pk_mul_f32 v[98:99], v[98:99], v[14:15] op_sel_hi:[1,0]
    v_pk_mul_f32 v[100:101], v[100:101], v[14:15] op_sel_hi:[1,0]
    v_pk_mul_f32 v[102:103], v[102:103], v[14:15] op_sel_hi:[1,0]
    v_cvt_pk_bf16_f32 v120, v96, v97
    v_cvt_pk_bf16_f32 v121, v98, v99
    v_cvt_pk_bf16_f32 v122, v100, v101
    v_cvt_pk_bf16_f32 v123, v102, v103
    v_pk_mul_f32 v[104:105], v[104:105], v[14:15] op_sel_hi:[1,0]
    v_pk_mul_f32 v[106:107], v[106:107], v[14:15] op_sel_hi:[1,0]
    v_pk_mul_f32 v[108:109], v[108:109], v[14:15] op_sel_hi:[1,0]
    v_pk_mul_f32 v[110:111], v[110:111], v[14:15] op_sel_hi:[1,0]
    v_cvt_pk_bf16_f32 v124, v104, v105
    v_cvt_pk_bf16_f32 v125, v106, v107
    v_cvt_pk_bf16_f32 v126, v108, v109
    v_cvt_pk_bf16_f32 v127, v110, v111
    s_waitcnt vmcnt(1)
    v_accvgpr_read_b32 v14, a72
    v_accvgpr_read_b32 v15, a245
    s_mov_b64 exec, s[96:97]
    v_cmp_ne_u32 vcc, s60, v14
    s_nop 0
    s_cbranch_vccz L_ok_10
    s_mov_b32 s41, 65536
L_spin_9:
    v_mov_b32 v14, 0
    buffer_atomic_add v14, v15, s[8:11], 0 offen sc0 sc1
    s_waitcnt vmcnt(0)
    s_nop 0
    v_cmp_ne_u32 vcc, s60, v14
    s_nop 0
    s_cbranch_vccz L_ok_10
    s_sub_u32 s41, s41, 1
    s_cbranch_scc0 L_spin_9
L_ok_10:
    s_mov_b64 exec, -1
    s_barrier
    s_add_u32 m0, s26, 0
    s_add_u32 s40, s58, 0
    buffer_load_dwordx4 v1, s[8:11], s40 offen offset:0 sc1 lds
    buffer_load_dwordx4 v1, s[8:11], s40 offen offset:1024 sc1 lds
    buffer_load_dwordx4 v1, s[8:11], s40 offen offset:2048 sc1 lds
    buffer_load_dwordx4 v1, s[8:11], s40 offen offset:3072 sc1 lds
    v_mov_b32 v64, 0
    v_mov_b32 v65, 0
    v_mov_b32 v66, 0
    v_mov_b32 v67, 0
    ds_write_b128 v2, v[64:67] offset:61440
    ds_write_b128 v2, v[64:67] offset:62464
    s_lshl_b32 s42, s17, 15
    s_lshl_b32 s43, s3, 9
    s_add_u32 s42, s42, s43
    s_add_u32 s47, s42, 21561344
    s_lshl_b32 s42, s17, 12
    s_add_u32 s42, s42, 23658496
    v_and_b32 v7, 0x1ff, v1
    v_and_b32 v6, 0x200, v1
    v_lshl_add_u32 v7, v6, 2, v7
    s_mov_b32 s34, 0x3f80
    s_mov_b32 s35, 0x3f800000
    v_accvgpr_read_b32 v8, a244
    v_accvgpr_read_b32 v9, a241
    v_accvgpr_read_b32 v10, a243
    v_accvgpr_read_b32 v11, a242
    v_mov_b32 v64, 0
    v_mov_b32 v65, 0
    v_mov_b32 v66, 0
    v_mov_b32 v67, 0
    v_mov_b32 v68, 0
    v_mov_b32 v69, 0
    v_mov_b32 v70, 0
    v_mov_b32 v71, 0
    s_waitcnt lgkmcnt(0)
    s_bitcmp1_b32 s54, 4
    s_cbranch_scc1 L_ok_12
    s_mov_b32 s41, 65536
L_spin_11:
    s_mov_b32 s54, 0
    s_atomic_add s54, s[4:5], s52 glc
    s_waitcnt lgkmcnt(0)
    s_bitcmp1_b32 s54, 4
    s_cbranch_scc1 L_ok_12
    s_sub_u32 s41, s41, 1
    s_cbranch_scc0 L_spin_11
L_ok_12:
    buffer_load_dwordx4 v[16:19], v1, s[8:11], s42 offen offset:0 sc1
    buffer_load_dwordx4 v[20:23], v1, s[8:11], s42 offen offset:1024 sc1
    buffer_load_dwordx4 v[24:27], v1, s[8:11], s42 offen offset:2048 sc1
    buffer_load_dwordx4 v[28:31], v1, s[8:11], s42 offen offset:3072 sc1
    buffer_load_dwordx4 v[32:35], v7, s[8:11], s47 offen offset:0 sc1
    s_add_u32 s43, s47, 4096
    buffer_load_dwordx4 v[36:39], v7, s[8:11], s43 offen offset:0 sc1
    s_add_u32 s43, s47, 8192
    buffer_load_dwordx4 v[40:43], v7, s[8:11], s43 offen offset:0 sc1
    s_add_u32 s43, s47, 12288
    buffer_load_dwordx4 v[44:47], v7, s[8:11], s43 offen offset:0 sc1
    s_add_u32 s43, s47, 16384
    buffer_load_dwordx4 v[48:51], v7, s[8:11], s43 offen offset:0 sc1
    s_add_u32 s43, s47, 20480
    buffer_load_dwordx4 v[52:55], v7, s[8:11], s43 offen offset:0 sc1
    s_add_u32 s43, s47, 24576
    buffer_load_dwordx4 v[56:59], v7, s[8:11], s43 offen offset:0 sc1
    s_add_u32 s43, s47, 28672
    buffer_load_dwordx4 v[60:63], v7, s[8:11], s43 offen offset:0 sc1
    v_and_b32 v12, 0x7f, v4
    v_lshrrev_b32 v13, 9, v1
    v_mul_u32_u24 v13, 14336, v13
    v_add_u32 v12, v12, v13
    v_add_u32 v13, 28672, v12
    s_mul_i32 s43, s17, 896
    s_add_u32 s43, s43, 38469632
    buffer_load_dword a0, v12, s[8:11], s43 offen offset:0 sc1
    buffer_load_dword a1, v13, s[8:11], s43 offen offset:0 sc1
    buffer_load_dword a2, v12, s[8:11], s43 offen offset:128 sc1
    buffer_load_dword a3, v13, s[8:11], s43 offen offset:128 sc1
    buffer_load_dword a4, v12, s[8:11], s43 offen offset:256 sc1
    buffer_load_dword a5, v13, s[8:11], s43 offen offset:256 sc1
    buffer_load_dword a6, v12, s[8:11], s43 offen offset:384 sc1
    buffer_load_dword a7, v13, s[8:11], s43 offen offset:384 sc1
    buffer_load_dword a8, v12, s[8:11], s43 offen offset:512 sc1
    buffer_load_dword a9, v13, s[8:11], s43 offen offset:512 sc1
    buffer_load_dword a10, v12, s[8:11], s43 offen offset:640 sc1
    buffer_load_dword a11, v13, s[8:11], s43 offen offset:640 sc1
    buffer_load_dword a12, v12, s[8:11], s43 offen offset:768 sc1
    buffer_load_dword a13, v13, s[8:11], s43 offen offset:768 sc1
    s_add_u32 m0, s26, 16384
    s_add_u32 s40, s58, 16384
    buffer_load_dwordx4 v1, s[8:11], s40 offen offset:0 sc1 lds
    buffer_load_dwordx4 v1, s[8:11], s40 offen offset:1024 sc1 lds
    buffer_load_dwordx4 v1, s[8:11], s40 offen offset:2048 sc1 lds
    buffer_load_dwordx4 v1, s[8:11], s40 offen offset:3072 sc1 lds
    s_add_u32 m0, s26, 32768
    s_add_u32 s40, s58, 32768
    buffer_load_dwordx4 v1, s[8:11], s40 offen offset:0 sc1 lds
    buffer_load_dwordx4 v1, s[8:11], s40 offen offset:1024 sc1 lds
    buffer_load_dwordx4 v1, s[8:11], s40 offen offset:2048 sc1 lds
    buffer_load_dwordx4 v1, s[8:11], s40 offen offset:3072 sc1 lds
    s_lshl_b32 s42, s17, 11
    s_add_u32 s42, s42, s20
    s_add_u32 s42, s42, 17367040
    s_lshl_b32 s43, s18, 2
    s_lshr_b32 s52, s17, 2
    s_add_u32 s52, s52, s43
    s_lshl_b32 s52, s52, 7
    s_add_u32 s52, s52, 7708672
    s_waitcnt vmcnt(32)
    v_pk_add_f32 v[16:17], v[16:17], v[20:21]
    v_pk_add_f32 v[18:19], v[18:19], v[22:23]
    s_waitcnt vmcnt(30)
    v_pk_add_f32 v[24:25], v[24:25], v[28:29]
    v_pk_add_f32 v[26:27], v[26:27], v[30:31]
    v_pk_add_f32 v[16:17], v[16:17], v[24:25]
    v_pk_add_f32 v[18:19], v[18:19], v[26:27]
    s_nop 1
    v_permlane32_swap_b32 v16, v18
    v_permlane32_swap_b32 v17, v19
    v_add_f32 v16, v16, v18
    v_add_f32 v17, v17, v19
    s_nop 1
    v_permlane16_swap_b32 v16, v17
    v_add_f32 v16, v16, v17
    v_cvt_pk_bf16_f32 v16, v16, v16
    ds_write_b16 v8, v16
    ds_read_b128 v[96:99], v10 offset:0
    ds_read_b128 v[100:103], v10 offset:16
    ds_read_b128 v[104:107], v10 offset:32
    ds_read_b128 v[108:111], v10 offset:48
    s_waitcnt vmcnt(29)
    v_dot2_f32_bf16 v64, v32, s34, v64
    v_dot2_f32_bf16 v65, v32, s35, v65
    v_dot2_f32_bf16 v66, v33, s34, v66
    v_dot2_f32_bf16 v67, v33, s35, v67
    v_dot2_f32_bf16 v68, v34, s34, v68
    v_dot2_f32_bf16 v69, v34, s35, v69
    v_dot2_f32_bf16 v70, v35, s34, v70
    v_dot2_f32_bf16 v71, v35, s35, v71
    s_waitcnt lgkmcnt(3)
    v_mfma_f32_32x32x16_bf16 v[80:95], v[96:99], v[112:115], 0
    s_waitcnt vmcnt(28)
    v_dot2_f32_bf16 v64, v36, s34, v64
    v_dot2_f32_bf16 v65, v36, s35, v65
    v_dot2_f32_bf16 v66, v37, s34, v66
    v_dot2_f32_bf16 v67, v37, s35, v67
    v_dot2_f32_bf16 v68, v38, s34, v68
    v_dot2_f32_bf16 v69, v38, s35, v69
    v_dot2_f32_bf16 v70, v39, s34, v70
    v_dot2_f32_bf16 v71, v39, s35, v71
    s_waitcnt lgkmcnt(2)
    v_mfma_f32_32x32x16_bf16 v[80:95], v[100:103], v[116:119], v[80:95]
    s_waitcnt vmcnt(27)
    v_dot2_f32_bf16 v64, v40, s34, v64
    v_dot2_f32_bf16 v65, v40, s35, v65
    v_dot2_f32_bf16 v66, v41, s34, v66
    v_dot2_f32_bf16 v67, v41, s35, v67
    v_dot2_f32_bf16 v68, v42, s34, v68
    v_dot2_f32_bf16 v69, v42, s35, v69
    v_dot2_f32_bf16 v70, v43, s34, v70
    v_dot2_f32_bf16 v71, v43, s35, v71
    s_waitcnt lgkmcnt(1)
    v_mfma_f32_32x32x16_bf16 v[80:95], v[104:107], v[120:123], v[80:95]
    s_waitcnt vmcnt(26)
    v_dot2_f32_bf16 v64, v44, s34, v64
    v_dot2_f32_bf16 v65, v44, s35, v65
    v_dot2_f32_bf16 v66, v45, s34, v66
    v_dot2_f32_bf16 v67, v45, s35, v67
    v_dot2_f32_bf16 v68, v46, s34, v68
    v_dot2_f32_bf16 v69, v46, s35, v69
    v_dot2_f32_bf16 v70, v47, s34, v70
    v_dot2_f32_bf16 v71, v47, s35, v71
    s_waitcnt lgkmcnt(0)
    v_mfma_f32_32x32x16_bf16 v[80:95], v[108:111], v[124:127], v[80:95]
    s_waitcnt vmcnt(25)
    v_dot2_f32_bf16 v64, v48, s34, v64
    v_dot2_f32_bf16 v65, v48, s35, v65
    v_dot2_f32_bf16 v66, v49, s34, v66
    v_dot2_f32_bf16 v67, v49, s35, v67
    v_dot2_f32_bf16 v68, v50, s34, v68
    v_dot2_f32_bf16 v69, v50, s35, v69
    v_dot2_f32_bf16 v70, v51, s34, v70
    v_dot2_f32_bf16 v71, v51, s35, v71
    s_waitcnt vmcnt(24)
    v_dot2_f32_bf16 v64, v52, s34, v64
    v_dot2_f32_bf16 v65, v52, s35, v65
    v_dot2_f32_bf16 v66, v53, s34, v66
    v_dot2_f32_bf16 v67, v53, s35, v67
    v_dot2_f32_bf16 v68, v54, s34, v68
    v_dot2_f32_bf16 v69, v54, s35, v69
    v_dot2_f32_bf16 v70, v55, s34, v70
    v_dot2_f32_bf16 v71, v55, s35, v71
    s_waitcnt vmcnt(23)
    v_dot2_f32_bf16 v64, v56, s34, v64
    v_dot2_f32_bf16 v65, v56, s35, v65
    v_dot2_f32_bf16 v66, v57, s34, v66
    v_dot2_f32_bf16 v67, v57, s35, v67
    v_dot2_f32_bf16 v68, v58, s34, v68
    v_dot2_f32_bf16 v69, v58, s35, v69
    v_dot2_f32_bf16 v70, v59, s34, v70
    v_dot2_f32_bf16 v71, v59, s35, v71
    v_add_f32 v80, 0x358637bd, v80
    v_rcp_f32 v80, v80
    s_waitcnt vmcnt(22)
    v_dot2_f32_bf16 v64, v60, s34, v64
    v_dot2_f32_bf16 v65, v60, s35, v65
    v_dot2_f32_bf16 v66, v61, s34, v66
    v_dot2_f32_bf16 v67, v61, s35, v67
    v_dot2_f32_bf16 v68, v62, s34, v68
    v_dot2_f32_bf16 v69, v62, s35, v69
    v_dot2_f32_bf16 v70, v63, s34, v70
    v_dot2_f32_bf16 v71, v63, s35, v71
    v_permlane32_swap_b32 v64, v68
    v_permlane32_swap_b32 v65, v69
    v_permlane32_swap_b32 v66, v70
    v_permlane32_swap_b32 v67, v71
    v_pk_add_f32 v[64:65], v[64:65], v[68:69]
    v_pk_add_f32 v[66:67], v[66:67], v[70:71]
    v_cvt_pk_bf16_f32 v64, v64, v65
    v_cvt_pk_bf16_f32 v65, v66, v67
    ds_write_b64 v9, v[64:65]
    s_waitcnt lgkmcnt(0)
    s_barrier
    ds_read_b128 v[32:35], v11 offset:0
    ds_read_b128 v[36:39], v11 offset:512
    ds_read_b128 v[40:43], v11 offset:1024
    ds_read_b128 v[44:47], v11 offset:1536
    s_waitcnt lgkmcnt(3)
    v_mfma_f32_32x32x16_bf16 v[16:31], v[32:35], v[112:115], 0
    s_waitcnt lgkmcnt(2)
    v_mfma_f32_32x32x16_bf16 v[16:31], v[36:39], v[116:119], v[16:31]
    s_waitcnt lgkmcnt(1)
    v_mfma_f32_32x32x16_bf16 v[16:31], v[40:43], v[120:123], v[16:31]
    s_waitcnt lgkmcnt(0)
    v_mfma_f32_32x32x16_bf16 v[16:31], v[44:47], v[124:127], v[16:31]
    s_nop 11
    v_pk_mul_f32 v[16:17], v[16:17], v[80:81] op_sel_hi:[1,0]
    v_pk_mul_f32 v[18:19], v[18:19], v[80:81] op_sel_hi:[1,0]
    v_pk_mul_f32 v[20:21], v[20:21], v[80:81] op_sel_hi:[1,0]
    v_pk_mul_f32 v[22:23], v[22:23], v[80:81] op_sel_hi:[1,0]
    v_cvt_pk_bf16_f32 v48, v16, v17
    v_cvt_pk_bf16_f32 v49, v18, v19
    v_cvt_pk_bf16_f32 v50, v20, v21
    v_cvt_pk_bf16_f32 v51, v22, v23
    buffer_store_dwordx4 v[48:51], v1, s[8:11], s42 offen offset:0 sc1
    v_pk_mul_f32 v[24:25], v[24:25], v[80:81] op_sel_hi:[1,0]
    v_pk_mul_f32 v[26:27], v[26:27], v[80:81] op_sel_hi:[1,0]
    v_pk_mul_f32 v[28:29], v[28:29], v[80:81] op_sel_hi:[1,0]
    v_pk_mul_f32 v[30:31], v[30:31], v[80:81] op_sel_hi:[1,0]
    v_cvt_pk_bf16_f32 v52, v24, v25
    v_cvt_pk_bf16_f32 v53, v26, v27
    v_cvt_pk_bf16_f32 v54, v28, v29
    v_cvt_pk_bf16_f32 v55, v30, v31
    buffer_store_dwordx4 v[52:55], v1, s[8:11], s42 offen offset:1024 sc1
    v_accvgpr_read_b32 v7, a238
    s_lshl_b32 s42, s28, 15
    s_lshl_b32 s43, s29, 6
    s_add_u32 s42, s42, s43
    buffer_load_dwordx4 v[8:11], v7, s[92:95], s42 offen
    buffer_load_dwordx4 v[12:15], v7, s[92:95], s42 offen offset:32
    s_waitcnt vmcnt(2)
    s_mov_b32 s19, 1
    s_atomic_add s19, s[4:5], s52
    s_add_u32 m0, s26, 49152
    s_add_u32 s40, s58, 49152
    buffer_load_dwordx4 v1, s[8:11], s40 offen offset:0 sc1 lds
    buffer_load_dwordx4 v1, s[8:11], s40 offen offset:1024 sc1 lds
    buffer_load_dwordx4 v1, s[8:11], s40 offen offset:2048 sc1 lds
    buffer_load_dwordx4 v1, s[8:11], s40 offen offset:3072 sc1 lds
    s_add_u32 m0, s26, 65536
    s_add_u32 s40, s58, 65536
    buffer_load_dwordx4 v1, s[8:11], s40 offen offset:0 sc1 lds
    buffer_load_dwordx4 v1, s[8:11], s40 offen offset:1024 sc1 lds
    buffer_load_dwordx4 v1, s[8:11], s40 offen offset:2048 sc1 lds
    buffer_load_dwordx4 v1, s[8:11], s40 offen offset:3072 sc1 lds
    s_add_u32 m0, s26, 81920
    s_add_u32 s40, s58, 81920
    buffer_load_dwordx4 v1, s[8:11], s40 offen offset:0 sc1 lds
    buffer_load_dwordx4 v1, s[8:11], s40 offen offset:1024 sc1 lds
    buffer_load_dwordx4 v1, s[8:11], s40 offen offset:2048 sc1 lds
    buffer_load_dwordx4 v1, s[8:11], s40 offen offset:3072 sc1 lds
    s_add_u32 s39, s25, 53248
    buffer_load_dwordx4 a[220:223], v1, s[8:11], s39 offen offset:3072 sc1
    buffer_load_dwordx4 a[216:219], v1, s[8:11], s39 offen offset:2048 sc1
    s_add_u32 s39, s25, 20480
    buffer_load_dwordx4 a[84:87], v1, s[8:11], s39 offen offset:1024 sc1
    buffer_load_dwordx4 a[80:83], v1, s[8:11], s39 offen offset:0 sc1
    s_add_u32 s39, s25, 16384
    buffer_load_dwordx4 a[76:79], v1, s[8:11], s39 offen offset:3072 sc1
    buffer_load_dwordx4 a[72:75], v1, s[8:11], s39 offen offset:2048 sc1
    v_cmp_gt_u32 vcc, 512, v1
    v_accvgpr_read_b32 v32, a0
    v_accvgpr_read_b32 v33, a1
    v_accvgpr_read_b32 v34, a2
    v_accvgpr_read_b32 v35, a3
    v_accvgpr_read_b32 v36, a4
    v_accvgpr_read_b32 v37, a5
    v_accvgpr_read_b32 v38, a6
    v_accvgpr_read_b32 v39, a7
    v_accvgpr_read_b32 v40, a8
    v_accvgpr_read_b32 v41, a9
    v_accvgpr_read_b32 v42, a10
    v_accvgpr_read_b32 v43, a11
    v_accvgpr_read_b32 v44, a12
    v_accvgpr_read_b32 v45, a13
    v_add_f32 v32, v32, v33
    v_mov_b32 v33, v32
    v_add_f32 v34, v34, v35
    v_mov_b32 v35, v34
    v_add_f32 v36, v36, v37
    v_mov_b32 v37, v36
    v_add_f32 v38, v38, v39
    v_mov_b32 v39, v38
    v_add_f32 v40, v40, v41
    v_mov_b32 v41, v40
    v_add_f32 v42, v42, v43
    v_mov_b32 v43, v42
    v_add_f32 v44, v44, v45
    v_mov_b32 v45, v44
    v_permlane32_swap_b32 v32, v33
    v_add_f32 v32, -v32, -v33
    v_cvt_pk_bf16_f32 v33, v32, v32
    v_lshlrev_b32 v33, 16, v33
    v_sub_f32 v33, v32, v33
    v_cvt_pk_bf16_f32 v32, v32, v33
    v_cndmask_b32 v32, 0, v32, vcc
    v_accvgpr_write_b32 a224, v32
    v_permlane32_swap_b32 v34, v35
    v_add_f32 v34, -v34, -v35
    v_cvt_pk_bf16_f32 v35, v34, v34
    v_lshlrev_b32 v35, 16, v35
    v_sub_f32 v35, v34, v35
    v_cvt_pk_bf16_f32 v34, v34, v35
    v_cndmask_b32 v34, 0, v34, vcc
    v_accvgpr_write_b32 a225, v34
    v_permlane32_swap_b32 v36, v37
    v_add_f32 v36, -v36, -v37
    v_cvt_pk_bf16_f32 v37, v36, v36
    v_lshlrev_b32 v37, 16, v37
    v_sub_f32 v37, v36, v37
    v_cvt_pk_bf16_f32 v36, v36, v37
    v_cndmask_b32 v36, 0, v36, vcc
    v_accvgpr_write_b32 a226, v36
    v_permlane32_swap_b32 v38, v39
    v_add_f32 v38, -v38, -v39
    v_cvt_pk_bf16_f32 v39, v38, v38
    v_lshlrev_b32 v39, 16, v39
    v_sub_f32 v39, v38, v39
    v_cvt_pk_bf16_f32 v38, v38, v39
    v_cndmask_b32 v38, 0, v38, vcc
    v_accvgpr_write_b32 a227, v38
    v_permlane32_swap_b32 v40, v41
    v_add_f32 v40, -v40, -v41
    v_cvt_pk_bf16_f32 v41, v40, v40
    v_lshlrev_b32 v41, 16, v41
    v_sub_f32 v41, v40, v41
    v_cvt_pk_bf16_f32 v40, v40, v41
    v_cndmask_b32 v40, 0, v40, vcc
    v_accvgpr_write_b32 a228, v40
    v_permlane32_swap_b32 v42, v43
    v_add_f32 v42, -v42, -v43
    v_cvt_pk_bf16_f32 v43, v42, v42
    v_lshlrev_b32 v43, 16, v43
    v_sub_f32 v43, v42, v43
    v_cvt_pk_bf16_f32 v42, v42, v43
    v_cndmask_b32 v42, 0, v42, vcc
    v_accvgpr_write_b32 a229, v42
    v_permlane32_swap_b32 v44, v45
    v_add_f32 v44, -v44, -v45
    v_cvt_pk_bf16_f32 v45, v44, v44
    v_lshlrev_b32 v45, 16, v45
    v_sub_f32 v45, v44, v45
    v_cvt_pk_bf16_f32 v44, v44, v45
    v_cndmask_b32 v44, 0, v44, vcc
    v_accvgpr_write_b32 a230, v44
    s_waitcnt vmcnt(19)
    v_lshlrev_b32 v16, 16, v8
    v_and_b32 v17, 0xffff0000, v8
    v_lshlrev_b32 v18, 16, v9
    v_and_b32 v19, 0xffff0000, v9
    v_lshlrev_b32 v20, 16, v10
    v_and_b32 v21, 0xffff0000, v10
    v_lshlrev_b32 v22, 16, v11
    v_and_b32 v23, 0xffff0000, v11
    s_waitcnt vmcnt(18)
    v_lshlrev_b32 v24, 16, v12
    v_and_b32 v25, 0xffff0000, v12
    v_lshlrev_b32 v26, 16, v13
    v_and_b32 v27, 0xffff0000, v13
    v_lshlrev_b32 v28, 16, v14
    v_and_b32 v29, 0xffff0000, v14
    v_lshlrev_b32 v30, 16, v15
    v_and_b32 v31, 0xffff0000, v15
    s_lshl_b32 s42, s28, 2
    s_add_u32 s42, s42, s3
    s_lshl_b32 s42, s42, 7
    s_add_u32 s52, s42, 7708672
    s_lshl_b32 s47, s28, 15
    s_lshl_b32 s43, s3, 13
    s_add_u32 s47, s47, s43
    s_lshl_b32 s42, s28, 15
    s_lshl_b32 s43, s29, 11
    s_add_u32 s42, s42, s43
    s_add_u32 s42, s42, 11075584
    v_accvgpr_read_b32 v6, a237
    s_lshl_b32 s46, s28, 12
    s_lshl_b32 s43, s29, 8
    s_add_u32 s46, s46, s43
    s_add_u32 s46, s46, 8192000
    v_accvgpr_read_b32 v7, a240
    s_mov_b32 s54, 0
    s_atomic_add s54, s[4:5], s52 glc
    s_waitcnt lgkmcnt(0)
    s_bitcmp1_b32 s54, 2
    s_cbranch_scc1 L_ok_14
    s_mov_b32 s41, 65536
L_spin_13:
    s_mov_b32 s54, 0
    s_atomic_add s54, s[4:5], s52 glc
    s_waitcnt lgkmcnt(0)
    s_bitcmp1_b32 s54, 2
    s_cbranch_scc1 L_ok_14
    s_sub_u32 s41, s41, 1
    s_cbranch_scc0 L_spin_13
L_ok_14:
    s_add_u32 m0, s27, 98304
    s_add_u32 s40, s47, 17367040
    buffer_load_dwordx4 v1, s[8:11], s40 offen offset:0 sc1 lds
    buffer_load_dwordx4 v1, s[8:11], s40 offen offset:1024 sc1 lds
    buffer_load_dwordx4 v1, s[8:11], s40 offen offset:2048 sc1 lds
    buffer_load_dwordx4 v1, s[8:11], s40 offen offset:3072 sc1 lds
    s_add_u32 m0, s27, 102400
    s_add_u32 s40, s47, 17371136
    buffer_load_dwordx4 v1, s[8:11], s40 offen offset:0 sc1 lds
    buffer_load_dwordx4 v1, s[8:11], s40 offen offset:1024 sc1 lds
    buffer_load_dwordx4 v1, s[8:11], s40 offen offset:2048 sc1 lds
    buffer_load_dwordx4 v1, s[8:11], s40 offen offset:3072 sc1 lds
    s_waitcnt vmcnt(0)
    s_barrier
    ds_read_b128 v[80:83], v2 offset:32768
    ds_read_b128 v[84:87], v2 offset:33792
    ds_read_b128 v[88:91], v2 offset:34816
    ds_read_b128 v[92:95], v2 offset:35840
    ds_read_b128 v[96:99], v2 offset:36864
    ds_read_b128 v[100:103], v2 offset:37888
    ds_read_b128 v[104:107], v2 offset:38912
    s_waitcnt lgkmcnt(6)
    v_mfma_f32_32x32x16_bf16 v[16:31], a[88:91], v[80:83], v[16:31]
    ds_read_b128 v[108:111], v2 offset:39936
    s_add_u32 s61, s25, 16384
    buffer_load_dwordx4 a[68:71], v1, s[8:11], s61 offen offset:1024 sc1
    s_waitcnt lgkmcnt(6)
    v_mfma_f32_32x32x16_bf16 v[16:31], a[92:95], v[84:87], v[16:31]
    ds_read_b128 v[80:83], v2 offset:49152
    s_waitcnt lgkmcnt(6)
    v_mfma_f32_32x32x16_bf16 v[16:31], a[96:99], v[88:91], v[16:31]
    ds_read_b128 v[84:87], v2 offset:50176
    buffer_load_dwordx4 a[64:67], v1, s[8:11], s61 offen offset:0 sc1
    s_waitcnt lgkmcnt(6)
    v_mfma_f32_32x32x16_bf16 v[16:31], a[100:103], v[92:95], v[16:31]
    ds_read_b128 v[88:91], v2 offset:51200
    s_waitcnt lgkmcnt(6)
    v_mfma_f32_32x32x16_bf16 v[16:31], a[104:107], v[96:99], v[16:31]
    ds_read_b128 v[92:95], v2 offset:52224
    s_add_u32 s61, s25, 12288
    buffer_load_dwordx4 a[60:63], v1, s[8:11], s61 offen offset:3072 sc1
    s_waitcnt lgkmcnt(6)
    v_mfma_f32_32x32x16_bf16 v[16:31], a[108:111], v[100:103], v[16:31]
    ds_read_b128 v[96:99], v2 offset:53248
    s_waitcnt lgkmcnt(6)
    v_mfma_f32_32x32x16_bf16 v[16:31], a[112:115], v[104:107], v[16:31]
    ds_read_b128 v[100:103], v2 offset:54272
    buffer_load_dwordx4 a[56:59], v1, s[8:11], s61 offen offset:2048 sc1
    s_waitcnt lgkmcnt(6)
    v_mfma_f32_32x32x16_bf16 v[16:31], a[116:119], v[108:111], v[16:31]
    ds_read_b128 v[104:107], v2 offset:55296
    s_waitcnt lgkmcnt(6)
    v_mfma_f32_32x32x16_bf16 v[16:31], a[120:123], v[80:83], v[16:31]
    ds_read_b128 v[108:111], v2 offset:56320
    buffer_load_dwordx4 a[52:55], v1, s[8:11], s61 offen offset:1024 sc1
    s_waitcnt lgkmcnt(6)
    v_mfma_f32_32x32x16_bf16 v[16:31], a[124:127], v[84:87], v[16:31]
    ds_read_b128 v[80:83], v3 offset:0
    s_waitcnt lgkmcnt(6)
    v_mfma_f32_32x32x16_bf16 v[16:31], a[128:131], v[88:91], v[16:31]
    ds_read_b128 v[84:87], v3 offset:1024
    buffer_load_dwordx4 a[48:51], v1, s[8:11], s61 offen offset:0 sc1
    s_waitcnt lgkmcnt(6)
    v_mfma_f32_32x32x16_bf16 v[16:31], a[132:135], v[92:95], v[16:31]
    ds_read_b128 v[88:91], v3 offset:2048
    s_waitcnt lgkmcnt(6)
    v_mfma_f32_32x32x16_bf16 v[16:31], a[136:139], v[96:99], v[16:31]
    ds_read_b128 v[92:95], v3 offset:3072
    s_add_u32 s61, s25, 8192
    buffer_load_dwordx4 a[44:47], v1, s[8:11], s61 offen offset:3072 sc1
    s_waitcnt lgkmcnt(6)
    v_mfma_f32_32x32x16_bf16 v[16:31], a[140:143], v[100:103], v[16:31]
    ds_read_b128 v[96:99], v3 offset:4096
    s_waitcnt lgkmcnt(6)
    v_mfma_f32_32x32x16_bf16 v[16:31], a[144:147], v[104:107], v[16:31]
    ds_read_b128 v[100:103], v3 offset:5120
    buffer_load_dwordx4 a[40:43], v1, s[8:11], s61 offen offset:2048 sc1
    s_waitcnt lgkmcnt(6)
    v_mfma_f32_32x32x16_bf16 v[16:31], a[148:151], v[108:111], v[16:31]
    ds_read_b128 v[104:107], v3 offset:6144
    s_waitcnt lgkmcnt(6)
    v_mfma_f32_32x32x16_bf16 v[16:31], a[152:155], v[80:83], v[16:31]
    ds_read_b128 v[108:111], v3 offset:7168
    buffer_load_dwordx4 a[36:39], v1, s[8:11], s61 offen offset:1024 sc1
    s_waitcnt lgkmcnt(6)
    v_mfma_f32_32x32x16_bf16 v[16:31], a[156:159], v[84:87], v[16:31]
    ds_read_b128 v[80:83], v3 offset:16384
    s_waitcnt lgkmcnt(6)
    v_mfma_f32_32x32x16_bf16 v[16:31], a[160:163], v[88:91], v[16:31]
    ds_read_b128 v[84:87], v3 offset:17408
    buffer_load_dwordx4 a[32:35], v1, s[8:11], s61 offen offset:0 sc1
    s_waitcnt lgkmcnt(6)
    v_mfma_f32_32x32x16_bf16 v[16:31], a[164:167], v[92:95], v[16:31]
    ds_read_b128 v[88:91], v3 offset:18432
    s_waitcnt lgkmcnt(6)
    v_mfma_f32_32x32x16_bf16 v[16:31], a[168:171], v[96:99], v[16:31]
    ds_read_b128 v[92:95], v3 offset:19456
    s_add_u32 s61, s25, 4096
    buffer_load_dwordx4 a[28:31], v1, s[8:11], s61 offen offset:3072 sc1
    s_waitcnt lgkmcnt(6)
    v_mfma_f32_32x32x16_bf16 v[16:31], a[172:175], v[100:103], v[16:31]
    ds_read_b128 v[96:99], v3 offset:20480
    s_waitcnt lgkmcnt(6)
    v_mfma_f32_32x32x16_bf16 v[16:31], a[176:179], v[104:107], v[16:31]
    ds_read_b128 v[100:103], v3 offset:21504
    buffer_load_dwordx4 a[24:27], v1, s[8:11], s61 offen offset:2048 sc1
    s_waitcnt lgkmcnt(6)
    v_mfma_f32_32x32x16_bf16 v[16:31], a[180:183], v[108:111], v[16:31]
    ds_read_b128 v[104:107], v3 offset:22528
    s_waitcnt lgkmcnt(6)
    v_mfma_f32_32x32x16_bf16 v[16:31], a[184:187], v[80:83], v[16:31]
    ds_read_b128 v[108:111], v3 offset:23552
    s_waitcnt lgkmcnt(6)
    v_mfma_f32_32x32x16_bf16 v[16:31], a[188:191], v[84:87], v[16:31]
    s_waitcnt lgkmcnt(5)
    v_mfma_f32_32x32x16_bf16 v[16:31], a[192:195], v[88:91], v[16:31]
    s_waitcnt lgkmcnt(4)
    v_mfma_f32_32x32x16_bf16 v[16:31], a[196:199], v[92:95], v[16:31]
    s_waitcnt lgkmcnt(3)
    v_mfma_f32_32x32x16_bf16 v[16:31], a[200:203], v[96:99], v[16:31]
    s_waitcnt lgkmcnt(2)
    v_mfma_f32_32x32x16_bf16 v[16:31], a[204:207], v[100:103], v[16:31]
    s_waitcnt lgkmcnt(1)
    v_mfma_f32_32x32x16_bf16 v[16:31], a[208:211], v[104:107], v[16:31]
    s_waitcnt lgkmcnt(0)
    v_mfma_f32_32x32x16_bf16 v[16:31], a[212:215], v[108:111], v[16:31]
    s_barrier
    s_nop 10
    v_cvt_pk_bf16_f32 v32, v16, v17
    v_cvt_pk_bf16_f32 v33, v18, v19
    v_cvt_pk_bf16_f32 v34, v20, v21
    v_cvt_pk_bf16_f32 v35, v22, v23
    buffer_store_dwordx4 v[32:35], v7, s[8:11], s42 offen offset:0 sc1
    v_cvt_pk_bf16_f32 v36, v24, v25
    v_cvt_pk_bf16_f32 v37, v26, v27
    v_cvt_pk_bf16_f32 v38, v28, v29
    v_cvt_pk_bf16_f32 v39, v30, v31
    buffer_store_dwordx4 v[36:39], v7, s[8:11], s42 offen offset:512 sc1
    v_pk_add_f32 v[40:41], v[16:17], v[18:19]
    v_pk_mul_f32 v[42:43], v[16:17], v[16:17]
    v_pk_fma_f32 v[42:43], v[18:19], v[18:19], v[42:43]
    v_pk_add_f32 v[40:41], v[40:41], v[20:21]
    v_pk_fma_f32 v[42:43], v[20:21], v[20:21], v[42:43]
    v_pk_add_f32 v[40:41], v[40:41], v[22:23]
    v_pk_fma_f32 v[42:43], v[22:23], v[22:23], v[42:43]
    v_pk_add_f32 v[40:41], v[40:41], v[24:25]
    v_pk_fma_f32 v[42:43], v[24:25], v[24:25], v[42:43]
    v_pk_add_f32 v[40:41], v[40:41], v[26:27]
    v_pk_fma_f32 v[42:43], v[26:27], v[26:27], v[42:43]
    v_pk_add_f32 v[40:41], v[40:41], v[28:29]
    v_pk_fma_f32 v[42:43], v[28:29], v[28:29], v[42:43]
    v_pk_add_f32 v[40:41], v[40:41], v[30:31]
    v_pk_fma_f32 v[42:43], v[30:31], v[30:31], v[42:43]
    v_add_f32 v40, v40, v41
    v_add_f32 v41, v42, v43
    s_nop 1
    v_permlane32_swap_b32 v40, v41
    v_add_f32 v40, v40, v41
    buffer_store_dword v40, v6, s[8:11], s46 offen sc1
    s_lshl_b32 s53, s3, 13
    s_add_u32 s53, s53, s23
    s_lshl_b32 s42, s28, 7
    s_add_u32 s42, s42, 7618560
    s_waitcnt vmcnt(0)
    s_mov_b32 s19, 1
    s_atomic_add s19, s[4:5], s42
    buffer_load_dwordx4 a[20:23], v1, s[8:11], s61 offen offset:1024 sc1
    buffer_load_dwordx4 a[16:19], v1, s[8:11], s61 offen offset:0 sc1
    buffer_load_dwordx4 a[0:3], v1, s[8:11], s25 offen offset:0 sc1
    buffer_load_dwordx4 a[4:7], v1, s[8:11], s25 offen offset:1024 sc1
    buffer_load_dwordx4 a[8:11], v1, s[8:11], s25 offen offset:2048 sc1
    buffer_load_dwordx4 a[12:15], v1, s[8:11], s25 offen offset:3072 sc1
    s_add_u32 m0, s27, 98304
    s_add_u32 s40, s53, 98304
    buffer_load_dwordx4 v1, s[8:11], s40 offen offset:0 sc1 lds
    buffer_load_dwordx4 v1, s[8:11], s40 offen offset:1024 sc1 lds
    buffer_load_dwordx4 v1, s[8:11], s40 offen offset:2048 sc1 lds
    buffer_load_dwordx4 v1, s[8:11], s40 offen offset:3072 sc1 lds
    s_add_u32 m0, s27, 102400
    s_add_u32 s40, s53, 102400
    buffer_load_dwordx4 v1, s[8:11], s40 offen offset:0 sc1 lds
    buffer_load_dwordx4 v1, s[8:11], s40 offen offset:1024 sc1 lds
    buffer_load_dwordx4 v1, s[8:11], s40 offen offset:2048 sc1 lds
    buffer_load_dwordx4 v1, s[8:11], s40 offen offset:3072 sc1 lds
    s_lshl_b32 s42, s18, 7
    s_add_u32 s52, s42, 7618560
    s_add_u32 s47, s20, 11075584
    s_mul_i32 s42, s18, 112
    s_mul_i32 s46, s17, 7
    s_add_u32 s42, s42, s46
    s_lshl_b32 s42, s42, 10
    s_add_u32 s34, s42, 23789568
    s_add_u32 s35, s34, 4096
    s_lshl_b32 s42, s18, 2
    s_lshr_b32 s43, s17, 2
    s_add_u32 s42, s42, s43
    s_lshl_b32 s42, s42, 7
    s_add_u32 s49, s42, 7643136
    s_and_b32 s42, s30, -2
    s_lshl_b32 s42, s42, 2
    s_add_u32 s42, s42, s3
    s_lshl_b32 s42, s42, 7
    s_add_u32 s48, s42, 7643136
    s_add_u32 s37, s48, 512
    s_mul_i32 s50, s32, 112
    s_mul_i32 s43, s3, 28
    s_add_u32 s50, s50, s43
    s_lshl_b32 s50, s50, 10
    s_add_u32 s50, s50, 23789568
    s_mul_i32 s51, s33, 112
    s_mul_i32 s43, s3, 28
    s_add_u32 s51, s51, s43
    s_lshl_b32 s51, s51, 10
    s_add_u32 s51, s51, 23789568
    s_lshl_b32 s36, s30, 15
    s_lshl_b32 s43, s31, 11
    s_add_u32 s36, s36, s43
    s_add_u32 s36, s36, 11075584
    s_add_u32 s46, s23, s26
    ds_read_b128 v[64:67], v1 offset:0
    ds_read_b128 v[68:71], v1 offset:1024
    ds_read_b128 v[72:75], v1 offset:32768
    ds_read_b128 v[76:79], v1 offset:33792
    ds_read_b128 v[80:83], v2 offset:0
    ds_read_b128 v[84:87], v2 offset:1024
    ds_read_b128 v[88:91], v1 offset:2048
    s_mov_b32 s54, 0
    s_atomic_add s54, s[4:5], s52 glc
    s_waitcnt lgkmcnt(0)
    s_bitcmp1_b32 s54, 4
    s_cbranch_scc1 L_ok_16
    s_mov_b32 s41, 65536
L_spin_15:
    s_mov_b32 s54, 0
    s_atomic_add s54, s[4:5], s52 glc
    s_waitcnt lgkmcnt(0)
    s_bitcmp1_b32 s54, 4
    s_cbranch_scc1 L_ok_16
    s_sub_u32 s41, s41, 1
    s_cbranch_scc0 L_spin_15
L_ok_16:
    buffer_load_dwordx4 v[128:131], v1, s[8:11], s47 offen offset:0 sc1
    buffer_load_dwordx4 v[132:135], v1, s[8:11], s47 offen offset:1024 sc1
    buffer_load_dwordx4 v[136:139], v1, s[8:11], s47 offen offset:2048 sc1
    buffer_load_dwordx4 v[140:143], v1, s[8:11], s47 offen offset:3072 sc1
    s_add_u32 s39, s47, 4096
    buffer_load_dwordx4 v[144:147], v1, s[8:11], s39 offen offset:0 sc1
    buffer_load_dwordx4 v[148:151], v1, s[8:11], s39 offen offset:1024 sc1
    buffer_load_dwordx4 v[152:155], v1, s[8:11], s39 offen offset:2048 sc1
    buffer_load_dwordx4 v[156:159], v1, s[8:11], s39 offen offset:3072 sc1
    s_add_u32 s39, s47, 8192
    buffer_load_dwordx4 v[160:163], v1, s[8:11], s39 offen offset:0 sc1
    buffer_load_dwordx4 v[164:167], v1, s[8:11], s39 offen offset:1024 sc1
    buffer_load_dwordx4 v[168:171], v1, s[8:11], s39 offen offset:2048 sc1
    buffer_load_dwordx4 v[172:175], v1, s[8:11], s39 offen offset:3072 sc1
    s_add_u32 s39, s47, 12288
    buffer_load_dwordx4 v[176:179], v1, s[8:11], s39 offen offset:0 sc1
    buffer_load_dwordx4 v[180:183], v1, s[8:11], s39 offen offset:1024 sc1
    s_waitcnt vmcnt(13)
    v_mfma_f32_16x16x32_bf16 v[16:19], v[64:67], v[128:131], 0
    ds_read_b128 v[92:95], v1 offset:3072
    s_waitcnt vmcnt(12)
    v_mfma_f32_16x16x32_bf16 v[20:23], v[64:67], v[132:135], 0
    buffer_load_dwordx4 v[184:187], v1, s[8:11], s39 offen offset:2048 sc1
    v_mfma_f32_16x16x32_bf16 v[28:31], v[68:71], v[132:135], 0
    ds_read_b128 v[64:67], v1 offset:34816
    v_mfma_f32_16x16x32_bf16 v[24:27], v[68:71], v[128:131], 0
    v_mfma_f32_16x16x32_bf16 v[32:35], v[72:75], v[128:131], 0
    ds_read_b128 v[68:71], v1 offset:35840
    v_mfma_f32_16x16x32_bf16 v[36:39], v[72:75], v[132:135], 0
    v_mfma_f32_16x16x32_bf16 v[44:47], v[76:79], v[132:135], 0
    ds_read_b128 v[72:75], v2 offset:2048
    v_mfma_f32_16x16x32_bf16 v[40:43], v[76:79], v[128:131], 0
    buffer_load_dwordx4 v[188:191], v1, s[8:11], s39 offen offset:3072 sc1
    v_mfma_f32_16x16x32_bf16 v[48:51], v[80:83], v[128:131], 0
    ds_read_b128 v[76:79], v2 offset:3072
    v_mfma_f32_16x16x32_bf16 v[52:55], v[80:83], v[132:135], 0
    s_add_u32 s42, s21, 8192000
    buffer_load_dwordx4 v[96:99], v1, s[8:11], s42 offen offset:0 sc1
    buffer_load_dwordx4 v[100:103], v1, s[8:11], s42 offen offset:1024 sc1
    buffer_load_dwordx4 v[104:107], v1, s[8:11], s42 offen offset:2048 sc1
    buffer_load_dwordx4 v[108:111], v1, s[8:11], s42 offen offset:3072 sc1
    v_mfma_f32_16x16x32_bf16 v[60:63], v[84:87], v[132:135], 0
    ds_read_b128 v[80:83], v1 offset:4096
    s_waitcnt lgkmcnt(5)
    v_mfma_f32_16x16x32_bf16 v[56:59], v[84:87], v[128:131], 0
    s_waitcnt vmcnt(17)
    v_mfma_f32_16x16x32_bf16 v[16:19], v[88:91], v[136:139], v[16:19]
    ds_read_b128 v[84:87], v1 offset:5120
    s_waitcnt vmcnt(16)
    v_mfma_f32_16x16x32_bf16 v[20:23], v[88:91], v[140:143], v[20:23]
    s_add_u32 s39, s47, 16384
    buffer_load_dwordx4 v[192:195], v1, s[8:11], s39 offen offset:0 sc1
    v_mfma_f32_16x16x32_bf16 v[28:31], v[92:95], v[140:143], v[28:31]
    ds_read_b128 v[88:91], v1 offset:36864
    s_waitcnt lgkmcnt(5)
    v_mfma_f32_16x16x32_bf16 v[24:27], v[92:95], v[136:139], v[24:27]
    v_mfma_f32_16x16x32_bf16 v[32:35], v[64:67], v[136:139], v[32:35]
    ds_read_b128 v[92:95], v1 offset:37888
    v_mfma_f32_16x16x32_bf16 v[36:39], v[64:67], v[140:143], v[36:39]
    v_mfma_f32_16x16x32_bf16 v[44:47], v[68:71], v[140:143], v[44:47]
    ds_read_b128 v[64:67], v2 offset:4096
    s_waitcnt lgkmcnt(5)
    v_mfma_f32_16x16x32_bf16 v[40:43], v[68:71], v[136:139], v[40:43]
    buffer_load_dwordx4 v[196:199], v1, s[8:11], s39 offen offset:1024 sc1
    v_mfma_f32_16x16x32_bf16 v[48:51], v[72:75], v[136:139], v[48:51]
    ds_read_b128 v[68:71], v2 offset:5120
    v_mfma_f32_16x16x32_bf16 v[52:55], v[72:75], v[140:143], v[52:55]
    v_mfma_f32_16x16x32_bf16 v[60:63], v[76:79], v[140:143], v[60:63]
    ds_read_b128 v[72:75], v1 offset:6144
    s_waitcnt lgkmcnt(5)
    v_mfma_f32_16x16x32_bf16 v[56:59], v[76:79], v[136:139], v[56:59]
    s_waitcnt vmcnt(17)
    v_mfma_f32_16x16x32_bf16 v[16:19], v[80:83], v[144:147], v[16:19]
    ds_read_b128 v[76:79], v1 offset:7168
    s_waitcnt vmcnt(16)
    v_mfma_f32_16x16x32_bf16 v[20:23], v[80:83], v[148:151], v[20:23]
    buffer_load_dwordx4 v[200:203], v1, s[8:11], s39 offen offset:2048 sc1
    v_mfma_f32_16x16x32_bf16 v[28:31], v[84:87], v[148:151], v[28:31]
    ds_read_b128 v[80:83], v1 offset:38912
    s_waitcnt lgkmcnt(5)
    v_mfma_f32_16x16x32_bf16 v[24:27], v[84:87], v[144:147], v[24:27]
    v_mfma_f32_16x16x32_bf16 v[32:35], v[88:91], v[144:147], v[32:35]
    ds_read_b128 v[84:87], v1 offset:39936
    v_mfma_f32_16x16x32_bf16 v[36:39], v[88:91], v[148:151], v[36:39]
    v_mfma_f32_16x16x32_bf16 v[44:47], v[92:95], v[148:151], v[44:47]
    ds_read_b128 v[88:91], v2 offset:6144
    s_waitcnt lgkmcnt(5)
    v_mfma_f32_16x16x32_bf16 v[40:43], v[92:95], v[144:147], v[40:43]
    buffer_load_dwordx4 v[204:207], v1, s[8:11], s39 offen offset:3072 sc1
    v_mfma_f32_16x16x32_bf16 v[48:51], v[64:67], v[144:147], v[48:51]
    ds_read_b128 v[92:95], v2 offset:7168
    v_mfma_f32_16x16x32_bf16 v[52:55], v[64:67], v[148:151], v[52:55]
    v_mfma_f32_16x16x32_bf16 v[60:63], v[68:71], v[148:151], v[60:63]
    ds_read_b128 v[64:67], v1 offset:8192
    s_waitcnt lgkmcnt(5)
    v_mfma_f32_16x16x32_bf16 v[56:59], v[68:71], v[144:147], v[56:59]
    s_waitcnt vmcnt(17)
    v_mfma_f32_16x16x32_bf16 v[16:19], v[72:75], v[152:155], v[16:19]
    ds_read_b128 v[68:71], v1 offset:9216
    s_waitcnt vmcnt(16)
    v_mfma_f32_16x16x32_bf16 v[20:23], v[72:75], v[156:159], v[20:23]
    s_add_u32 s39, s47, 20480
    buffer_load_dwordx4 v[208:211], v1, s[8:11], s39 offen offset:0 sc1
    v_mfma_f32_16x16x32_bf16 v[28:31], v[76:79], v[156:159], v[28:31]
    ds_read_b128 v[72:75], v1 offset:40960
    s_waitcnt lgkmcnt(5)
    v_mfma_f32_16x16x32_bf16 v[24:27], v[76:79], v[152:155], v[24:27]
    v_mfma_f32_16x16x32_bf16 v[32:35], v[80:83], v[152:155], v[32:35]
    ds_read_b128 v[76:79], v1 offset:41984
    v_mfma_f32_16x16x32_bf16 v[36:39], v[80:83], v[156:159], v[36:39]
    v_mfma_f32_16x16x32_bf16 v[44:47], v[84:87], v[156:159], v[44:47]
    ds_read_b128 v[80:83], v2 offset:8192
    s_waitcnt lgkmcnt(5)
    v_mfma_f32_16x16x32_bf16 v[40:43], v[84:87], v[152:155], v[40:43]
    buffer_load_dwordx4 v[212:215], v1, s[8:11], s39 offen offset:1024 sc1
    v_mfma_f32_16x16x32_bf16 v[48:51], v[88:91], v[152:155], v[48:51]
    ds_read_b128 v[84:87], v2 offset:9216
    v_mfma_f32_16x16x32_bf16 v[52:55], v[88:91], v[156:159], v[52:55]
    v_mfma_f32_16x16x32_bf16 v[60:63], v[92:95], v[156:159], v[60:63]
    ds_read_b128 v[88:91], v1 offset:10240
    s_waitcnt lgkmcnt(5)
    v_mfma_f32_16x16x32_bf16 v[56:59], v[92:95], v[152:155], v[56:59]
    s_waitcnt vmcnt(17)
    v_mfma_f32_16x16x32_bf16 v[16:19], v[64:67], v[160:163], v[16:19]
    ds_read_b128 v[92:95], v1 offset:11264
    s_waitcnt vmcnt(16)
    v_mfma_f32_16x16x32_bf16 v[20:23], v[64:67], v[164:167], v[20:23]
    buffer_load_dwordx4 v[216:219], v1, s[8:11], s39 offen offset:2048 sc1
    v_and_b32 v9, 16, v1
    v_mfma_f32_16x16x32_bf16 v[28:31], v[68:71], v[164:167], v[28:31]
    ds_read_b128 v[64:67], v1 offset:43008
    s_waitcnt lgkmcnt(5)
    v_mfma_f32_16x16x32_bf16 v[24:27], v[68:71], v[160:163], v[24:27]
    v_lshlrev_b32 v9, 3, v9
    v_mfma_f32_16x16x32_bf16 v[32:35], v[72:75], v[160:163], v[32:35]
    ds_read_b128 v[68:71], v1 offset:44032
    v_bfe_u32 v8, v1, 5, 3
    v_mfma_f32_16x16x32_bf16 v[36:39], v[72:75], v[164:167], v[36:39]
    v_mfma_f32_16x16x32_bf16 v[44:47], v[76:79], v[164:167], v[44:47]
    ds_read_b128 v[72:75], v2 offset:10240
    s_waitcnt lgkmcnt(5)
    v_mfma_f32_16x16x32_bf16 v[40:43], v[76:79], v[160:163], v[40:43]
    buffer_load_dwordx4 v[220:223], v1, s[8:11], s39 offen offset:3072 sc1
    v_lshl_add_u32 v9, v8, 2, v9
    v_mfma_f32_16x16x32_bf16 v[48:51], v[80:83], v[160:163], v[48:51]
    ds_read_b128 v[76:79], v2 offset:11264
    s_waitcnt vmcnt(10)
    v_add_f32 v96, v96, v100
    v_mfma_f32_16x16x32_bf16 v[52:55], v[80:83], v[164:167], v[52:55]
    v_mfma_f32_16x16x32_bf16 v[60:63], v[84:87], v[164:167], v[60:63]
    ds_read_b128 v[80:83], v1 offset:12288
    s_waitcnt lgkmcnt(5)
    v_mfma_f32_16x16x32_bf16 v[56:59], v[84:87], v[160:163], v[56:59]
    s_waitcnt vmcnt(8)
    v_add_f32 v104, v104, v108
    v_mfma_f32_16x16x32_bf16 v[16:19], v[88:91], v[168:171], v[16:19]
    ds_read_b128 v[84:87], v1 offset:13312
    v_mfma_f32_16x16x32_bf16 v[20:23], v[88:91], v[172:175], v[20:23]
    s_add_u32 s39, s47, 24576
    buffer_load_dwordx4 v[224:227], v1, s[8:11], s39 offen offset:0 sc1
    v_add_f32 v97, v97, v101
    v_mfma_f32_16x16x32_bf16 v[28:31], v[92:95], v[172:175], v[28:31]
    ds_read_b128 v[88:91], v1 offset:45056
    s_waitcnt lgkmcnt(5)
    v_mfma_f32_16x16x32_bf16 v[24:27], v[92:95], v[168:171], v[24:27]
    v_add_f32 v105, v105, v109
    v_mfma_f32_16x16x32_bf16 v[32:35], v[64:67], v[168:171], v[32:35]
    ds_read_b128 v[92:95], v1 offset:46080
    v_add_f32 v98, v98, v102
    v_mfma_f32_16x16x32_bf16 v[36:39], v[64:67], v[172:175], v[36:39]
    v_mfma_f32_16x16x32_bf16 v[44:47], v[68:71], v[172:175], v[44:47]
    ds_read_b128 v[64:67], v2 offset:12288
    s_waitcnt lgkmcnt(5)
    v_mfma_f32_16x16x32_bf16 v[40:43], v[68:71], v[168:171], v[40:43]
    buffer_load_dwordx4 v[228:231], v1, s[8:11], s39 offen offset:1024 sc1
    v_add_f32 v106, v106, v110
    v_mfma_f32_16x16x32_bf16 v[48:51], v[72:75], v[168:171], v[48:51]
    ds_read_b128 v[68:71], v2 offset:13312
    v_add_f32 v99, v99, v103
    v_mfma_f32_16x16x32_bf16 v[52:55], v[72:75], v[172:175], v[52:55]
    v_mfma_f32_16x16x32_bf16 v[60:63], v[76:79], v[172:175], v[60:63]
    ds_read_b128 v[72:75], v1 offset:14336
    s_waitcnt lgkmcnt(5)
    v_mfma_f32_16x16x32_bf16 v[56:59], v[76:79], v[168:171], v[56:59]
    v_add_f32 v107, v107, v111
    v_mfma_f32_16x16x32_bf16 v[16:19], v[80:83], v[176:179], v[16:19]
    ds_read_b128 v[76:79], v1 offset:15360
    v_mfma_f32_16x16x32_bf16 v[20:23], v[80:83], v[180:183], v[20:23]
    buffer_load_dwordx4 v[232:235], v1, s[8:11], s39 offen offset:2048 sc1
    v_add_f32 v96, v96, v104
    v_mfma_f32_16x16x32_bf16 v[28:31], v[84:87], v[180:183], v[28:31]
    ds_read_b128 v[80:83], v1 offset:47104
    s_waitcnt lgkmcnt(5)
    v_mfma_f32_16x16x32_bf16 v[24:27], v[84:87], v[176:179], v[24:27]
    v_add_f32 v97, v97, v105
    v_mfma_f32_16x16x32_bf16 v[32:35], v[88:91], v[176:179], v[32:35]
    ds_read_b128 v[84:87], v1 offset:48128
    v_add_f32 v98, v98, v106
    v_mfma_f32_16x16x32_bf16 v[36:39], v[88:91], v[180:183], v[36:39]
    v_mfma_f32_16x16x32_bf16 v[44:47], v[92:95], v[180:183], v[44:47]
    ds_read_b128 v[88:91], v2 offset:14336
    s_waitcnt lgkmcnt(5)
    v_mfma_f32_16x16x32_bf16 v[40:43], v[92:95], v[176:179], v[40:43]
    buffer_load_dwordx4 v[236:239], v1, s[8:11], s39 offen offset:3072 sc1
    v_add_f32 v99, v99, v107
    v_mfma_f32_16x16x32_bf16 v[48:51], v[64:67], v[176:179], v[48:51]
    ds_read_b128 v[92:95], v2 offset:15360
    v_permlane32_swap_b32 v96, v98
    v_mfma_f32_16x16x32_bf16 v[52:55], v[64:67], v[180:183], v[52:55]
    v_mfma_f32_16x16x32_bf16 v[60:63], v[68:71], v[180:183], v[60:63]
    ds_read_b128 v[64:67], v1 offset:16384
    s_waitcnt lgkmcnt(5)
    v_mfma_f32_16x16x32_bf16 v[56:59], v[68:71], v[176:179], v[56:59]
    v_permlane32_swap_b32 v97, v99
    v_mfma_f32_16x16x32_bf16 v[16:19], v[72:75], v[184:187], v[16:19]
    ds_read_b128 v[68:71], v1 offset:17408
    v_mfma_f32_16x16x32_bf16 v[20:23], v[72:75], v[188:191], v[20:23]
    s_add_u32 s39, s47, 28672
    buffer_load_dwordx4 v[240:243], v1, s[8:11], s39 offen offset:0 sc1
    v_add_f32 v96, v96, v98
    v_mfma_f32_16x16x32_bf16 v[28:31], v[76:79], v[188:191], v[28:31]
    ds_read_b128 v[72:75], v1 offset:49152
    s_waitcnt lgkmcnt(5)
    v_mfma_f32_16x16x32_bf16 v[24:27], v[76:79], v[184:187], v[24:27]
    v_add_f32 v97, v97, v99
    v_mfma_f32_16x16x32_bf16 v[32:35], v[80:83], v[184:187], v[32:35]
    ds_read_b128 v[76:79], v1 offset:50176
    v_permlane16_swap_b32 v96, v97
    v_mfma_f32_16x16x32_bf16 v[36:39], v[80:83], v[188:191], v[36:39]
    v_mfma_f32_16x16x32_bf16 v[44:47], v[84:87], v[188:191], v[44:47]
    ds_read_b128 v[80:83], v2 offset:16384
    s_waitcnt lgkmcnt(5)
    v_mfma_f32_16x16x32_bf16 v[40:43], v[84:87], v[184:187], v[40:43]
    buffer_load_dwordx4 v[244:247], v1, s[8:11], s39 offen offset:1024 sc1
    v_add_f32 v96, v96, v97
    v_mfma_f32_16x16x32_bf16 v[48:51], v[88:91], v[184:187], v[48:51]
    ds_read_b128 v[84:87], v2 offset:17408
    v_mov_b32 v97, v96
    v_mfma_f32_16x16x32_bf16 v[52:55], v[88:91], v[188:191], v[52:55]
    v_mfma_f32_16x16x32_bf16 v[60:63], v[92:95], v[188:191], v[60:63]
    ds_read_b128 v[88:91], v1 offset:18432
    s_waitcnt lgkmcnt(5)
    v_mfma_f32_16x16x32_bf16 v[56:59], v[92:95], v[184:187], v[56:59]
    v_permlane16_swap_b32 v96, v97
    s_waitcnt vmcnt(13)
    v_mfma_f32_16x16x32_bf16 v[16:19], v[64:67], v[192:195], v[16:19]
    ds_read_b128 v[92:95], v1 offset:19456
    s_waitcnt vmcnt(12)
    v_mfma_f32_16x16x32_bf16 v[20:23], v[64:67], v[196:199], v[20:23]
    buffer_load_dwordx4 v[248:251], v1, s[8:11], s39 offen offset:2048 sc1
    v_mul_f32 v98, 0x3b000000, v96
    s_barrier
    v_mfma_f32_16x16x32_bf16 v[28:31], v[68:71], v[196:199], v[28:31]
    ds_read_b128 v[64:67], v1 offset:51200
    s_waitcnt lgkmcnt(5)
    v_mfma_f32_16x16x32_bf16 v[24:27], v[68:71], v[192:195], v[24:27]
    v_mul_f32 v97, 0x3b000000, v97
    v_mfma_f32_16x16x32_bf16 v[32:35], v[72:75], v[192:195], v[32:35]
    ds_read_b128 v[68:71], v1 offset:52224
    v_fma_f32 v97, -v98, v98, v97
    v_mfma_f32_16x16x32_bf16 v[36:39], v[72:75], v[196:199], v[36:39]
    v_mfma_f32_16x16x32_bf16 v[44:47], v[76:79], v[196:199], v[44:47]
    ds_read_b128 v[72:75], v2 offset:18432
    s_waitcnt lgkmcnt(5)
    v_mfma_f32_16x16x32_bf16 v[40:43], v[76:79], v[192:195], v[40:43]
    buffer_load_dwordx4 v[252:255], v1, s[8:11], s39 offen offset:3072 sc1
    v_max_f32 v97, 0, v97
    v_mfma_f32_16x16x32_bf16 v[48:51], v[80:83], v[192:195], v[48:51]
    ds_read_b128 v[76:79], v2 offset:19456
    v_add_f32 v97, 0x3727c5ac, v97
    v_mfma_f32_16x16x32_bf16 v[52:55], v[80:83], v[196:199], v[52:55]
    v_mfma_f32_16x16x32_bf16 v[60:63], v[84:87], v[196:199], v[60:63]
    ds_read_b128 v[80:83], v1 offset:20480
    s_waitcnt lgkmcnt(5)
    v_mfma_f32_16x16x32_bf16 v[56:59], v[84:87], v[192:195], v[56:59]
    v_rsq_f32 v96, v97
    s_waitcnt vmcnt(13)
    v_mfma_f32_16x16x32_bf16 v[16:19], v[88:91], v[200:203], v[16:19]
    ds_read_b128 v[84:87], v1 offset:21504
    s_waitcnt vmcnt(12)
    v_mfma_f32_16x16x32_bf16 v[20:23], v[88:91], v[204:207], v[20:23]
    ds_bpermute_b32 v10, v9, v96
    s_add_u32 m0, s27, 106496
    s_add_u32 s40, s53, 131072
    buffer_load_dwordx4 v1, s[8:11], s40 offen offset:0 sc1 lds
    v_mfma_f32_16x16x32_bf16 v[28:31], v[92:95], v[204:207], v[28:31]
    ds_read_b128 v[88:91], v1 offset:53248
    s_waitcnt lgkmcnt(6)
    v_mfma_f32_16x16x32_bf16 v[24:27], v[92:95], v[200:203], v[24:27]
    ds_bpermute_b32 v11, v9, v96 offset:32
    v_mfma_f32_16x16x32_bf16 v[32:35], v[64:67], v[200:203], v[32:35]
    ds_read_b128 v[92:95], v1 offset:54272
    v_mfma_f32_16x16x32_bf16 v[36:39], v[64:67], v[204:207], v[36:39]
    ds_bpermute_b32 v12, v9, v98
    buffer_load_dwordx4 v1, s[8:11], s40 offen offset:1024 sc1 lds
    v_mfma_f32_16x16x32_bf16 v[44:47], v[68:71], v[204:207], v[44:47]
    ds_read_b128 v[64:67], v2 offset:20480
    s_waitcnt lgkmcnt(8)
    v_mfma_f32_16x16x32_bf16 v[40:43], v[68:71], v[200:203], v[40:43]
    ds_bpermute_b32 v13, v9, v98 offset:32
    v_mfma_f32_16x16x32_bf16 v[48:51], v[72:75], v[200:203], v[48:51]
    ds_read_b128 v[68:71], v2 offset:21504
    v_mfma_f32_16x16x32_bf16 v[52:55], v[72:75], v[204:207], v[52:55]
    buffer_load_dwordx4 v1, s[8:11], s40 offen offset:2048 sc1 lds
    v_mfma_f32_16x16x32_bf16 v[60:63], v[76:79], v[204:207], v[60:63]
    ds_read_b128 v[72:75], v1 offset:22528
    s_waitcnt lgkmcnt(9)
    v_mfma_f32_16x16x32_bf16 v[56:59], v[76:79], v[200:203], v[56:59]
    s_waitcnt vmcnt(14)
    v_mfma_f32_16x16x32_bf16 v[16:19], v[80:83], v[208:211], v[16:19]
    ds_read_b128 v[76:79], v1 offset:23552
    s_waitcnt vmcnt(13)
    v_mfma_f32_16x16x32_bf16 v[20:23], v[80:83], v[212:215], v[20:23]
    buffer_load_dwordx4 v1, s[8:11], s40 offen offset:3072 sc1 lds
    v_mfma_f32_16x16x32_bf16 v[28:31], v[84:87], v[212:215], v[28:31]
    ds_read_b128 v[80:83], v1 offset:55296
    s_waitcnt lgkmcnt(7)
    v_mfma_f32_16x16x32_bf16 v[24:27], v[84:87], v[208:211], v[24:27]
    v_mfma_f32_16x16x32_bf16 v[32:35], v[88:91], v[208:211], v[32:35]
    ds_read_b128 v[84:87], v1 offset:56320
    v_mul_f32 v10, v10, v10
    v_mfma_f32_16x16x32_bf16 v[36:39], v[88:91], v[212:215], v[36:39]
    v_mul_f32 v11, v11, v11
    s_add_u32 m0, s27, 110592
    s_add_u32 s40, s53, 135168
    buffer_load_dwordx4 v1, s[8:11], s40 offen offset:0 sc1 lds
    v_mfma_f32_16x16x32_bf16 v[44:47], v[92:95], v[212:215], v[44:47]
    ds_read_b128 v[88:91], v2 offset:22528
    s_waitcnt lgkmcnt(5)
    v_mfma_f32_16x16x32_bf16 v[40:43], v[92:95], v[208:211], v[40:43]
    s_mov_b64 s[44:45], 0xffff
    v_mfma_f32_16x16x32_bf16 v[48:51], v[64:67], v[208:211], v[48:51]
    ds_read_b128 v[92:95], v2 offset:23552
    v_mfma_f32_16x16x32_bf16 v[52:55], v[64:67], v[212:215], v[52:55]
    s_mov_b64 s[6:7], 0xffff0000
    v_cvt_pk_bf16_f32 v14, v12, v12
    buffer_load_dwordx4 v1, s[8:11], s40 offen offset:1024 sc1 lds
    v_mfma_f32_16x16x32_bf16 v[60:63], v[68:71], v[212:215], v[60:63]
    ds_read_b128 v[64:67], v1 offset:24576
    s_waitcnt lgkmcnt(5)
    v_mfma_f32_16x16x32_bf16 v[56:59], v[68:71], v[208:211], v[56:59]
    v_lshlrev_b32 v15, 16, v14
    s_waitcnt vmcnt(15)
    v_mfma_f32_16x16x32_bf16 v[16:19], v[72:75], v[216:219], v[16:19]
    ds_read_b128 v[68:71], v1 offset:25600
    v_sub_f32 v15, v12, v15
    s_waitcnt vmcnt(14)
    v_mfma_f32_16x16x32_bf16 v[20:23], v[72:75], v[220:223], v[20:23]
    v_cvt_pk_bf16_f32 v15, v15, 0
    buffer_load_dwordx4 v1, s[8:11], s40 offen offset:2048 sc1 lds
    v_mfma_f32_16x16x32_bf16 v[28:31], v[76:79], v[220:223], v[28:31]
    ds_read_b128 v[72:75], v1 offset:57344
    s_waitcnt lgkmcnt(5)
    v_mfma_f32_16x16x32_bf16 v[24:27], v[76:79], v[216:219], v[24:27]
    v_cndmask_b32 v120, 0, v14, s[44:45]
    v_mfma_f32_16x16x32_bf16 v[32:35], v[80:83], v[216:219], v[32:35]
    ds_read_b128 v[76:79], v1 offset:58368
    v_cndmask_b32 v121, 0, v15, s[44:45]
    v_mfma_f32_16x16x32_bf16 v[36:39], v[80:83], v[220:223], v[36:39]
    v_cndmask_b32 v124, 0, v14, s[6:7]
    buffer_load_dwordx4 v1, s[8:11], s40 offen offset:3072 sc1 lds
    v_mfma_f32_16x16x32_bf16 v[44:47], v[84:87], v[220:223], v[44:47]
    ds_read_b128 v[80:83], v2 offset:24576
    s_waitcnt lgkmcnt(5)
    v_mfma_f32_16x16x32_bf16 v[40:43], v[84:87], v[216:219], v[40:43]
    v_cndmask_b32 v125, 0, v15, s[6:7]
    v_mfma_f32_16x16x32_bf16 v[48:51], v[88:91], v[216:219], v[48:51]
    ds_read_b128 v[84:87], v2 offset:25600
    v_cvt_pk_bf16_f32 v14, v13, v13
    v_mfma_f32_16x16x32_bf16 v[52:55], v[88:91], v[220:223], v[52:55]
    v_lshlrev_b32 v15, 16, v14
    s_add_u32 m0, s26, 0
    s_add_u32 s40, s46, 163840
    buffer_load_dwordx4 v1, s[8:11], s40 offen offset:0 sc1 lds
    v_mfma_f32_16x16x32_bf16 v[60:63], v[92:95], v[220:223], v[60:63]
    ds_read_b128 v[88:91], v1 offset:26624
    s_waitcnt lgkmcnt(5)
    v_mfma_f32_16x16x32_bf16 v[56:59], v[92:95], v[216:219], v[56:59]
    v_sub_f32 v15, v13, v15
    s_waitcnt vmcnt(16)
    v_mfma_f32_16x16x32_bf16 v[16:19], v[64:67], v[224:227], v[16:19]
    ds_read_b128 v[92:95], v1 offset:27648
    v_cvt_pk_bf16_f32 v15, v15, 0
    s_waitcnt vmcnt(15)
    v_mfma_f32_16x16x32_bf16 v[20:23], v[64:67], v[228:231], v[20:23]
    v_cndmask_b32 v122, 0, v14, s[44:45]
    buffer_load_dwordx4 v1, s[8:11], s40 offen offset:1024 sc1 lds
    v_mfma_f32_16x16x32_bf16 v[28:31], v[68:71], v[228:231], v[28:31]
    ds_read_b128 v[64:67], v1 offset:59392
    s_waitcnt lgkmcnt(5)
    v_mfma_f32_16x16x32_bf16 v[24:27], v[68:71], v[224:227], v[24:27]
    v_cndmask_b32 v123, 0, v15, s[44:45]
    v_mfma_f32_16x16x32_bf16 v[32:35], v[72:75], v[224:227], v[32:35]
    ds_read_b128 v[68:71], v1 offset:60416
    v_cndmask_b32 v126, 0, v14, s[6:7]
    v_mfma_f32_16x16x32_bf16 v[36:39], v[72:75], v[228:231], v[36:39]
    v_cndmask_b32 v127, 0, v15, s[6:7]
    buffer_load_dwordx4 v1, s[8:11], s40 offen offset:2048 sc1 lds
    v_mfma_f32_16x16x32_bf16 v[44:47], v[76:79], v[228:231], v[44:47]
    ds_read_b128 v[72:75], v2 offset:26624
    s_waitcnt lgkmcnt(5)
    v_mfma_f32_16x16x32_bf16 v[40:43], v[76:79], v[224:227], v[40:43]
    v_mov_b32 v14, 0
    v_mfma_f32_16x16x32_bf16 v[48:51], v[80:83], v[224:227], v[48:51]
    ds_read_b128 v[76:79], v2 offset:27648
    v_mov_b32 v15, 0
    v_mfma_f32_16x16x32_bf16 v[52:55], v[80:83], v[228:231], v[52:55]
    buffer_load_dwordx4 v1, s[8:11], s40 offen offset:3072 sc1 lds
    v_mfma_f32_16x16x32_bf16 v[60:63], v[84:87], v[228:231], v[60:63]
    ds_read_b128 v[80:83], v1 offset:28672
    s_waitcnt lgkmcnt(5)
    v_mfma_f32_16x16x32_bf16 v[56:59], v[84:87], v[224:227], v[56:59]
    s_waitcnt vmcnt(17)
    v_mfma_f32_16x16x32_bf16 v[16:19], v[88:91], v[232:235], v[16:19]
    ds_read_b128 v[84:87], v1 offset:29696
    s_waitcnt vmcnt(16)
    v_mfma_f32_16x16x32_bf16 v[20:23], v[88:91], v[236:239], v[20:23]
    s_add_u32 m0, s26, 32768
    s_add_u32 s40, s46, 180224
    buffer_load_dwordx4 v1, s[8:11], s40 offen offset:0 sc1 lds
    v_mfma_f32_16x16x32_bf16 v[28:31], v[92:95], v[236:239], v[28:31]
    ds_read_b128 v[88:91], v1 offset:61440
    s_waitcnt lgkmcnt(5)
    v_mfma_f32_16x16x32_bf16 v[24:27], v[92:95], v[232:235], v[24:27]
    v_mfma_f32_16x16x32_bf16 v[32:35], v[64:67], v[232:235], v[32:35]
    ds_read_b128 v[92:95], v1 offset:62464
    v_accvgpr_read_b32 v12, a224
    v_mfma_f32_16x16x32_bf16 v[36:39], v[64:67], v[236:239], v[36:39]
    v_accvgpr_read_b32 v13, a224
    buffer_load_dwordx4 v1, s[8:11], s40 offen offset:1024 sc1 lds
    v_mfma_f32_16x16x32_bf16 v[44:47], v[68:71], v[236:239], v[44:47]
    ds_read_b128 v[64:67], v2 offset:28672
    s_waitcnt lgkmcnt(5)
    v_mfma_f32_16x16x32_bf16 v[40:43], v[68:71], v[232:235], v[40:43]
    v_mfma_f32_16x16x32_bf16 v[16:19], v[12:15], v[120:123], v[16:19]
    v_mfma_f32_16x16x32_bf16 v[20:23], v[12:15], v[122:125], v[20:23]
    v_mfma_f32_16x16x32_bf16 v[48:51], v[72:75], v[232:235], v[48:51]
    ds_read_b128 v[68:71], v2 offset:29696
    v_mfma_f32_16x16x32_bf16 v[52:55], v[72:75], v[236:239], v[52:55]
    v_mfma_f32_16x16x32_bf16 v[24:27], v[12:15], v[124:127], v[24:27]
    v_mfma_f32_16x16x32_bf16 v[28:31], v[12:15], v[126:129], v[28:31]
    buffer_load_dwordx4 v1, s[8:11], s40 offen offset:2048 sc1 lds
    v_mfma_f32_16x16x32_bf16 v[60:63], v[76:79], v[236:239], v[60:63]
    ds_read_b128 v[72:75], v1 offset:30720
    s_waitcnt lgkmcnt(5)
    v_mfma_f32_16x16x32_bf16 v[56:59], v[76:79], v[232:235], v[56:59]
    s_waitcnt vmcnt(18)
    v_mfma_f32_16x16x32_bf16 v[16:19], v[80:83], v[240:243], v[16:19]
    ds_read_b128 v[76:79], v1 offset:31744
    s_waitcnt vmcnt(17)
    v_mfma_f32_16x16x32_bf16 v[20:23], v[80:83], v[244:247], v[20:23]
    buffer_load_dwordx4 v1, s[8:11], s40 offen offset:3072 sc1 lds
    v_mfma_f32_16x16x32_bf16 v[28:31], v[84:87], v[244:247], v[28:31]
    ds_read_b128 v[80:83], v1 offset:63488
    s_waitcnt lgkmcnt(5)
    v_mfma_f32_16x16x32_bf16 v[24:27], v[84:87], v[240:243], v[24:27]
    v_accvgpr_read_b32 v12, a225
    v_accvgpr_read_b32 v13, a225
    v_mfma_f32_16x16x32_bf16 v[32:35], v[88:91], v[240:243], v[32:35]
    ds_read_b128 v[84:87], v1 offset:64512
    v_mfma_f32_16x16x32_bf16 v[36:39], v[88:91], v[244:247], v[36:39]
    v_mfma_f32_16x16x32_bf16 v[32:35], v[12:15], v[120:123], v[32:35]
    v_mfma_f32_16x16x32_bf16 v[36:39], v[12:15], v[122:125], v[36:39]
    s_add_u32 m0, s26, 65536
    s_add_u32 s40, s46, 196608
    buffer_load_dwordx4 v1, s[8:11], s40 offen offset:0 sc1 lds
    v_mfma_f32_16x16x32_bf16 v[44:47], v[92:95], v[244:247], v[44:47]
    ds_read_b128 v[88:91], v2 offset:30720
    s_waitcnt lgkmcnt(5)
    v_mfma_f32_16x16x32_bf16 v[40:43], v[92:95], v[240:243], v[40:43]
    v_mfma_f32_16x16x32_bf16 v[40:43], v[12:15], v[124:127], v[40:43]
    v_mfma_f32_16x16x32_bf16 v[44:47], v[12:15], v[126:129], v[44:47]
    v_mfma_f32_16x16x32_bf16 v[48:51], v[64:67], v[240:243], v[48:51]
    ds_read_b128 v[92:95], v2 offset:31744
    v_mfma_f32_16x16x32_bf16 v[52:55], v[64:67], v[244:247], v[52:55]
    buffer_load_dwordx4 v1, s[8:11], s40 offen offset:1024 sc1 lds
    v_mfma_f32_16x16x32_bf16 v[60:63], v[68:71], v[244:247], v[60:63]
    ds_read_b128 v[64:67], v2 offset:32768
    s_waitcnt lgkmcnt(5)
    v_mfma_f32_16x16x32_bf16 v[56:59], v[68:71], v[240:243], v[56:59]
    s_waitcnt vmcnt(19)
    v_mfma_f32_16x16x32_bf16 v[16:19], v[72:75], v[248:251], v[16:19]
    ds_read_b128 v[68:71], v2 offset:33792
    v_accvgpr_read_b32 v12, a226
    s_waitcnt vmcnt(18)
    v_mfma_f32_16x16x32_bf16 v[20:23], v[72:75], v[252:255], v[20:23]
    v_accvgpr_read_b32 v13, a226
    buffer_load_dwordx4 v1, s[8:11], s40 offen offset:2048 sc1 lds
    v_mfma_f32_16x16x32_bf16 v[28:31], v[76:79], v[252:255], v[28:31]
    ds_read_b128 v[72:75], v2 offset:34816
    s_waitcnt lgkmcnt(5)
    v_mfma_f32_16x16x32_bf16 v[24:27], v[76:79], v[248:251], v[24:27]
    v_mfma_f32_16x16x32_bf16 v[48:51], v[12:15], v[120:123], v[48:51]
    v_mfma_f32_16x16x32_bf16 v[52:55], v[12:15], v[122:125], v[52:55]
    v_mfma_f32_16x16x32_bf16 v[32:35], v[80:83], v[248:251], v[32:35]
    ds_read_b128 v[76:79], v2 offset:35840
    v_mfma_f32_16x16x32_bf16 v[36:39], v[80:83], v[252:255], v[36:39]
    v_mfma_f32_16x16x32_bf16 v[56:59], v[12:15], v[124:127], v[56:59]
    v_mfma_f32_16x16x32_bf16 v[60:63], v[12:15], v[126:129], v[60:63]
    buffer_load_dwordx4 v1, s[8:11], s40 offen offset:3072 sc1 lds
    v_mfma_f32_16x16x32_bf16 v[44:47], v[84:87], v[252:255], v[44:47]
    ds_read_b128 v[80:83], v2 offset:36864
    s_waitcnt lgkmcnt(5)
    v_mfma_f32_16x16x32_bf16 v[40:43], v[84:87], v[248:251], v[40:43]
    v_mfma_f32_16x16x32_bf16 v[48:51], v[88:91], v[248:251], v[48:51]
    ds_read_b128 v[84:87], v2 offset:37888
    v_mfma_f32_16x16x32_bf16 v[52:55], v[88:91], v[252:255], v[52:55]
    v_mfma_f32_16x16x32_bf16 v[60:63], v[92:95], v[252:255], v[60:63]
    ds_read_b128 v[88:91], v2 offset:38912
    s_waitcnt lgkmcnt(5)
    v_mfma_f32_16x16x32_bf16 v[56:59], v[92:95], v[248:251], v[56:59]
    v_mfma_f32_16x16x32_bf16 v[104:107], v[64:67], v[128:131], 0
    ds_read_b128 v[92:95], v2 offset:39936
    v_mfma_f32_16x16x32_bf16 v[108:111], v[64:67], v[132:135], 0
    v_mfma_f32_16x16x32_bf16 v[116:119], v[68:71], v[132:135], 0
    ds_read_b128 v[64:67], v2 offset:49152
    s_waitcnt lgkmcnt(5)
    v_mfma_f32_16x16x32_bf16 v[112:115], v[68:71], v[128:131], 0
    v_mul_f32 v16, v16, v10
    v_mul_f32 v17, v17, v10
    v_mfma_f32_16x16x32_bf16 v[104:107], v[72:75], v[136:139], v[104:107]
    ds_read_b128 v[68:71], v2 offset:50176
    v_mul_f32 v16, v16, v24
    v_mfma_f32_16x16x32_bf16 v[108:111], v[72:75], v[140:143], v[108:111]
    v_mul_f32 v17, v17, v25
    v_mfma_f32_16x16x32_bf16 v[116:119], v[76:79], v[140:143], v[116:119]
    ds_read_b128 v[72:75], v2 offset:51200
    s_waitcnt lgkmcnt(5)
    v_mfma_f32_16x16x32_bf16 v[112:115], v[76:79], v[136:139], v[112:115]
    v_cvt_pk_bf16_f32 v96, v16, v17
    v_mul_f32 v18, v18, v10
    v_mfma_f32_16x16x32_bf16 v[104:107], v[80:83], v[144:147], v[104:107]
    ds_read_b128 v[76:79], v2 offset:52224
    v_mul_f32 v19, v19, v10
    v_mfma_f32_16x16x32_bf16 v[108:111], v[80:83], v[148:151], v[108:111]
    v_mul_f32 v18, v18, v26
    v_mfma_f32_16x16x32_bf16 v[116:119], v[84:87], v[148:151], v[116:119]
    ds_read_b128 v[80:83], v2 offset:53248
    s_waitcnt lgkmcnt(5)
    v_mfma_f32_16x16x32_bf16 v[112:115], v[84:87], v[144:147], v[112:115]
    s_waitcnt vmcnt(12)
    s_barrier
    v_mul_f32 v19, v19, v27
    v_cvt_pk_bf16_f32 v97, v18, v19
    v_mfma_f32_16x16x32_bf16 v[104:107], v[88:91], v[152:155], v[104:107]
    ds_read_b128 v[84:87], v2 offset:54272
    v_mfma_f32_16x16x32_bf16 v[108:111], v[88:91], v[156:159], v[108:111]
    s_add_u32 m0, s26, 16384
    s_add_u32 s40, s46, 212992
    buffer_load_dwordx4 v1, s[8:11], s40 offen offset:0 sc1 lds
    v_mfma_f32_16x16x32_bf16 v[116:119], v[92:95], v[156:159], v[116:119]
    ds_read_b128 v[88:91], v2 offset:55296
    s_waitcnt lgkmcnt(5)
    v_mfma_f32_16x16x32_bf16 v[112:115], v[92:95], v[152:155], v[112:115]
    buffer_load_dwordx4 v1, s[8:11], s40 offen offset:1024 sc1 lds
    v_mfma_f32_16x16x32_bf16 v[104:107], v[64:67], v[160:163], v[104:107]
    ds_read_b128 v[92:95], v2 offset:56320
    v_mfma_f32_16x16x32_bf16 v[108:111], v[64:67], v[164:167], v[108:111]
    buffer_load_dwordx4 v1, s[8:11], s40 offen offset:2048 sc1 lds
    v_mul_f32 v20, v20, v11
    v_mul_f32 v21, v21, v11
    v_mfma_f32_16x16x32_bf16 v[116:119], v[68:71], v[164:167], v[116:119]
    ds_read_b128 v[64:67], v3 offset:0
    s_waitcnt lgkmcnt(5)
    v_mfma_f32_16x16x32_bf16 v[112:115], v[68:71], v[160:163], v[112:115]
    buffer_load_dwordx4 v1, s[8:11], s40 offen offset:3072 sc1 lds
    v_mul_f32 v20, v20, v28
    v_mul_f32 v21, v21, v29
    v_mfma_f32_16x16x32_bf16 v[104:107], v[72:75], v[168:171], v[104:107]
    ds_read_b128 v[68:71], v3 offset:1024
    v_cvt_pk_bf16_f32 v98, v20, v21
    v_mfma_f32_16x16x32_bf16 v[108:111], v[72:75], v[172:175], v[108:111]
    v_mul_f32 v22, v22, v11
    v_mfma_f32_16x16x32_bf16 v[116:119], v[76:79], v[172:175], v[116:119]
    ds_read_b128 v[72:75], v3 offset:2048
    s_waitcnt lgkmcnt(5)
    v_mfma_f32_16x16x32_bf16 v[112:115], v[76:79], v[168:171], v[112:115]
    v_mul_f32 v23, v23, v11
    v_mul_f32 v22, v22, v30
    v_mfma_f32_16x16x32_bf16 v[104:107], v[80:83], v[176:179], v[104:107]
    ds_read_b128 v[76:79], v3 offset:3072
    v_mfma_f32_16x16x32_bf16 v[108:111], v[80:83], v[180:183], v[108:111]
    s_add_u32 s61, s25, 20480
    buffer_load_dwordx4 a[88:91], v1, s[8:11], s61 offen offset:2048 sc1
    v_mul_f32 v23, v23, v31
    v_cvt_pk_bf16_f32 v99, v22, v23
    v_mfma_f32_16x16x32_bf16 v[116:119], v[84:87], v[180:183], v[116:119]
    ds_read_b128 v[80:83], v3 offset:4096
    s_waitcnt lgkmcnt(5)
    v_mfma_f32_16x16x32_bf16 v[112:115], v[84:87], v[176:179], v[112:115]
    v_permlane16_swap_b32 v96, v98
    v_permlane16_swap_b32 v97, v99
    v_mfma_f32_16x16x32_bf16 v[104:107], v[88:91], v[184:187], v[104:107]
    ds_read_b128 v[84:87], v3 offset:5120
    v_mfma_f32_16x16x32_bf16 v[108:111], v[88:91], v[188:191], v[108:111]
    buffer_load_dwordx4 a[92:95], v1, s[8:11], s61 offen offset:3072 sc1
    buffer_store_dwordx4 v[96:99], v1, s[8:11], s34 offen offset:0 sc1
    v_mul_f32 v32, v32, v10
    v_mfma_f32_16x16x32_bf16 v[116:119], v[92:95], v[188:191], v[116:119]
    ds_read_b128 v[88:91], v3 offset:6144
    s_waitcnt lgkmcnt(5)
    v_mfma_f32_16x16x32_bf16 v[112:115], v[92:95], v[184:187], v[112:115]
    v_mul_f32 v33, v33, v10
    v_mul_f32 v32, v32, v40
    v_mfma_f32_16x16x32_bf16 v[104:107], v[64:67], v[192:195], v[104:107]
    ds_read_b128 v[92:95], v3 offset:7168
    v_mul_f32 v33, v33, v41
    v_mfma_f32_16x16x32_bf16 v[108:111], v[64:67], v[196:199], v[108:111]
    v_cvt_pk_bf16_f32 v100, v32, v33
    v_mfma_f32_16x16x32_bf16 v[116:119], v[68:71], v[196:199], v[116:119]
    ds_read_b128 v[64:67], v3 offset:16384
    s_waitcnt lgkmcnt(5)
    v_mfma_f32_16x16x32_bf16 v[112:115], v[68:71], v[192:195], v[112:115]
    s_add_u32 s61, s25, 24576
    buffer_load_dwordx4 a[96:99], v1, s[8:11], s61 offen offset:0 sc1
    v_mul_f32 v34, v34, v10
    v_mul_f32 v35, v35, v10
    v_mfma_f32_16x16x32_bf16 v[104:107], v[72:75], v[200:203], v[104:107]
    ds_read_b128 v[68:71], v3 offset:17408
    v_mul_f32 v34, v34, v42
    v_mfma_f32_16x16x32_bf16 v[108:111], v[72:75], v[204:207], v[108:111]
    v_mul_f32 v35, v35, v43
    v_mfma_f32_16x16x32_bf16 v[116:119], v[76:79], v[204:207], v[116:119]
    ds_read_b128 v[72:75], v3 offset:18432
    s_waitcnt lgkmcnt(5)
    v_mfma_f32_16x16x32_bf16 v[112:115], v[76:79], v[200:203], v[112:115]
    buffer_load_dwordx4 a[100:103], v1, s[8:11], s61 offen offset:1024 sc1
    v_cvt_pk_bf16_f32 v101, v34, v35
    v_mul_f32 v36, v36, v11
    v_mfma_f32_16x16x32_bf16 v[104:107], v[80:83], v[208:211], v[104:107]
    ds_read_b128 v[76:79], v3 offset:19456
    v_mul_f32 v37, v37, v11
    v_mfma_f32_16x16x32_bf16 v[108:111], v[80:83], v[212:215], v[108:111]
    v_mul_f32 v36, v36, v44
    v_mfma_f32_16x16x32_bf16 v[116:119], v[84:87], v[212:215], v[116:119]
    ds_read_b128 v[80:83], v3 offset:20480
    s_waitcnt lgkmcnt(5)
    v_mfma_f32_16x16x32_bf16 v[112:115], v[84:87], v[208:211], v[112:115]
    v_mul_f32 v37, v37, v45
    v_cvt_pk_bf16_f32 v102, v36, v37
    v_mfma_f32_16x16x32_bf16 v[104:107], v[88:91], v[216:219], v[104:107]
    ds_read_b128 v[84:87], v3 offset:21504
    v_mfma_f32_16x16x32_bf16 v[108:111], v[88:91], v[220:223], v[108:111]
    buffer_load_dwordx4 a[104:107], v1, s[8:11], s61 offen offset:2048 sc1
    v_mul_f32 v38, v38, v11
    v_mul_f32 v39, v39, v11
    v_mfma_f32_16x16x32_bf16 v[116:119], v[92:95], v[220:223], v[116:119]
    ds_read_b128 v[88:91], v3 offset:22528
    s_waitcnt lgkmcnt(5)
    v_mfma_f32_16x16x32_bf16 v[112:115], v[92:95], v[216:219], v[112:115]
    v_mul_f32 v38, v38, v46
    v_mul_f32 v39, v39, v47
    v_mfma_f32_16x16x32_bf16 v[104:107], v[64:67], v[224:227], v[104:107]
    ds_read_b128 v[92:95], v3 offset:23552
    v_mfma_f32_16x16x32_bf16 v[108:111], v[64:67], v[228:231], v[108:111]
    buffer_load_dwordx4 a[108:111], v1, s[8:11], s61 offen offset:3072 sc1
    v_cvt_pk_bf16_f32 v103, v38, v39
    v_permlane16_swap_b32 v100, v102
    v_mfma_f32_16x16x32_bf16 v[116:119], v[68:71], v[228:231], v[116:119]
    ds_read_b128 v[64:67], v2 offset:40960
    s_waitcnt lgkmcnt(5)
    v_mfma_f32_16x16x32_bf16 v[112:115], v[68:71], v[224:227], v[112:115]
    v_permlane16_swap_b32 v101, v103
    buffer_store_dwordx4 v[100:103], v1, s[8:11], s34 offen offset:1024 sc1
    v_mfma_f32_16x16x32_bf16 v[104:107], v[72:75], v[232:235], v[104:107]
    ds_read_b128 v[68:71], v2 offset:41984
    v_mul_f32 v48, v48, v10
    v_mfma_f32_16x16x32_bf16 v[108:111], v[72:75], v[236:239], v[108:111]
    v_mul_f32 v49, v49, v10
    v_mfma_f32_16x16x32_bf16 v[116:119], v[76:79], v[236:239], v[116:119]
    ds_read_b128 v[72:75], v2 offset:43008
    s_waitcnt lgkmcnt(5)
    v_mfma_f32_16x16x32_bf16 v[112:115], v[76:79], v[232:235], v[112:115]
    s_add_u32 s61, s25, 28672
    buffer_load_dwordx4 a[112:115], v1, s[8:11], s61 offen offset:0 sc1
    v_mul_f32 v48, v48, v56
    v_mul_f32 v49, v49, v57
    v_mfma_f32_16x16x32_bf16 v[104:107], v[80:83], v[240:243], v[104:107]
    ds_read_b128 v[76:79], v2 offset:44032
    v_accvgpr_read_b32 v12, a227
    v_mfma_f32_16x16x32_bf16 v[108:111], v[80:83], v[244:247], v[108:111]
    v_accvgpr_read_b32 v13, a227
    v_cvt_pk_bf16_f32 v96, v48, v49
    v_mul_f32 v50, v50, v10
    v_mfma_f32_16x16x32_bf16 v[116:119], v[84:87], v[244:247], v[116:119]
    ds_read_b128 v[80:83], v2 offset:45056
    s_waitcnt lgkmcnt(5)
    v_mfma_f32_16x16x32_bf16 v[112:115], v[84:87], v[240:243], v[112:115]
    v_mfma_f32_16x16x32_bf16 v[104:107], v[12:15], v[120:123], v[104:107]
    v_mfma_f32_16x16x32_bf16 v[108:111], v[12:15], v[122:125], v[108:111]
    buffer_load_dwordx4 a[116:119], v1, s[8:11], s61 offen offset:1024 sc1
    v_mul_f32 v51, v51, v10
    v_mul_f32 v50, v50, v58
    v_mfma_f32_16x16x32_bf16 v[104:107], v[88:91], v[248:251], v[104:107]
    ds_read_b128 v[84:87], v2 offset:46080
    v_mfma_f32_16x16x32_bf16 v[108:111], v[88:91], v[252:255], v[108:111]
    v_mfma_f32_16x16x32_bf16 v[112:115], v[12:15], v[124:127], v[112:115]
    v_mfma_f32_16x16x32_bf16 v[116:119], v[12:15], v[126:129], v[116:119]
    v_mul_f32 v51, v51, v59
    v_cvt_pk_bf16_f32 v97, v50, v51
    v_mfma_f32_16x16x32_bf16 v[116:119], v[92:95], v[252:255], v[116:119]
    ds_read_b128 v[88:91], v2 offset:47104
    s_waitcnt lgkmcnt(5)
    v_mfma_f32_16x16x32_bf16 v[112:115], v[92:95], v[248:251], v[112:115]
    v_mul_f32 v52, v52, v11
    v_mul_f32 v53, v53, v11
    v_mfma_f32_16x16x32_bf16 v[16:19], v[64:67], v[128:131], 0
    ds_read_b128 v[92:95], v2 offset:48128
    v_mfma_f32_16x16x32_bf16 v[20:23], v[64:67], v[132:135], 0
    buffer_load_dwordx4 a[120:123], v1, s[8:11], s61 offen offset:2048 sc1
    v_mul_f32 v52, v52, v60
    v_mul_f32 v53, v53, v61
    v_mfma_f32_16x16x32_bf16 v[28:31], v[68:71], v[132:135], 0
    ds_read_b128 v[64:67], v2 offset:57344
    s_waitcnt lgkmcnt(5)
    v_mfma_f32_16x16x32_bf16 v[24:27], v[68:71], v[128:131], 0
    v_cvt_pk_bf16_f32 v98, v52, v53
    v_mul_f32 v54, v54, v11
    v_mfma_f32_16x16x32_bf16 v[16:19], v[72:75], v[136:139], v[16:19]
    ds_read_b128 v[68:71], v2 offset:58368
    v_mfma_f32_16x16x32_bf16 v[20:23], v[72:75], v[140:143], v[20:23]
    buffer_load_dwordx4 a[124:127], v1, s[8:11], s61 offen offset:3072 sc1
    v_mul_f32 v55, v55, v11
    v_mul_f32 v54, v54, v62
    v_mfma_f32_16x16x32_bf16 v[28:31], v[76:79], v[140:143], v[28:31]
    ds_read_b128 v[72:75], v2 offset:59392
    s_waitcnt lgkmcnt(5)
    v_mfma_f32_16x16x32_bf16 v[24:27], v[76:79], v[136:139], v[24:27]
    v_mul_f32 v55, v55, v63
    v_cvt_pk_bf16_f32 v99, v54, v55
    v_mfma_f32_16x16x32_bf16 v[16:19], v[80:83], v[144:147], v[16:19]
    ds_read_b128 v[76:79], v2 offset:60416
    v_permlane16_swap_b32 v96, v98
    v_mfma_f32_16x16x32_bf16 v[20:23], v[80:83], v[148:151], v[20:23]
    v_permlane16_swap_b32 v97, v99
    v_mfma_f32_16x16x32_bf16 v[28:31], v[84:87], v[148:151], v[28:31]
    ds_read_b128 v[80:83], v2 offset:61440
    s_waitcnt lgkmcnt(5)
    v_mfma_f32_16x16x32_bf16 v[24:27], v[84:87], v[144:147], v[24:27]
    s_add_u32 s61, s25, 32768
    buffer_load_dwordx4 a[128:131], v1, s[8:11], s61 offen offset:0 sc1
    buffer_store_dwordx4 v[96:99], v1, s[8:11], s34 offen offset:2048 sc1
    v_mfma_f32_16x16x32_bf16 v[16:19], v[88:91], v[152:155], v[16:19]
    ds_read_b128 v[84:87], v2 offset:62464
    v_mul_f32 v104, v104, v10
    v_mfma_f32_16x16x32_bf16 v[20:23], v[88:91], v[156:159], v[20:23]
    v_mul_f32 v105, v105, v10
    v_mfma_f32_16x16x32_bf16 v[28:31], v[92:95], v[156:159], v[28:31]
    ds_read_b128 v[88:91], v2 offset:63488
    s_waitcnt lgkmcnt(5)
    v_mfma_f32_16x16x32_bf16 v[24:27], v[92:95], v[152:155], v[24:27]
    buffer_load_dwordx4 a[132:135], v1, s[8:11], s61 offen offset:1024 sc1
    v_mul_f32 v104, v104, v112
    v_mul_f32 v105, v105, v113
    v_mfma_f32_16x16x32_bf16 v[16:19], v[64:67], v[160:163], v[16:19]
    ds_read_b128 v[92:95], v2 offset:64512
    v_cvt_pk_bf16_f32 v100, v104, v105
    v_mfma_f32_16x16x32_bf16 v[20:23], v[64:67], v[164:167], v[20:23]
    v_mul_f32 v106, v106, v10
    v_mfma_f32_16x16x32_bf16 v[28:31], v[68:71], v[164:167], v[28:31]
    ds_read_b128 v[64:67], v3 offset:8192
    s_waitcnt lgkmcnt(5)
    v_mfma_f32_16x16x32_bf16 v[24:27], v[68:71], v[160:163], v[24:27]
    v_mul_f32 v107, v107, v10
    v_mul_f32 v106, v106, v114
    v_mfma_f32_16x16x32_bf16 v[16:19], v[72:75], v[168:171], v[16:19]
    ds_read_b128 v[68:71], v3 offset:9216
    v_mfma_f32_16x16x32_bf16 v[20:23], v[72:75], v[172:175], v[20:23]
    buffer_load_dwordx4 a[136:139], v1, s[8:11], s61 offen offset:2048 sc1
    v_mul_f32 v107, v107, v115
    v_cvt_pk_bf16_f32 v101, v106, v107
    v_mfma_f32_16x16x32_bf16 v[28:31], v[76:79], v[172:175], v[28:31]
    ds_read_b128 v[72:75], v3 offset:10240
    s_waitcnt lgkmcnt(5)
    v_mfma_f32_16x16x32_bf16 v[24:27], v[76:79], v[168:171], v[24:27]
    v_mul_f32 v108, v108, v11
    v_mul_f32 v109, v109, v11
    v_mfma_f32_16x16x32_bf16 v[16:19], v[80:83], v[176:179], v[16:19]
    ds_read_b128 v[76:79], v3 offset:11264
    v_mfma_f32_16x16x32_bf16 v[20:23], v[80:83], v[180:183], v[20:23]
    buffer_load_dwordx4 a[140:143], v1, s[8:11], s61 offen offset:3072 sc1
    v_mul_f32 v108, v108, v116
    v_mul_f32 v109, v109, v117
    v_mfma_f32_16x16x32_bf16 v[28:31], v[84:87], v[180:183], v[28:31]
    ds_read_b128 v[80:83], v3 offset:12288
    s_waitcnt lgkmcnt(5)
    v_mfma_f32_16x16x32_bf16 v[24:27], v[84:87], v[176:179], v[24:27]
    v_cvt_pk_bf16_f32 v102, v108, v109
    v_mul_f32 v110, v110, v11
    v_mfma_f32_16x16x32_bf16 v[16:19], v[88:91], v[184:187], v[16:19]
    ds_read_b128 v[84:87], v3 offset:13312
    v_mul_f32 v111, v111, v11
    v_mfma_f32_16x16x32_bf16 v[20:23], v[88:91], v[188:191], v[20:23]
    v_mul_f32 v110, v110, v118
    v_mfma_f32_16x16x32_bf16 v[28:31], v[92:95], v[188:191], v[28:31]
    ds_read_b128 v[88:91], v3 offset:14336
    s_waitcnt lgkmcnt(5)
    v_mfma_f32_16x16x32_bf16 v[24:27], v[92:95], v[184:187], v[24:27]
    s_add_u32 s61, s25, 36864
    buffer_load_dwordx4 a[144:147], v1, s[8:11], s61 offen offset:0 sc1
    v_mul_f32 v111, v111, v119
    v_cvt_pk_bf16_f32 v103, v110, v111
    v_mfma_f32_16x16x32_bf16 v[16:19], v[64:67], v[192:195], v[16:19]
    ds_read_b128 v[92:95], v3 offset:15360
    v_permlane16_swap_b32 v100, v102
    v_mfma_f32_16x16x32_bf16 v[20:23], v[64:67], v[196:199], v[20:23]
    v_permlane16_swap_b32 v101, v103
    v_mfma_f32_16x16x32_bf16 v[28:31], v[68:71], v[196:199], v[28:31]
    ds_read_b128 v[64:67], v3 offset:24576
    s_waitcnt lgkmcnt(5)
    v_mfma_f32_16x16x32_bf16 v[24:27], v[68:71], v[192:195], v[24:27]
    buffer_load_dwordx4 a[148:151], v1, s[8:11], s61 offen offset:1024 sc1
    buffer_store_dwordx4 v[100:103], v1, s[8:11], s34 offen offset:3072 sc1
    v_mfma_f32_16x16x32_bf16 v[16:19], v[72:75], v[200:203], v[16:19]
    ds_read_b128 v[68:71], v3 offset:25600
    v_mfma_f32_16x16x32_bf16 v[20:23], v[72:75], v[204:207], v[20:23]
    v_mfma_f32_16x16x32_bf16 v[28:31], v[76:79], v[204:207], v[28:31]
    ds_read_b128 v[72:75], v3 offset:26624
    s_waitcnt lgkmcnt(5)
    v_mfma_f32_16x16x32_bf16 v[24:27], v[76:79], v[200:203], v[24:27]
    v_mfma_f32_16x16x32_bf16 v[16:19], v[80:83], v[208:211], v[16:19]
    ds_read_b128 v[76:79], v3 offset:27648
    v_mfma_f32_16x16x32_bf16 v[20:23], v[80:83], v[212:215], v[20:23]
    buffer_load_dwordx4 a[152:155], v1, s[8:11], s61 offen offset:2048 sc1
    v_mfma_f32_16x16x32_bf16 v[28:31], v[84:87], v[212:215], v[28:31]
    ds_read_b128 v[80:83], v3 offset:28672
    s_waitcnt lgkmcnt(5)
    v_mfma_f32_16x16x32_bf16 v[24:27], v[84:87], v[208:211], v[24:27]
    v_mfma_f32_16x16x32_bf16 v[16:19], v[88:91], v[216:219], v[16:19]
    ds_read_b128 v[84:87], v3 offset:29696
    v_mfma_f32_16x16x32_bf16 v[20:23], v[88:91], v[220:223], v[20:23]
    buffer_load_dwordx4 a[156:159], v1, s[8:11], s61 offen offset:3072 sc1
    v_mfma_f32_16x16x32_bf16 v[28:31], v[92:95], v[220:223], v[28:31]
    ds_read_b128 v[88:91], v3 offset:30720
    s_waitcnt lgkmcnt(5)
    v_mfma_f32_16x16x32_bf16 v[24:27], v[92:95], v[216:219], v[24:27]
    s_waitcnt vmcnt(22)
    s_barrier
    v_mfma_f32_16x16x32_bf16 v[16:19], v[64:67], v[224:227], v[16:19]
    ds_read_b128 v[92:95], v3 offset:31744
    v_accvgpr_read_b32 v12, a228
    v_mfma_f32_16x16x32_bf16 v[20:23], v[64:67], v[228:231], v[20:23]
    v_accvgpr_read_b32 v13, a228
    v_mfma_f32_16x16x32_bf16 v[28:31], v[68:71], v[228:231], v[28:31]
    ds_read_b128 v[64:67], v1 offset:0
    s_waitcnt lgkmcnt(5)
    v_mfma_f32_16x16x32_bf16 v[24:27], v[68:71], v[224:227], v[24:27]
    v_mfma_f32_16x16x32_bf16 v[16:19], v[12:15], v[120:123], v[16:19]
    v_mfma_f32_16x16x32_bf16 v[20:23], v[12:15], v[122:125], v[20:23]
    s_add_u32 s61, s25, 40960
    buffer_load_dwordx4 a[160:163], v1, s[8:11], s61 offen offset:0 sc1
    v_mfma_f32_16x16x32_bf16 v[16:19], v[72:75], v[232:235], v[16:19]
    ds_read_b128 v[68:71], v1 offset:1024
    v_mfma_f32_16x16x32_bf16 v[20:23], v[72:75], v[236:239], v[20:23]
    v_mfma_f32_16x16x32_bf16 v[24:27], v[12:15], v[124:127], v[24:27]
    v_mfma_f32_16x16x32_bf16 v[28:31], v[12:15], v[126:129], v[28:31]
    v_mfma_f32_16x16x32_bf16 v[28:31], v[76:79], v[236:239], v[28:31]
    ds_read_b128 v[72:75], v1 offset:2048
    s_waitcnt lgkmcnt(5)
    v_mfma_f32_16x16x32_bf16 v[24:27], v[76:79], v[232:235], v[24:27]
    buffer_load_dwordx4 a[164:167], v1, s[8:11], s61 offen offset:1024 sc1
    v_mfma_f32_16x16x32_bf16 v[16:19], v[80:83], v[240:243], v[16:19]
    ds_read_b128 v[76:79], v1 offset:3072
    v_mfma_f32_16x16x32_bf16 v[20:23], v[80:83], v[244:247], v[20:23]
    v_mfma_f32_16x16x32_bf16 v[28:31], v[84:87], v[244:247], v[28:31]
    ds_read_b128 v[80:83], v1 offset:4096
    s_waitcnt lgkmcnt(5)
    v_mfma_f32_16x16x32_bf16 v[24:27], v[84:87], v[240:243], v[24:27]
    v_mfma_f32_16x16x32_bf16 v[16:19], v[88:91], v[248:251], v[16:19]
    ds_read_b128 v[84:87], v1 offset:5120
    v_mfma_f32_16x16x32_bf16 v[20:23], v[88:91], v[252:255], v[20:23]
    buffer_load_dwordx4 a[168:171], v1, s[8:11], s61 offen offset:2048 sc1
    v_mfma_f32_16x16x32_bf16 v[28:31], v[92:95], v[252:255], v[28:31]
    ds_read_b128 v[88:91], v1 offset:6144
    s_waitcnt lgkmcnt(5)
    v_mfma_f32_16x16x32_bf16 v[24:27], v[92:95], v[248:251], v[24:27]
    v_mfma_f32_16x16x32_bf16 v[32:35], v[64:67], v[128:131], 0
    ds_read_b128 v[92:95], v1 offset:7168
    v_mfma_f32_16x16x32_bf16 v[36:39], v[64:67], v[132:135], 0
    buffer_load_dwordx4 a[172:175], v1, s[8:11], s61 offen offset:3072 sc1
    s_waitcnt vmcnt(12)
    v_mov_b32 v5, 1
    s_mov_b64 exec, 1
    buffer_atomic_add v5, off, s[8:11], s49 sc1
    s_mov_b64 exec, -1
    v_mfma_f32_16x16x32_bf16 v[44:47], v[68:71], v[132:135], 0
    ds_read_b128 v[64:67], v1 offset:8192
    s_waitcnt lgkmcnt(5)
    v_mfma_f32_16x16x32_bf16 v[40:43], v[68:71], v[128:131], 0
    v_mfma_f32_16x16x32_bf16 v[32:35], v[72:75], v[136:139], v[32:35]
    ds_read_b128 v[68:71], v1 offset:9216
    v_mul_f32 v16, v16, v10
    v_mfma_f32_16x16x32_bf16 v[36:39], v[72:75], v[140:143], v[36:39]
    v_mul_f32 v17, v17, v10
    v_mfma_f32_16x16x32_bf16 v[44:47], v[76:79], v[140:143], v[44:47]
    ds_read_b128 v[72:75], v1 offset:10240
    s_waitcnt lgkmcnt(5)
    v_mfma_f32_16x16x32_bf16 v[40:43], v[76:79], v[136:139], v[40:43]
    s_add_u32 s61, s25, 45056
    buffer_load_dwordx4 a[176:179], v1, s[8:11], s61 offen offset:0 sc1
    v_mul_f32 v16, v16, v24
    v_mul_f32 v17, v17, v25
    v_mfma_f32_16x16x32_bf16 v[32:35], v[80:83], v[144:147], v[32:35]
    ds_read_b128 v[76:79], v1 offset:11264
    v_cvt_pk_bf16_f32 v96, v16, v17
    v_mfma_f32_16x16x32_bf16 v[36:39], v[80:83], v[148:151], v[36:39]
    v_mul_f32 v18, v18, v10
    v_mfma_f32_16x16x32_bf16 v[44:47], v[84:87], v[148:151], v[44:47]
    ds_read_b128 v[80:83], v1 offset:12288
    s_waitcnt lgkmcnt(5)
    v_mfma_f32_16x16x32_bf16 v[40:43], v[84:87], v[144:147], v[40:43]
    buffer_load_dwordx4 a[180:183], v1, s[8:11], s61 offen offset:1024 sc1
    v_mul_f32 v19, v19, v10
    v_mul_f32 v18, v18, v26
    v_mfma_f32_16x16x32_bf16 v[32:35], v[88:91], v[152:155], v[32:35]
    ds_read_b128 v[84:87], v1 offset:13312
    v_mul_f32 v19, v19, v27
    v_mfma_f32_16x16x32_bf16 v[36:39], v[88:91], v[156:159], v[36:39]
    v_cvt_pk_bf16_f32 v97, v18, v19
    v_mfma_f32_16x16x32_bf16 v[44:47], v[92:95], v[156:159], v[44:47]
    ds_read_b128 v[88:91], v1 offset:14336
    s_waitcnt lgkmcnt(5)
    v_mfma_f32_16x16x32_bf16 v[40:43], v[92:95], v[152:155], v[40:43]
    v_mul_f32 v20, v20, v11
    v_mul_f32 v21, v21, v11
    v_mfma_f32_16x16x32_bf16 v[32:35], v[64:67], v[160:163], v[32:35]
    ds_read_b128 v[92:95], v1 offset:15360
    v_mfma_f32_16x16x32_bf16 v[36:39], v[64:67], v[164:167], v[36:39]
    buffer_load_dwordx4 a[184:187], v1, s[8:11], s61 offen offset:2048 sc1
    v_mul_f32 v20, v20, v28
    v_mul_f32 v21, v21, v29
    v_mfma_f32_16x16x32_bf16 v[44:47], v[68:71], v[164:167], v[44:47]
    ds_read_b128 v[64:67], v1 offset:32768
    s_waitcnt lgkmcnt(5)
    v_mfma_f32_16x16x32_bf16 v[40:43], v[68:71], v[160:163], v[40:43]
    v_cvt_pk_bf16_f32 v98, v20, v21
    v_mul_f32 v22, v22, v11
    v_mfma_f32_16x16x32_bf16 v[32:35], v[72:75], v[168:171], v[32:35]
    ds_read_b128 v[68:71], v1 offset:33792
    v_mfma_f32_16x16x32_bf16 v[36:39], v[72:75], v[172:175], v[36:39]
    buffer_load_dwordx4 a[188:191], v1, s[8:11], s61 offen offset:3072 sc1
    v_mul_f32 v23, v23, v11
    v_mul_f32 v22, v22, v30
    v_mfma_f32_16x16x32_bf16 v[44:47], v[76:79], v[172:175], v[44:47]
    ds_read_b128 v[72:75], v1 offset:34816
    s_waitcnt lgkmcnt(5)
    v_mfma_f32_16x16x32_bf16 v[40:43], v[76:79], v[168:171], v[40:43]
    v_mul_f32 v23, v23, v31
    v_cvt_pk_bf16_f32 v99, v22, v23
    v_mfma_f32_16x16x32_bf16 v[32:35], v[80:83], v[176:179], v[32:35]
    ds_read_b128 v[76:79], v1 offset:35840
    v_permlane16_swap_b32 v96, v98
    v_mfma_f32_16x16x32_bf16 v[36:39], v[80:83], v[180:183], v[36:39]
    v_permlane16_swap_b32 v97, v99
    v_mfma_f32_16x16x32_bf16 v[44:47], v[84:87], v[180:183], v[44:47]
    ds_read_b128 v[80:83], v1 offset:36864
    s_waitcnt lgkmcnt(5)
    v_mfma_f32_16x16x32_bf16 v[40:43], v[84:87], v[176:179], v[40:43]
    s_add_u32 s61, s25, 49152
    buffer_load_dwordx4 a[192:195], v1, s[8:11], s61 offen offset:0 sc1
    buffer_store_dwordx4 v[96:99], v1, s[8:11], s35 offen offset:0 sc1
    v_mfma_f32_16x16x32_bf16 v[32:35], v[88:91], v[184:187], v[32:35]
    ds_read_b128 v[84:87], v1 offset:37888
    v_mfma_f32_16x16x32_bf16 v[36:39], v[88:91], v[188:191], v[36:39]
    v_mfma_f32_16x16x32_bf16 v[44:47], v[92:95], v[188:191], v[44:47]
    ds_read_b128 v[88:91], v1 offset:38912
    s_waitcnt lgkmcnt(5)
    v_mfma_f32_16x16x32_bf16 v[40:43], v[92:95], v[184:187], v[40:43]
    buffer_load_dwordx4 a[196:199], v1, s[8:11], s61 offen offset:1024 sc1
    v_mfma_f32_16x16x32_bf16 v[32:35], v[64:67], v[192:195], v[32:35]
    ds_read_b128 v[92:95], v1 offset:39936
    v_lshrrev_b32 v6, 9, v1
    v_mfma_f32_16x16x32_bf16 v[36:39], v[64:67], v[196:199], v[36:39]
    s_mov_b32 s54, 0
    s_atomic_add s54, s[4:5], s48 glc
    s_mov_b32 s55, 0
    s_atomic_add s55, s[4:5], s37 glc
    v_mfma_f32_16x16x32_bf16 v[44:47], v[68:71], v[196:199], v[44:47]
    ds_read_b128 v[64:67], v1 offset:40960
    s_waitcnt lgkmcnt(5)
    v_mfma_f32_16x16x32_bf16 v[40:43], v[68:71], v[192:195], v[40:43]
    v_mul_u32_u24 v6, 7168, v6
    v_mfma_f32_16x16x32_bf16 v[32:35], v[72:75], v[200:203], v[32:35]
    ds_read_b128 v[68:71], v1 offset:41984
    v_mfma_f32_16x16x32_bf16 v[36:39], v[72:75], v[204:207], v[36:39]
    buffer_load_dwordx4 a[200:203], v1, s[8:11], s61 offen offset:2048 sc1
    v_and_b32 v7, 0x100, v1
    v_mfma_f32_16x16x32_bf16 v[44:47], v[76:79], v[204:207], v[44:47]
    ds_read_b128 v[72:75], v1 offset:43008
    s_waitcnt lgkmcnt(5)
    v_mfma_f32_16x16x32_bf16 v[40:43], v[76:79], v[200:203], v[40:43]
    v_lshl_add_u32 v6, v7, 1, v6
    v_mfma_f32_16x16x32_bf16 v[32:35], v[80:83], v[208:211], v[32:35]
    ds_read_b128 v[76:79], v1 offset:44032
    v_mfma_f32_16x16x32_bf16 v[36:39], v[80:83], v[212:215], v[36:39]
    buffer_load_dwordx4 a[204:207], v1, s[8:11], s61 offen offset:3072 sc1
    v_and_b32 v7, 0xf0, v1
    v_mfma_f32_16x16x32_bf16 v[44:47], v[84:87], v[212:215], v[44:47]
    ds_read_b128 v[80:83], v1 offset:45056
    s_waitcnt lgkmcnt(5)
    v_mfma_f32_16x16x32_bf16 v[40:43], v[84:87], v[208:211], v[40:43]
    v_add_u32 v6, v6, v7
    v_mfma_f32_16x16x32_bf16 v[32:35], v[88:91], v[216:219], v[32:35]
    ds_read_b128 v[84:87], v1 offset:46080
    v_add_u32 v7, 14336, v6
    v_mfma_f32_16x16x32_bf16 v[36:39], v[88:91], v[220:223], v[36:39]
    v_mfma_f32_16x16x32_bf16 v[44:47], v[92:95], v[220:223], v[44:47]
    ds_read_b128 v[88:91], v1 offset:47104
    s_waitcnt lgkmcnt(5)
    v_mfma_f32_16x16x32_bf16 v[40:43], v[92:95], v[216:219], v[40:43]
    s_add_u32 s61, s25, 53248
    buffer_load_dwordx4 a[208:211], v1, s[8:11], s61 offen offset:0 sc1
    s_add_u32 s6, s50, 4096
    v_mfma_f32_16x16x32_bf16 v[32:35], v[64:67], v[224:227], v[32:35]
    ds_read_b128 v[92:95], v1 offset:48128
    v_accvgpr_read_b32 v12, a229
    v_mfma_f32_16x16x32_bf16 v[36:39], v[64:67], v[228:231], v[36:39]
    v_accvgpr_read_b32 v13, a229
    s_add_u32 s7, s51, 4096
    v_mfma_f32_16x16x32_bf16 v[44:47], v[68:71], v[228:231], v[44:47]
    ds_read_b128 v[64:67], v2 offset:0
    s_waitcnt lgkmcnt(5)
    v_mfma_f32_16x16x32_bf16 v[40:43], v[68:71], v[224:227], v[40:43]
    v_mfma_f32_16x16x32_bf16 v[32:35], v[12:15], v[120:123], v[32:35]
    v_mfma_f32_16x16x32_bf16 v[36:39], v[12:15], v[122:125], v[36:39]
    buffer_load_dwordx4 a[212:215], v1, s[8:11], s61 offen offset:1024 sc1
    v_mfma_f32_16x16x32_bf16 v[32:35], v[72:75], v[232:235], v[32:35]
    ds_read_b128 v[68:71], v2 offset:1024
    v_mfma_f32_16x16x32_bf16 v[36:39], v[72:75], v[236:239], v[36:39]
    v_mfma_f32_16x16x32_bf16 v[40:43], v[12:15], v[124:127], v[40:43]
    v_mfma_f32_16x16x32_bf16 v[44:47], v[12:15], v[126:129], v[44:47]
    v_mfma_f32_16x16x32_bf16 v[44:47], v[76:79], v[236:239], v[44:47]
    ds_read_b128 v[72:75], v2 offset:2048
    s_waitcnt lgkmcnt(5)
    v_mfma_f32_16x16x32_bf16 v[40:43], v[76:79], v[232:235], v[40:43]
    v_mfma_f32_16x16x32_bf16 v[32:35], v[80:83], v[240:243], v[32:35]
    ds_read_b128 v[76:79], v2 offset:3072
    v_mfma_f32_16x16x32_bf16 v[36:39], v[80:83], v[244:247], v[36:39]
    v_mfma_f32_16x16x32_bf16 v[44:47], v[84:87], v[244:247], v[44:47]
    ds_read_b128 v[80:83], v2 offset:4096
    s_waitcnt lgkmcnt(5)
    v_mfma_f32_16x16x32_bf16 v[40:43], v[84:87], v[240:243], v[40:43]
    v_mfma_f32_16x16x32_bf16 v[32:35], v[88:91], v[248:251], v[32:35]
    ds_read_b128 v[84:87], v2 offset:5120
    v_mfma_f32_16x16x32_bf16 v[36:39], v[88:91], v[252:255], v[36:39]
    v_mfma_f32_16x16x32_bf16 v[44:47], v[92:95], v[252:255], v[44:47]
    ds_read_b128 v[88:91], v2 offset:6144
    s_waitcnt lgkmcnt(5)
    v_mfma_f32_16x16x32_bf16 v[40:43], v[92:95], v[248:251], v[40:43]
    v_mfma_f32_16x16x32_bf16 v[104:107], v[64:67], v[128:131], 0
    ds_read_b128 v[92:95], v2 offset:7168
    v_mfma_f32_16x16x32_bf16 v[108:111], v[64:67], v[132:135], 0
    v_mfma_f32_16x16x32_bf16 v[116:119], v[68:71], v[132:135], 0
    ds_read_b128 v[64:67], v2 offset:8192
    s_waitcnt lgkmcnt(5)
    v_mfma_f32_16x16x32_bf16 v[112:115], v[68:71], v[128:131], 0
    v_mfma_f32_16x16x32_bf16 v[104:107], v[72:75], v[136:139], v[104:107]
    ds_read_b128 v[68:71], v2 offset:9216
    v_mul_f32 v32, v32, v10
    v_mfma_f32_16x16x32_bf16 v[108:111], v[72:75], v[140:143], v[108:111]
    v_mul_f32 v33, v33, v10
    s_waitcnt lgkmcnt(0)
    s_and_b32 s54, s54, s55
    s_bitcmp1_b32 s54, 2
    s_cbranch_scc1 L_ok_18
    s_mov_b32 s41, 65536
L_spin_17:
    s_mov_b32 s54, 0
    s_atomic_add s54, s[4:5], s48 glc
    s_mov_b32 s55, 0
    s_atomic_add s55, s[4:5], s37 glc
    s_waitcnt lgkmcnt(0)
    s_and_b32 s54, s54, s55
    s_bitcmp1_b32 s54, 2
    s_cbranch_scc1 L_ok_18
    s_sub_u32 s41, s41, 1
    s_cbranch_scc0 L_spin_17
L_ok_18:
    buffer_load_dwordx4 v[48:51], v1, s[8:11], s36 offen sc1
    buffer_load_dwordx4 v[52:55], v1, s[8:11], s36 offen offset:1024 sc1
    buffer_load_dwordx4 v[128:131], v6, s[8:11], s50 offen offset:0 sc1
    v_mfma_f32_16x16x32_bf16 v[116:119], v[76:79], v[140:143], v[116:119]
    ds_read_b128 v[72:75], v2 offset:10240
    v_mfma_f32_16x16x32_bf16 v[112:115], v[76:79], v[136:139], v[112:115]
    v_mul_f32 v32, v32, v40
    v_mul_f32 v33, v33, v41
    v_mfma_f32_16x16x32_bf16 v[104:107], v[80:83], v[144:147], v[104:107]
    ds_read_b128 v[76:79], v2 offset:11264
    v_cvt_pk_bf16_f32 v100, v32, v33
    v_mfma_f32_16x16x32_bf16 v[108:111], v[80:83], v[148:151], v[108:111]
    v_mul_f32 v34, v34, v10
    buffer_load_dwordx4 v[132:135], v6, s[8:11], s50 offen offset:256 sc1
    v_mfma_f32_16x16x32_bf16 v[116:119], v[84:87], v[148:151], v[116:119]
    ds_read_b128 v[80:83], v2 offset:12288
    v_mfma_f32_16x16x32_bf16 v[112:115], v[84:87], v[144:147], v[112:115]
    v_mul_f32 v35, v35, v10
    v_mul_f32 v34, v34, v42
    v_mfma_f32_16x16x32_bf16 v[104:107], v[88:91], v[152:155], v[104:107]
    ds_read_b128 v[84:87], v2 offset:13312
    v_mul_f32 v35, v35, v43
    v_mfma_f32_16x16x32_bf16 v[108:111], v[88:91], v[156:159], v[108:111]
    v_cvt_pk_bf16_f32 v101, v34, v35
    buffer_load_dwordx4 v[136:139], v6, s[8:11], s51 offen offset:0 sc1
    v_mfma_f32_16x16x32_bf16 v[116:119], v[92:95], v[156:159], v[116:119]
    ds_read_b128 v[88:91], v2 offset:14336
    v_mfma_f32_16x16x32_bf16 v[112:115], v[92:95], v[152:155], v[112:115]
    v_mul_f32 v36, v36, v11
    v_mul_f32 v37, v37, v11
    v_mfma_f32_16x16x32_bf16 v[104:107], v[64:67], v[160:163], v[104:107]
    ds_read_b128 v[92:95], v2 offset:15360
    v_mul_f32 v36, v36, v44
    v_mfma_f32_16x16x32_bf16 v[108:111], v[64:67], v[164:167], v[108:111]
    v_mul_f32 v37, v37, v45
    buffer_load_dwordx4 v[140:143], v6, s[8:11], s51 offen offset:256 sc1
    v_mfma_f32_16x16x32_bf16 v[116:119], v[68:71], v[164:167], v[116:119]
    ds_read_b128 v[64:67], v1 offset:16384
    s_waitcnt lgkmcnt(5)
    v_mfma_f32_16x16x32_bf16 v[112:115], v[68:71], v[160:163], v[112:115]
    v_cvt_pk_bf16_f32 v102, v36, v37
    v_mul_f32 v38, v38, v11
    v_mfma_f32_16x16x32_bf16 v[104:107], v[72:75], v[168:171], v[104:107]
    ds_read_b128 v[68:71], v1 offset:17408
    v_mul_f32 v39, v39, v11
    v_mfma_f32_16x16x32_bf16 v[108:111], v[72:75], v[172:175], v[108:111]
    v_mul_f32 v38, v38, v46
    buffer_load_dwordx4 v[144:147], v7, s[8:11], s50 offen offset:0 sc1
    v_mfma_f32_16x16x32_bf16 v[116:119], v[76:79], v[172:175], v[116:119]
    ds_read_b128 v[72:75], v1 offset:18432
    s_waitcnt lgkmcnt(5)
    v_mfma_f32_16x16x32_bf16 v[112:115], v[76:79], v[168:171], v[112:115]
    v_mul_f32 v39, v39, v47
    v_cvt_pk_bf16_f32 v103, v38, v39
    v_mfma_f32_16x16x32_bf16 v[104:107], v[80:83], v[176:179], v[104:107]
    ds_read_b128 v[76:79], v1 offset:19456
    v_permlane16_swap_b32 v100, v102
    v_mfma_f32_16x16x32_bf16 v[108:111], v[80:83], v[180:183], v[108:111]
    v_permlane16_swap_b32 v101, v103
    buffer_load_dwordx4 v[148:151], v7, s[8:11], s50 offen offset:256 sc1
    v_mfma_f32_16x16x32_bf16 v[116:119], v[84:87], v[180:183], v[116:119]
    ds_read_b128 v[80:83], v1 offset:20480
    s_waitcnt lgkmcnt(5)
    v_mfma_f32_16x16x32_bf16 v[112:115], v[84:87], v[176:179], v[112:115]
    buffer_store_dwordx4 v[100:103], v1, s[8:11], s35 offen offset:1024 sc1
    v_mfma_f32_16x16x32_bf16 v[104:107], v[88:91], v[184:187], v[104:107]
    ds_read_b128 v[84:87], v1 offset:21504
    v_mfma_f32_16x16x32_bf16 v[108:111], v[88:91], v[188:191], v[108:111]
    buffer_load_dwordx4 v[152:155], v7, s[8:11], s51 offen offset:0 sc1
    v_mfma_f32_16x16x32_bf16 v[116:119], v[92:95], v[188:191], v[116:119]
    ds_read_b128 v[88:91], v1 offset:22528
    s_waitcnt lgkmcnt(5)
    v_mfma_f32_16x16x32_bf16 v[112:115], v[92:95], v[184:187], v[112:115]
    v_mfma_f32_16x16x32_bf16 v[104:107], v[64:67], v[192:195], v[104:107]
    ds_read_b128 v[92:95], v1 offset:23552
    v_mfma_f32_16x16x32_bf16 v[108:111], v[64:67], v[196:199], v[108:111]
    buffer_load_dwordx4 v[156:159], v7, s[8:11], s51 offen offset:256 sc1
    v_mfma_f32_16x16x32_bf16 v[116:119], v[68:71], v[196:199], v[116:119]
    ds_read_b128 v[64:67], v1 offset:24576
    s_waitcnt lgkmcnt(5)
    v_mfma_f32_16x16x32_bf16 v[112:115], v[68:71], v[192:195], v[112:115]
    v_mfma_f32_16x16x32_bf16 v[104:107], v[72:75], v[200:203], v[104:107]
    ds_read_b128 v[68:71], v1 offset:25600
    v_mfma_f32_16x16x32_bf16 v[108:111], v[72:75], v[204:207], v[108:111]
    buffer_load_dwordx4 v[160:163], v6, s[8:11], s50 offen offset:1024 sc1
    v_mfma_f32_16x16x32_bf16 v[116:119], v[76:79], v[204:207], v[116:119]
    ds_read_b128 v[72:75], v1 offset:26624
    s_waitcnt lgkmcnt(5)
    v_mfma_f32_16x16x32_bf16 v[112:115], v[76:79], v[200:203], v[112:115]
    v_mfma_f32_16x16x32_bf16 v[104:107], v[80:83], v[208:211], v[104:107]
    ds_read_b128 v[76:79], v1 offset:27648
    v_accvgpr_read_b32 v12, a230
    v_mfma_f32_16x16x32_bf16 v[108:111], v[80:83], v[212:215], v[108:111]
    v_accvgpr_read_b32 v13, a230
    buffer_load_dwordx4 v[164:167], v6, s[8:11], s50 offen offset:1280 sc1
    v_mfma_f32_16x16x32_bf16 v[116:119], v[84:87], v[212:215], v[116:119]
    ds_read_b128 v[80:83], v1 offset:28672
    s_waitcnt lgkmcnt(5)
    v_mfma_f32_16x16x32_bf16 v[112:115], v[84:87], v[208:211], v[112:115]
    v_mfma_f32_16x16x32_bf16 v[104:107], v[12:15], v[120:123], v[104:107]
    v_mfma_f32_16x16x32_bf16 v[108:111], v[12:15], v[122:125], v[108:111]
    v_mfma_f32_16x16x32_bf16 v[104:107], v[88:91], v[216:219], v[104:107]
    ds_read_b128 v[84:87], v1 offset:29696
    v_mfma_f32_16x16x32_bf16 v[108:111], v[88:91], v[220:223], v[108:111]
    v_mfma_f32_16x16x32_bf16 v[112:115], v[12:15], v[124:127], v[112:115]
    s_waitcnt vmcnt(10)
    v_mfma_f32_16x16x32_bf16 v[116:119], v[12:15], v[126:129], v[116:119]
    buffer_load_dwordx4 v[168:171], v6, s[8:11], s51 offen offset:1024 sc1
    v_mov_b32 v5, 256
    s_mov_b64 exec, 1
    buffer_atomic_add v5, off, s[8:11], s49 sc1
    s_mov_b64 exec, -1
    v_mfma_f32_16x16x32_bf16 v[116:119], v[92:95], v[220:223], v[116:119]
    ds_read_b128 v[88:91], v1 offset:30720
    s_waitcnt lgkmcnt(5)
    v_mfma_f32_16x16x32_bf16 v[112:115], v[92:95], v[216:219], v[112:115]
    v_mfma_f32_16x16x32_bf16 v[104:107], v[64:67], v[224:227], v[104:107]
    ds_read_b128 v[92:95], v1 offset:31744
    v_lshlrev_b32 v16, 16, v48
    v_mfma_f32_16x16x32_bf16 v[108:111], v[64:67], v[228:231], v[108:111]
    v_and_b32 v17, 0xffff0000, v48
    buffer_load_dwordx4 v[172:175], v6, s[8:11], s51 offen offset:1280 sc1
    v_mfma_f32_16x16x32_bf16 v[116:119], v[68:71], v[228:231], v[116:119]
    s_waitcnt lgkmcnt(4)
    v_mfma_f32_16x16x32_bf16 v[112:115], v[68:71], v[224:227], v[112:115]
    v_lshlrev_b32 v18, 16, v49
    v_and_b32 v19, 0xffff0000, v49
    v_mfma_f32_16x16x32_bf16 v[104:107], v[72:75], v[232:235], v[104:107]
    v_lshlrev_b32 v24, 16, v50
    v_mfma_f32_16x16x32_bf16 v[108:111], v[72:75], v[236:239], v[108:111]
    v_and_b32 v25, 0xffff0000, v50
    buffer_load_dwordx4 v[176:179], v7, s[8:11], s50 offen offset:1024 sc1
    v_mfma_f32_16x16x32_bf16 v[116:119], v[76:79], v[236:239], v[116:119]
    s_waitcnt lgkmcnt(2)
    v_mfma_f32_16x16x32_bf16 v[112:115], v[76:79], v[232:235], v[112:115]
    v_lshlrev_b32 v26, 16, v51
    v_and_b32 v27, 0xffff0000, v51
    v_mfma_f32_16x16x32_bf16 v[104:107], v[80:83], v[240:243], v[104:107]
    v_lshlrev_b32 v20, 16, v52
    v_mfma_f32_16x16x32_bf16 v[108:111], v[80:83], v[244:247], v[108:111]
    v_and_b32 v21, 0xffff0000, v52
    buffer_load_dwordx4 v[180:183], v7, s[8:11], s50 offen offset:1280 sc1
    v_mfma_f32_16x16x32_bf16 v[116:119], v[84:87], v[244:247], v[116:119]
    s_waitcnt lgkmcnt(0)
    v_mfma_f32_16x16x32_bf16 v[112:115], v[84:87], v[240:243], v[112:115]
    v_lshlrev_b32 v22, 16, v53
    v_and_b32 v23, 0xffff0000, v53
    v_mfma_f32_16x16x32_bf16 v[104:107], v[88:91], v[248:251], v[104:107]
    v_lshlrev_b32 v28, 16, v54
    v_mfma_f32_16x16x32_bf16 v[108:111], v[88:91], v[252:255], v[108:111]
    v_and_b32 v29, 0xffff0000, v54
    buffer_load_dwordx4 v[184:187], v7, s[8:11], s51 offen offset:1024 sc1
    v_mfma_f32_16x16x32_bf16 v[116:119], v[92:95], v[252:255], v[116:119]
    v_mfma_f32_16x16x32_bf16 v[112:115], v[92:95], v[248:251], v[112:115]
    v_lshlrev_b32 v30, 16, v55
    v_and_b32 v31, 0xffff0000, v55
    s_barrier
    v_mfma_f32_16x16x32_bf16 v[16:19], a[0:3], v[128:131], v[16:19]
    v_mul_f32 v104, v104, v10
    v_mfma_f32_16x16x32_bf16 v[24:27], a[4:7], v[128:131], v[24:27]
    v_mul_f32 v105, v105, v10
    s_nop 0
    v_mul_f32 v104, v104, v112
    v_mul_f32 v105, v105, v113
    v_cvt_pk_bf16_f32 v96, v104, v105
    v_mul_f32 v106, v106, v10
    v_mul_f32 v107, v107, v10
    v_mul_f32 v106, v106, v114
    v_mul_f32 v107, v107, v115
    v_cvt_pk_bf16_f32 v97, v106, v107
    v_mul_f32 v108, v108, v11
    v_mul_f32 v109, v109, v11
    v_mul_f32 v108, v108, v116
    v_mul_f32 v109, v109, v117
    v_cvt_pk_bf16_f32 v98, v108, v109
    v_mul_f32 v110, v110, v11
    v_mul_f32 v111, v111, v11
    v_mul_f32 v110, v110, v118
    v_mul_f32 v111, v111, v119
    v_cvt_pk_bf16_f32 v99, v110, v111
    v_permlane16_swap_b32 v96, v98
    s_nop 0
    v_permlane16_swap_b32 v97, v99
    buffer_store_dwordx4 v[96:99], v1, s[8:11], s35 offen offset:2048 sc1
    buffer_load_dwordx4 v[188:191], v7, s[8:11], s51 offen offset:1280 sc1
    v_mfma_f32_16x16x32_bf16 v[32:35], a[8:11], v[128:131], 0
    v_mfma_f32_16x16x32_bf16 v[40:43], a[12:15], v[128:131], 0
    s_waitcnt vmcnt(17)
    v_mfma_f32_16x16x32_bf16 v[44:47], a[12:15], v[132:135], 0
    buffer_load_dwordx4 v[192:195], v6, s[8:11], s50 offen offset:2048 sc1
    v_mfma_f32_16x16x32_bf16 v[36:39], a[8:11], v[132:135], 0
    v_mfma_f32_16x16x32_bf16 v[28:31], a[4:7], v[132:135], v[28:31]
    v_mfma_f32_16x16x32_bf16 v[20:23], a[0:3], v[132:135], v[20:23]
    s_waitcnt vmcnt(17)
    v_mfma_f32_16x16x32_bf16 v[48:51], a[0:3], v[136:139], 0
    buffer_load_dwordx4 v[196:199], v6, s[8:11], s50 offen offset:2304 sc1
    v_mfma_f32_16x16x32_bf16 v[56:59], a[4:7], v[136:139], 0
    s_mov_b32 s54, 0
    s_atomic_add s54, s[4:5], s48 glc
    s_mov_b32 s55, 0
    s_atomic_add s55, s[4:5], s37 glc
    v_mfma_f32_16x16x32_bf16 v[64:67], a[8:11], v[136:139], 0
    v_mfma_f32_16x16x32_bf16 v[72:75], a[12:15], v[136:139], 0
    s_waitcnt vmcnt(17)
    v_mfma_f32_16x16x32_bf16 v[76:79], a[12:15], v[140:143], 0
    buffer_load_dwordx4 v[200:203], v6, s[8:11], s51 offen offset:2048 sc1
    v_mfma_f32_16x16x32_bf16 v[68:71], a[8:11], v[140:143], 0
    v_mfma_f32_16x16x32_bf16 v[60:63], a[4:7], v[140:143], 0
    v_mfma_f32_16x16x32_bf16 v[52:55], a[0:3], v[140:143], 0
    s_waitcnt vmcnt(17)
    v_mfma_f32_16x16x32_bf16 v[16:19], a[16:19], v[144:147], v[16:19]
    buffer_load_dwordx4 v[204:207], v6, s[8:11], s51 offen offset:2304 sc1
    v_mfma_f32_16x16x32_bf16 v[24:27], a[20:23], v[144:147], v[24:27]
    v_mfma_f32_16x16x32_bf16 v[32:35], a[24:27], v[144:147], v[32:35]
    v_mfma_f32_16x16x32_bf16 v[40:43], a[28:31], v[144:147], v[40:43]
    s_waitcnt vmcnt(17)
    v_mfma_f32_16x16x32_bf16 v[44:47], a[28:31], v[148:151], v[44:47]
    buffer_load_dwordx4 v[208:211], v7, s[8:11], s50 offen offset:2048 sc1
    v_mfma_f32_16x16x32_bf16 v[36:39], a[24:27], v[148:151], v[36:39]
    v_mfma_f32_16x16x32_bf16 v[28:31], a[20:23], v[148:151], v[28:31]
    v_mfma_f32_16x16x32_bf16 v[20:23], a[16:19], v[148:151], v[20:23]
    s_waitcnt vmcnt(16)
    v_mfma_f32_16x16x32_bf16 v[48:51], a[16:19], v[152:155], v[48:51]
    buffer_load_dwordx4 v[212:215], v7, s[8:11], s50 offen offset:2304 sc1
    v_mfma_f32_16x16x32_bf16 v[56:59], a[20:23], v[152:155], v[56:59]
    v_mfma_f32_16x16x32_bf16 v[64:67], a[24:27], v[152:155], v[64:67]
    v_mfma_f32_16x16x32_bf16 v[72:75], a[28:31], v[152:155], v[72:75]
    s_waitcnt vmcnt(16)
    v_mfma_f32_16x16x32_bf16 v[76:79], a[28:31], v[156:159], v[76:79]
    buffer_load_dwordx4 v[216:219], v7, s[8:11], s51 offen offset:2048 sc1
    v_mfma_f32_16x16x32_bf16 v[68:71], a[24:27], v[156:159], v[68:71]
    v_mfma_f32_16x16x32_bf16 v[60:63], a[20:23], v[156:159], v[60:63]
    v_mfma_f32_16x16x32_bf16 v[52:55], a[16:19], v[156:159], v[52:55]
    s_waitcnt vmcnt(16)
    v_mfma_f32_16x16x32_bf16 v[16:19], a[32:35], v[160:163], v[16:19]
    buffer_load_dwordx4 v[220:223], v7, s[8:11], s51 offen offset:2304 sc1
    v_mfma_f32_16x16x32_bf16 v[24:27], a[36:39], v[160:163], v[24:27]
    v_mfma_f32_16x16x32_bf16 v[32:35], a[40:43], v[160:163], v[32:35]
    v_mfma_f32_16x16x32_bf16 v[40:43], a[44:47], v[160:163], v[40:43]
    s_waitcnt vmcnt(16)
    v_mfma_f32_16x16x32_bf16 v[44:47], a[44:47], v[164:167], v[44:47]
    v_mfma_f32_16x16x32_bf16 v[36:39], a[40:43], v[164:167], v[36:39]
    v_mfma_f32_16x16x32_bf16 v[28:31], a[36:39], v[164:167], v[28:31]
    v_mfma_f32_16x16x32_bf16 v[20:23], a[32:35], v[164:167], v[20:23]
    s_waitcnt vmcnt(15)
    v_mfma_f32_16x16x32_bf16 v[48:51], a[32:35], v[168:171], v[48:51]
    v_mfma_f32_16x16x32_bf16 v[56:59], a[36:39], v[168:171], v[56:59]
    s_waitcnt lgkmcnt(0)
    s_and_b32 s54, s54, s55
    s_bitcmp1_b32 s54, 10
    s_cbranch_scc1 L_ok_20
    s_mov_b32 s41, 65536
L_spin_19:
    s_mov_b32 s54, 0
    s_atomic_add s54, s[4:5], s48 glc
    s_mov_b32 s55, 0
    s_atomic_add s55, s[4:5], s37 glc
    s_waitcnt lgkmcnt(0)
    s_and_b32 s54, s54, s55
    s_bitcmp1_b32 s54, 10
    s_cbranch_scc1 L_ok_20
    s_sub_u32 s41, s41, 1
    s_cbranch_scc0 L_spin_19
L_ok_20:
    buffer_load_dwordx4 v[224:227], v6, s[8:11], s50 offen offset:3072 sc1
    v_mfma_f32_16x16x32_bf16 v[64:67], a[40:43], v[168:171], v[64:67]
    v_mfma_f32_16x16x32_bf16 v[72:75], a[44:47], v[168:171], v[72:75]
    s_waitcnt vmcnt(14)
    v_mfma_f32_16x16x32_bf16 v[76:79], a[44:47], v[172:175], v[76:79]
    buffer_load_dwordx4 v[228:231], v6, s[8:11], s50 offen offset:3328 sc1
    v_mfma_f32_16x16x32_bf16 v[68:71], a[40:43], v[172:175], v[68:71]
    v_mov_b32 v5, 65536
    s_mov_b64 exec, 1
    buffer_atomic_add v5, off, s[8:11], s49 sc1
    s_mov_b64 exec, -1
    v_mfma_f32_16x16x32_bf16 v[60:63], a[36:39], v[172:175], v[60:63]
    v_mfma_f32_16x16x32_bf16 v[52:55], a[32:35], v[172:175], v[52:55]
    s_waitcnt vmcnt(15)
    v_mfma_f32_16x16x32_bf16 v[16:19], a[48:51], v[176:179], v[16:19]
    buffer_load_dwordx4 v[232:235], v6, s[8:11], s51 offen offset:3072 sc1
    v_mfma_f32_16x16x32_bf16 v[24:27], a[52:55], v[176:179], v[24:27]
    v_mfma_f32_16x16x32_bf16 v[32:35], a[56:59], v[176:179], v[32:35]
    v_mfma_f32_16x16x32_bf16 v[40:43], a[60:63], v[176:179], v[40:43]
    s_waitcnt vmcnt(15)
    v_mfma_f32_16x16x32_bf16 v[44:47], a[60:63], v[180:183], v[44:47]
    buffer_load_dwordx4 v[236:239], v6, s[8:11], s51 offen offset:3328 sc1
    v_mfma_f32_16x16x32_bf16 v[36:39], a[56:59], v[180:183], v[36:39]
    v_mfma_f32_16x16x32_bf16 v[28:31], a[52:55], v[180:183], v[28:31]
    v_mfma_f32_16x16x32_bf16 v[20:23], a[48:51], v[180:183], v[20:23]
    s_waitcnt vmcnt(15)
    v_mfma_f32_16x16x32_bf16 v[48:51], a[48:51], v[184:187], v[48:51]
    buffer_load_dwordx4 v[240:243], v7, s[8:11], s50 offen offset:3072 sc1
    v_mfma_f32_16x16x32_bf16 v[56:59], a[52:55], v[184:187], v[56:59]
    v_mfma_f32_16x16x32_bf16 v[64:67], a[56:59], v[184:187], v[64:67]
    v_mfma_f32_16x16x32_bf16 v[72:75], a[60:63], v[184:187], v[72:75]
    s_waitcnt vmcnt(14)
    v_mfma_f32_16x16x32_bf16 v[76:79], a[60:63], v[188:191], v[76:79]
    buffer_load_dwordx4 v[244:247], v7, s[8:11], s50 offen offset:3328 sc1
    v_mfma_f32_16x16x32_bf16 v[68:71], a[56:59], v[188:191], v[68:71]
    v_mfma_f32_16x16x32_bf16 v[60:63], a[52:55], v[188:191], v[60:63]
    v_mfma_f32_16x16x32_bf16 v[52:55], a[48:51], v[188:191], v[52:55]
    s_waitcnt vmcnt(14)
    v_mfma_f32_16x16x32_bf16 v[16:19], a[64:67], v[192:195], v[16:19]
    buffer_load_dwordx4 v[248:251], v7, s[8:11], s51 offen offset:3072 sc1
    v_mfma_f32_16x16x32_bf16 v[24:27], a[68:71], v[192:195], v[24:27]
    v_mfma_f32_16x16x32_bf16 v[32:35], a[72:75], v[192:195], v[32:35]
    v_mfma_f32_16x16x32_bf16 v[40:43], a[76:79], v[192:195], v[40:43]
    s_waitcnt vmcnt(14)
    v_mfma_f32_16x16x32_bf16 v[44:47], a[76:79], v[196:199], v[44:47]
    buffer_load_dwordx4 v[252:255], v7, s[8:11], s51 offen offset:3328 sc1
    v_mfma_f32_16x16x32_bf16 v[36:39], a[72:75], v[196:199], v[36:39]
    v_mfma_f32_16x16x32_bf16 v[28:31], a[68:71], v[196:199], v[28:31]
    v_mfma_f32_16x16x32_bf16 v[20:23], a[64:67], v[196:199], v[20:23]
    s_waitcnt vmcnt(14)
    v_mfma_f32_16x16x32_bf16 v[48:51], a[64:67], v[200:203], v[48:51]
    buffer_load_dwordx4 v[80:83], v6, s[8:11], s6 offen offset:0 sc1
    v_mfma_f32_16x16x32_bf16 v[56:59], a[68:71], v[200:203], v[56:59]
    s_mov_b32 s54, 0
    s_atomic_add s54, s[4:5], s48 glc
    s_mov_b32 s55, 0
    s_atomic_add s55, s[4:5], s37 glc
    v_mfma_f32_16x16x32_bf16 v[64:67], a[72:75], v[200:203], v[64:67]
    v_mfma_f32_16x16x32_bf16 v[72:75], a[76:79], v[200:203], v[72:75]
    s_waitcnt vmcnt(14)
    v_mfma_f32_16x16x32_bf16 v[76:79], a[76:79], v[204:207], v[76:79]
    buffer_load_dwordx4 v[84:87], v6, s[8:11], s6 offen offset:256 sc1
    v_mfma_f32_16x16x32_bf16 v[68:71], a[72:75], v[204:207], v[68:71]
    v_mfma_f32_16x16x32_bf16 v[60:63], a[68:71], v[204:207], v[60:63]
    v_mfma_f32_16x16x32_bf16 v[52:55], a[64:67], v[204:207], v[52:55]
    s_waitcnt vmcnt(14)
    v_mfma_f32_16x16x32_bf16 v[16:19], a[80:83], v[208:211], v[16:19]
    buffer_load_dwordx4 v[88:91], v6, s[8:11], s7 offen offset:0 sc1
    v_mfma_f32_16x16x32_bf16 v[24:27], a[84:87], v[208:211], v[24:27]
    v_mfma_f32_16x16x32_bf16 v[32:35], a[88:91], v[208:211], v[32:35]
    v_mfma_f32_16x16x32_bf16 v[40:43], a[92:95], v[208:211], v[40:43]
    s_waitcnt vmcnt(14)
    v_mfma_f32_16x16x32_bf16 v[44:47], a[92:95], v[212:215], v[44:47]
    buffer_load_dwordx4 v[92:95], v6, s[8:11], s7 offen offset:256 sc1
    v_mfma_f32_16x16x32_bf16 v[36:39], a[88:91], v[212:215], v[36:39]
    v_mov_b32 v5, 16777216
    s_mov_b64 exec, 1
    buffer_atomic_add v5, off, s[8:11], s49 sc1
    s_mov_b64 exec, -1
    v_mfma_f32_16x16x32_bf16 v[28:31], a[84:87], v[212:215], v[28:31]
    v_mfma_f32_16x16x32_bf16 v[20:23], a[80:83], v[212:215], v[20:23]
    s_waitcnt vmcnt(15)
    v_mfma_f32_16x16x32_bf16 v[48:51], a[80:83], v[216:219], v[48:51]
    buffer_load_dwordx4 v[96:99], v7, s[8:11], s6 offen offset:0 sc1
    v_mfma_f32_16x16x32_bf16 v[56:59], a[84:87], v[216:219], v[56:59]
    v_mfma_f32_16x16x32_bf16 v[64:67], a[88:91], v[216:219], v[64:67]
    v_mfma_f32_16x16x32_bf16 v[72:75], a[92:95], v[216:219], v[72:75]
    s_waitcnt vmcnt(15)
    v_mfma_f32_16x16x32_bf16 v[76:79], a[92:95], v[220:223], v[76:79]
    buffer_load_dwordx4 v[100:103], v7, s[8:11], s6 offen offset:256 sc1
    v_mfma_f32_16x16x32_bf16 v[68:71], a[88:91], v[220:223], v[68:71]
    v_mfma_f32_16x16x32_bf16 v[60:63], a[84:87], v[220:223], v[60:63]
    v_mfma_f32_16x16x32_bf16 v[52:55], a[80:83], v[220:223], v[52:55]
    s_waitcnt vmcnt(15)
    v_mfma_f32_16x16x32_bf16 v[16:19], a[96:99], v[224:227], v[16:19]
    buffer_load_dwordx4 v[104:107], v7, s[8:11], s7 offen offset:0 sc1
    v_mfma_f32_16x16x32_bf16 v[24:27], a[100:103], v[224:227], v[24:27]
    v_mfma_f32_16x16x32_bf16 v[32:35], a[104:107], v[224:227], v[32:35]
    v_mfma_f32_16x16x32_bf16 v[40:43], a[108:111], v[224:227], v[40:43]
    s_waitcnt vmcnt(15)
    v_mfma_f32_16x16x32_bf16 v[44:47], a[108:111], v[228:231], v[44:47]
    buffer_load_dwordx4 v[108:111], v7, s[8:11], s7 offen offset:256 sc1
    v_mfma_f32_16x16x32_bf16 v[36:39], a[104:107], v[228:231], v[36:39]
    v_mfma_f32_16x16x32_bf16 v[28:31], a[100:103], v[228:231], v[28:31]
    v_mfma_f32_16x16x32_bf16 v[20:23], a[96:99], v[228:231], v[20:23]
    s_waitcnt vmcnt(14)
    v_mfma_f32_16x16x32_bf16 v[48:51], a[96:99], v[232:235], v[48:51]
    v_mfma_f32_16x16x32_bf16 v[56:59], a[100:103], v[232:235], v[56:59]
    s_waitcnt lgkmcnt(0)
    s_and_b32 s54, s54, s55
    s_bitcmp1_b32 s54, 18
    s_cbranch_scc1 L_ok_22
    s_mov_b32 s41, 65536
L_spin_21:
    s_mov_b32 s54, 0
    s_atomic_add s54, s[4:5], s48 glc
    s_mov_b32 s55, 0
    s_atomic_add s55, s[4:5], s37 glc
    s_waitcnt lgkmcnt(0)
    s_and_b32 s54, s54, s55
    s_bitcmp1_b32 s54, 18
    s_cbranch_scc1 L_ok_22
    s_sub_u32 s41, s41, 1
    s_cbranch_scc0 L_spin_21
L_ok_22:
    buffer_load_dwordx4 v[112:115], v6, s[8:11], s6 offen offset:1024 sc1
    v_mfma_f32_16x16x32_bf16 v[64:67], a[104:107], v[232:235], v[64:67]
    v_mfma_f32_16x16x32_bf16 v[72:75], a[108:111], v[232:235], v[72:75]
    s_waitcnt vmcnt(14)
    v_mfma_f32_16x16x32_bf16 v[76:79], a[108:111], v[236:239], v[76:79]
    buffer_load_dwordx4 v[116:119], v6, s[8:11], s6 offen offset:1280 sc1
    v_mfma_f32_16x16x32_bf16 v[68:71], a[104:107], v[236:239], v[68:71]
    v_mfma_f32_16x16x32_bf16 v[60:63], a[100:103], v[236:239], v[60:63]
    v_mfma_f32_16x16x32_bf16 v[52:55], a[96:99], v[236:239], v[52:55]
    s_waitcnt vmcnt(14)
    v_mfma_f32_16x16x32_bf16 v[16:19], a[112:115], v[240:243], v[16:19]
    buffer_load_dwordx4 v[120:123], v6, s[8:11], s7 offen offset:1024 sc1
    v_mfma_f32_16x16x32_bf16 v[24:27], a[116:119], v[240:243], v[24:27]
    s_mov_b32 s54, 0
    s_atomic_add s54, s[4:5], s48 glc
    s_mov_b32 s55, 0
    s_atomic_add s55, s[4:5], s37 glc
    v_mfma_f32_16x16x32_bf16 v[32:35], a[120:123], v[240:243], v[32:35]
    v_mfma_f32_16x16x32_bf16 v[40:43], a[124:127], v[240:243], v[40:43]
    s_waitcnt vmcnt(14)
    v_mfma_f32_16x16x32_bf16 v[44:47], a[124:127], v[244:247], v[44:47]
    buffer_load_dwordx4 v[124:127], v6, s[8:11], s7 offen offset:1280 sc1
    v_mfma_f32_16x16x32_bf16 v[36:39], a[120:123], v[244:247], v[36:39]
    v_mfma_f32_16x16x32_bf16 v[28:31], a[116:119], v[244:247], v[28:31]
    v_mfma_f32_16x16x32_bf16 v[20:23], a[112:115], v[244:247], v[20:23]
    s_waitcnt vmcnt(14)
    v_mfma_f32_16x16x32_bf16 v[48:51], a[112:115], v[248:251], v[48:51]
    buffer_load_dwordx4 v[128:131], v7, s[8:11], s6 offen offset:1024 sc1
    v_mfma_f32_16x16x32_bf16 v[56:59], a[116:119], v[248:251], v[56:59]
    v_mfma_f32_16x16x32_bf16 v[64:67], a[120:123], v[248:251], v[64:67]
    v_mfma_f32_16x16x32_bf16 v[72:75], a[124:127], v[248:251], v[72:75]
    s_waitcnt vmcnt(14)
    v_mfma_f32_16x16x32_bf16 v[76:79], a[124:127], v[252:255], v[76:79]
    buffer_load_dwordx4 v[132:135], v7, s[8:11], s6 offen offset:1280 sc1
    v_mfma_f32_16x16x32_bf16 v[68:71], a[120:123], v[252:255], v[68:71]
    v_mfma_f32_16x16x32_bf16 v[60:63], a[116:119], v[252:255], v[60:63]
    v_mfma_f32_16x16x32_bf16 v[52:55], a[112:115], v[252:255], v[52:55]
    s_waitcnt vmcnt(14)
    v_mfma_f32_16x16x32_bf16 v[16:19], a[128:131], v[80:83], v[16:19]
    buffer_load_dwordx4 v[136:139], v7, s[8:11], s7 offen offset:1024 sc1
    v_mfma_f32_16x16x32_bf16 v[24:27], a[132:135], v[80:83], v[24:27]
    v_mfma_f32_16x16x32_bf16 v[32:35], a[136:139], v[80:83], v[32:35]
    v_mfma_f32_16x16x32_bf16 v[40:43], a[140:143], v[80:83], v[40:43]
    s_waitcnt vmcnt(14)
    v_mfma_f32_16x16x32_bf16 v[44:47], a[140:143], v[84:87], v[44:47]
    buffer_load_dwordx4 v[140:143], v7, s[8:11], s7 offen offset:1280 sc1
    v_mfma_f32_16x16x32_bf16 v[36:39], a[136:139], v[84:87], v[36:39]
    v_mfma_f32_16x16x32_bf16 v[28:31], a[132:135], v[84:87], v[28:31]
    v_mfma_f32_16x16x32_bf16 v[20:23], a[128:131], v[84:87], v[20:23]
    s_waitcnt vmcnt(14)
    v_mfma_f32_16x16x32_bf16 v[48:51], a[128:131], v[88:91], v[48:51]
    v_mfma_f32_16x16x32_bf16 v[56:59], a[132:135], v[88:91], v[56:59]
    v_mfma_f32_16x16x32_bf16 v[64:67], a[136:139], v[88:91], v[64:67]
    v_mfma_f32_16x16x32_bf16 v[72:75], a[140:143], v[88:91], v[72:75]
    s_waitcnt vmcnt(13)
    v_mfma_f32_16x16x32_bf16 v[76:79], a[140:143], v[92:95], v[76:79]
    v_mfma_f32_16x16x32_bf16 v[68:71], a[136:139], v[92:95], v[68:71]
    v_mfma_f32_16x16x32_bf16 v[60:63], a[132:135], v[92:95], v[60:63]
    v_mfma_f32_16x16x32_bf16 v[52:55], a[128:131], v[92:95], v[52:55]
    s_waitcnt vmcnt(11)
    v_mfma_f32_16x16x32_bf16 v[16:19], a[144:147], v[96:99], v[16:19]
    v_mfma_f32_16x16x32_bf16 v[24:27], a[148:151], v[96:99], v[24:27]
    s_waitcnt lgkmcnt(0)
    s_and_b32 s54, s54, s55
    s_bitcmp1_b32 s54, 26
    s_cbranch_scc1 L_ok_24
    s_mov_b32 s41, 65536
L_spin_23:
    s_mov_b32 s54, 0
    s_atomic_add s54, s[4:5], s48 glc
    s_mov_b32 s55, 0
    s_atomic_add s55, s[4:5], s37 glc
    s_waitcnt lgkmcnt(0)
    s_and_b32 s54, s54, s55
    s_bitcmp1_b32 s54, 26
    s_cbranch_scc1 L_ok_24
    s_sub_u32 s41, s41, 1
    s_cbranch_scc0 L_spin_23
L_ok_24:
    buffer_load_dwordx4 v[144:147], v6, s[8:11], s7 offen offset:2048 sc1
    v_mfma_f32_16x16x32_bf16 v[32:35], a[152:155], v[96:99], v[32:35]
    buffer_load_dwordx4 v[148:151], v6, s[8:11], s7 offen offset:2304 sc1
    v_mfma_f32_16x16x32_bf16 v[40:43], a[156:159], v[96:99], v[40:43]
    s_waitcnt vmcnt(12)
    v_mfma_f32_16x16x32_bf16 v[44:47], a[156:159], v[100:103], v[44:47]
    buffer_load_dwordx4 v[152:155], v7, s[8:11], s7 offen offset:2048 sc1
    v_mfma_f32_16x16x32_bf16 v[36:39], a[152:155], v[100:103], v[36:39]
    v_mfma_f32_16x16x32_bf16 v[28:31], a[148:151], v[100:103], v[28:31]
    buffer_load_dwordx4 v[156:159], v7, s[8:11], s7 offen offset:2304 sc1
    v_mfma_f32_16x16x32_bf16 v[20:23], a[144:147], v[100:103], v[20:23]
    s_waitcnt vmcnt(13)
    v_mfma_f32_16x16x32_bf16 v[48:51], a[144:147], v[104:107], v[48:51]
    buffer_load_dwordx4 v[160:163], v6, s[8:11], s6 offen offset:2048 sc1
    v_mfma_f32_16x16x32_bf16 v[56:59], a[148:151], v[104:107], v[56:59]
    v_mfma_f32_16x16x32_bf16 v[64:67], a[152:155], v[104:107], v[64:67]
    buffer_load_dwordx4 v[164:167], v6, s[8:11], s6 offen offset:2304 sc1
    v_mfma_f32_16x16x32_bf16 v[72:75], a[156:159], v[104:107], v[72:75]
    s_waitcnt vmcnt(14)
    v_mfma_f32_16x16x32_bf16 v[76:79], a[156:159], v[108:111], v[76:79]
    buffer_load_dwordx4 v[168:171], v7, s[8:11], s6 offen offset:2048 sc1
    v_mfma_f32_16x16x32_bf16 v[68:71], a[152:155], v[108:111], v[68:71]
    v_mfma_f32_16x16x32_bf16 v[60:63], a[148:151], v[108:111], v[60:63]
    buffer_load_dwordx4 v[172:175], v7, s[8:11], s6 offen offset:2304 sc1
    v_mfma_f32_16x16x32_bf16 v[52:55], a[144:147], v[108:111], v[52:55]
    s_waitcnt vmcnt(15)
    v_mfma_f32_16x16x32_bf16 v[16:19], a[160:163], v[112:115], v[16:19]
    v_mfma_f32_16x16x32_bf16 v[24:27], a[164:167], v[112:115], v[24:27]
    v_mfma_f32_16x16x32_bf16 v[32:35], a[168:171], v[112:115], v[32:35]
    v_mfma_f32_16x16x32_bf16 v[40:43], a[172:175], v[112:115], v[40:43]
    s_add_u32 m0, s26, 0
    s_add_u32 s40, s22, 0
    buffer_load_dwordx4 v1, s[8:11], s40 offen offset:0 sc1 lds
    s_waitcnt vmcnt(15)
    v_mfma_f32_16x16x32_bf16 v[44:47], a[172:175], v[116:119], v[44:47]
    v_mfma_f32_16x16x32_bf16 v[36:39], a[168:171], v[116:119], v[36:39]
    v_mfma_f32_16x16x32_bf16 v[28:31], a[164:167], v[116:119], v[28:31]
    v_mfma_f32_16x16x32_bf16 v[20:23], a[160:163], v[116:119], v[20:23]
    buffer_load_dwordx4 v1, s[8:11], s40 offen offset:1024 sc1 lds
    s_waitcnt vmcnt(15)
    v_mfma_f32_16x16x32_bf16 v[48:51], a[160:163], v[120:123], v[48:51]
    v_mfma_f32_16x16x32_bf16 v[56:59], a[164:167], v[120:123], v[56:59]
    v_mfma_f32_16x16x32_bf16 v[64:67], a[168:171], v[120:123], v[64:67]
    v_mfma_f32_16x16x32_bf16 v[72:75], a[172:175], v[120:123], v[72:75]
    buffer_load_dwordx4 v1, s[8:11], s40 offen offset:2048 sc1 lds
    s_waitcnt vmcnt(15)
    v_mfma_f32_16x16x32_bf16 v[76:79], a[172:175], v[124:127], v[76:79]
    v_mfma_f32_16x16x32_bf16 v[68:71], a[168:171], v[124:127], v[68:71]
    v_mfma_f32_16x16x32_bf16 v[60:63], a[164:167], v[124:127], v[60:63]
    v_mfma_f32_16x16x32_bf16 v[52:55], a[160:163], v[124:127], v[52:55]
    buffer_load_dwordx4 v1, s[8:11], s40 offen offset:3072 sc1 lds
    s_waitcnt vmcnt(15)
    v_mfma_f32_16x16x32_bf16 v[16:19], a[176:179], v[128:131], v[16:19]
    v_mfma_f32_16x16x32_bf16 v[24:27], a[180:183], v[128:131], v[24:27]
    v_mfma_f32_16x16x32_bf16 v[32:35], a[184:187], v[128:131], v[32:35]
    v_mfma_f32_16x16x32_bf16 v[40:43], a[188:191], v[128:131], v[40:43]
    s_add_u32 m0, s26, 16384
    s_add_u32 s40, s22, 16384
    buffer_load_dwordx4 v1, s[8:11], s40 offen offset:0 sc1 lds
    s_waitcnt vmcnt(15)
    v_mfma_f32_16x16x32_bf16 v[44:47], a[188:191], v[132:135], v[44:47]
    v_mfma_f32_16x16x32_bf16 v[36:39], a[184:187], v[132:135], v[36:39]
    v_mfma_f32_16x16x32_bf16 v[28:31], a[180:183], v[132:135], v[28:31]
    v_mfma_f32_16x16x32_bf16 v[20:23], a[176:179], v[132:135], v[20:23]
    buffer_load_dwordx4 v1, s[8:11], s40 offen offset:1024 sc1 lds
    s_waitcnt vmcnt(15)
    v_mfma_f32_16x16x32_bf16 v[48:51], a[176:179], v[136:139], v[48:51]
    v_mfma_f32_16x16x32_bf16 v[56:59], a[180:183], v[136:139], v[56:59]
    s_xor_b32 s42, s3, 1
    s_lshl_b32 s42, s42, 14
    v_mfma_f32_16x16x32_bf16 v[64:67], a[184:187], v[136:139], v[64:67]
    v_mfma_f32_16x16x32_bf16 v[72:75], a[188:191], v[136:139], v[72:75]
    buffer_load_dwordx4 v1, s[8:11], s40 offen offset:2048 sc1 lds
    s_add_u32 s42, s42, 98304
    v_add_u32 v120, s42, v1
    s_waitcnt vmcnt(15)
    v_mfma_f32_16x16x32_bf16 v[76:79], a[188:191], v[140:143], v[76:79]
    v_mfma_f32_16x16x32_bf16 v[68:71], a[184:187], v[140:143], v[68:71]
    s_xor_b32 s42, s3, 2
    s_lshl_b32 s42, s42, 14
    v_mfma_f32_16x16x32_bf16 v[60:63], a[180:183], v[140:143], v[60:63]
    v_mfma_f32_16x16x32_bf16 v[52:55], a[176:179], v[140:143], v[52:55]
    buffer_load_dwordx4 v1, s[8:11], s40 offen offset:3072 sc1 lds
    s_add_u32 s42, s42, 102400
    v_add_u32 v121, s42, v1
    s_waitcnt vmcnt(15)
    v_mfma_f32_16x16x32_bf16 v[48:51], a[192:195], v[144:147], v[48:51]
    v_mfma_f32_16x16x32_bf16 v[56:59], a[196:199], v[144:147], v[56:59]
    s_xor_b32 s42, s3, 3
    s_lshl_b32 s42, s42, 14
    v_mfma_f32_16x16x32_bf16 v[64:67], a[200:203], v[144:147], v[64:67]
    v_mfma_f32_16x16x32_bf16 v[72:75], a[204:207], v[144:147], v[72:75]
    s_add_u32 m0, s26, 32768
    s_add_u32 s40, s22, 32768
    buffer_load_dwordx4 v1, s[8:11], s40 offen offset:0 sc1 lds
    s_add_u32 s42, s42, 106496
    v_add_u32 v122, s42, v1
    s_waitcnt vmcnt(15)
    v_mfma_f32_16x16x32_bf16 v[76:79], a[204:207], v[148:151], v[76:79]
    v_mfma_f32_16x16x32_bf16 v[68:71], a[200:203], v[148:151], v[68:71]
    v_mfma_f32_16x16x32_bf16 v[60:63], a[196:199], v[148:151], v[60:63]
    v_mfma_f32_16x16x32_bf16 v[52:55], a[192:195], v[148:151], v[52:55]
    buffer_load_dwordx4 v1, s[8:11], s40 offen offset:1024 sc1 lds
    s_waitcnt vmcnt(15)
    v_mfma_f32_16x16x32_bf16 v[48:51], a[208:211], v[152:155], v[48:51]
    v_mfma_f32_16x16x32_bf16 v[56:59], a[212:215], v[152:155], v[56:59]
    v_mfma_f32_16x16x32_bf16 v[64:67], a[216:219], v[152:155], v[64:67]
    v_mfma_f32_16x16x32_bf16 v[72:75], a[220:223], v[152:155], v[72:75]
    s_waitcnt vmcnt(14)
    v_mfma_f32_16x16x32_bf16 v[76:79], a[220:223], v[156:159], v[76:79]
    v_mfma_f32_16x16x32_bf16 v[68:71], a[216:219], v[156:159], v[68:71]
    v_mfma_f32_16x16x32_bf16 v[60:63], a[212:215], v[156:159], v[60:63]
    v_mfma_f32_16x16x32_bf16 v[52:55], a[208:211], v[156:159], v[52:55]
    s_waitcnt vmcnt(13)
    v_mfma_f32_16x16x32_bf16 v[16:19], a[192:195], v[160:163], v[16:19]
    v_mfma_f32_16x16x32_bf16 v[24:27], a[196:199], v[160:163], v[24:27]
    v_mfma_f32_16x16x32_bf16 v[32:35], a[200:203], v[160:163], v[32:35]
    v_mfma_f32_16x16x32_bf16 v[40:43], a[204:207], v[160:163], v[40:43]
    s_waitcnt vmcnt(12)
    v_mfma_f32_16x16x32_bf16 v[44:47], a[204:207], v[164:167], v[44:47]
    ds_write_b128 v121, v[48:51] offset:0
    v_mfma_f32_16x16x32_bf16 v[36:39], a[200:203], v[164:167], v[36:39]
    v_mfma_f32_16x16x32_bf16 v[28:31], a[196:199], v[164:167], v[28:31]
    ds_write_b128 v121, v[52:55] offset:1024
    v_mfma_f32_16x16x32_bf16 v[20:23], a[192:195], v[164:167], v[20:23]
    s_waitcnt vmcnt(11)
    v_mfma_f32_16x16x32_bf16 v[16:19], a[208:211], v[168:171], v[16:19]
    ds_write_b128 v121, v[56:59] offset:2048
    v_mfma_f32_16x16x32_bf16 v[24:27], a[212:215], v[168:171], v[24:27]
    v_mfma_f32_16x16x32_bf16 v[32:35], a[216:219], v[168:171], v[32:35]
    ds_write_b128 v121, v[60:63] offset:3072
    v_mfma_f32_16x16x32_bf16 v[40:43], a[220:223], v[168:171], v[40:43]
    s_waitcnt vmcnt(10)
    v_mfma_f32_16x16x32_bf16 v[44:47], a[220:223], v[172:175], v[44:47]
    ds_write_b128 v122, v[64:67] offset:0
    v_mfma_f32_16x16x32_bf16 v[36:39], a[216:219], v[172:175], v[36:39]
    v_mfma_f32_16x16x32_bf16 v[28:31], a[212:215], v[172:175], v[28:31]
    ds_write_b128 v122, v[68:71] offset:1024
    v_mfma_f32_16x16x32_bf16 v[20:23], a[208:211], v[172:175], v[20:23]
    ds_write_b128 v122, v[72:75] offset:2048
    ds_write_b128 v122, v[76:79] offset:3072
    s_lshl_b32 s42, s30, 15
    s_lshl_b32 s43, s31, 11
    s_add_u32 s42, s42, s43
    s_add_u32 s42, s42, 13172736
    v_accvgpr_read_b32 v6, a237
    s_lshl_b32 s46, s30, 12
    s_lshl_b32 s43, s31, 8
    s_add_u32 s46, s46, s43
    s_add_u32 s46, s46, 8454144
    v_and_b32 v7, 0x300, v1
    v_and_b32 v8, 0xf0, v1
    v_lshl_add_u32 v7, v7, 1, v8
    v_lshrrev_b32 v6, 1, v8
    v_bfe_u32 v8, v1, 8, 1
    v_lshl_add_u32 v6, v8, 2, v6
    v_lshrrev_b32 v8, 9, v1
    v_lshl_add_u32 v6, v8, 7, v6
    ds_write_b128 v120, v[32:35] offset:0
    ds_write_b128 v120, v[36:39] offset:1024
    ds_write_b128 v120, v[40:43] offset:2048
    ds_write_b128 v120, v[44:47] offset:3072
    v_accvgpr_read_b32 v5, a239
    s_waitcnt lgkmcnt(0)
    s_barrier
    ds_read_b128 v[80:83], v5 offset:0
    ds_read_b128 v[84:87], v5 offset:1024
    ds_read_b128 v[88:91], v5 offset:2048
    ds_read_b128 v[92:95], v5 offset:3072
    ds_read_b128 v[96:99], v5 offset:4096
    ds_read_b128 v[100:103], v5 offset:5120
    ds_read_b128 v[104:107], v5 offset:6144
    ds_read_b128 v[108:111], v5 offset:7168
    ds_read_b128 v[112:115], v5 offset:8192
    ds_read_b128 v[116:119], v5 offset:9216
    ds_read_b128 v[120:123], v5 offset:10240
    ds_read_b128 v[124:127], v5 offset:11264
    s_waitcnt lgkmcnt(11)
    v_pk_add_f32 v[16:17], v[16:17], v[80:81]
    v_pk_add_f32 v[18:19], v[18:19], v[82:83]
    s_waitcnt lgkmcnt(10)
    v_pk_add_f32 v[20:21], v[20:21], v[84:85]
    v_pk_add_f32 v[22:23], v[22:23], v[86:87]
    s_waitcnt lgkmcnt(9)
    v_pk_add_f32 v[24:25], v[24:25], v[88:89]
    v_pk_add_f32 v[26:27], v[26:27], v[90:91]
    s_waitcnt lgkmcnt(8)
    v_pk_add_f32 v[28:29], v[28:29], v[92:93]
    v_pk_add_f32 v[30:31], v[30:31], v[94:95]
    s_waitcnt lgkmcnt(7)
    v_pk_add_f32 v[16:17], v[16:17], v[96:97]
    v_pk_add_f32 v[18:19], v[18:19], v[98:99]
    s_waitcnt lgkmcnt(6)
    v_pk_add_f32 v[20:21], v[20:21], v[100:101]
    v_pk_add_f32 v[22:23], v[22:23], v[102:103]
    s_waitcnt lgkmcnt(5)
    v_pk_add_f32 v[24:25], v[24:25], v[104:105]
    v_pk_add_f32 v[26:27], v[26:27], v[106:107]
    s_waitcnt lgkmcnt(4)
    v_pk_add_f32 v[28:29], v[28:29], v[108:109]
    v_pk_add_f32 v[30:31], v[30:31], v[110:111]
    s_waitcnt lgkmcnt(3)
    v_pk_add_f32 v[16:17], v[16:17], v[112:113]
    v_pk_add_f32 v[18:19], v[18:19], v[114:115]
    s_waitcnt lgkmcnt(2)
    v_pk_add_f32 v[20:21], v[20:21], v[116:117]
    v_pk_add_f32 v[22:23], v[22:23], v[118:119]
    s_waitcnt lgkmcnt(1)
    v_pk_add_f32 v[24:25], v[24:25], v[120:121]
    v_pk_add_f32 v[26:27], v[26:27], v[122:123]
    s_waitcnt lgkmcnt(0)
    v_pk_add_f32 v[28:29], v[28:29], v[124:125]
    v_pk_add_f32 v[30:31], v[30:31], v[126:127]
    v_cvt_pk_bf16_f32 v32, v16, v17
    v_cvt_pk_bf16_f32 v33, v18, v19
    v_cvt_pk_bf16_f32 v34, v24, v25
    v_cvt_pk_bf16_f32 v35, v26, v27
    buffer_store_dwordx4 v[32:35], v7, s[8:11], s42 offen offset:0 sc1
    v_cvt_pk_bf16_f32 v36, v20, v21
    v_cvt_pk_bf16_f32 v37, v22, v23
    v_cvt_pk_bf16_f32 v38, v28, v29
    v_cvt_pk_bf16_f32 v39, v30, v31
    buffer_store_dwordx4 v[36:39], v7, s[8:11], s42 offen offset:256 sc1
    v_pk_add_f32 v[40:41], v[16:17], v[18:19]
    v_pk_mul_f32 v[44:45], v[16:17], v[16:17]
    v_pk_add_f32 v[40:41], v[40:41], v[24:25]
    v_pk_fma_f32 v[44:45], v[18:19], v[18:19], v[44:45]
    v_pk_add_f32 v[40:41], v[40:41], v[26:27]
    v_pk_fma_f32 v[44:45], v[24:25], v[24:25], v[44:45]
    v_pk_fma_f32 v[44:45], v[26:27], v[26:27], v[44:45]
    v_pk_add_f32 v[42:43], v[20:21], v[22:23]
    v_pk_mul_f32 v[46:47], v[20:21], v[20:21]
    v_pk_add_f32 v[42:43], v[42:43], v[28:29]
    v_pk_fma_f32 v[46:47], v[22:23], v[22:23], v[46:47]
    v_pk_add_f32 v[42:43], v[42:43], v[30:31]
    v_pk_fma_f32 v[46:47], v[28:29], v[28:29], v[46:47]
    v_pk_fma_f32 v[46:47], v[30:31], v[30:31], v[46:47]
    v_add_f32 v40, v40, v41
    v_add_f32 v41, v42, v43
    v_add_f32 v42, v44, v45
    v_add_f32 v43, v46, v47
    v_permlane32_swap_b32 v40, v41
    s_nop 0
    v_permlane32_swap_b32 v42, v43
    v_add_f32 v40, v40, v41
    v_add_f32 v42, v42, v43
    s_nop 1
    v_permlane16_swap_b32 v40, v42
    v_add_f32 v40, v40, v42
    buffer_store_dword v40, v6, s[8:11], s46 offen sc1
    s_lshl_b32 s42, s30, 7
    s_add_u32 s42, s42, 7634944
    s_waitcnt vmcnt(0)
    s_mov_b32 s19, 1
    s_atomic_add s19, s[4:5], s42
    buffer_load_dwordx4 v1, s[8:11], s40 offen offset:2048 sc1 lds
    buffer_load_dwordx4 v1, s[8:11], s40 offen offset:3072 sc1 lds
    s_add_u32 m0, s26, 49152
    s_add_u32 s40, s22, 49152
    buffer_load_dwordx4 v1, s[8:11], s40 offen offset:0 sc1 lds
    buffer_load_dwordx4 v1, s[8:11], s40 offen offset:1024 sc1 lds
    buffer_load_dwordx4 v1, s[8:11], s40 offen offset:2048 sc1 lds
    buffer_load_dwordx4 v1, s[8:11], s40 offen offset:3072 sc1 lds
    s_add_u32 s47, s20, 13172736
    s_lshl_b32 s42, s18, 7
    s_add_u32 s42, s42, 7634944
    s_mov_b32 s54, 0
    s_atomic_add s54, s[4:5], s42 glc
    s_waitcnt lgkmcnt(0)
    s_bitcmp1_b32 s54, 4
    s_cbranch_scc1 L_ok_26
    s_mov_b32 s41, 65536
L_spin_25:
    s_mov_b32 s54, 0
    s_atomic_add s54, s[4:5], s42 glc
    s_waitcnt lgkmcnt(0)
    s_bitcmp1_b32 s54, 4
    s_cbranch_scc1 L_ok_26
    s_sub_u32 s41, s41, 1
    s_cbranch_scc0 L_spin_25
L_ok_26:
    buffer_load_dwordx4 v[128:131], v1, s[8:11], s47 offen offset:0 sc1
    buffer_load_dwordx4 v[132:135], v1, s[8:11], s47 offen offset:1024 sc1
    buffer_load_dwordx4 v[136:139], v1, s[8:11], s47 offen offset:2048 sc1
    buffer_load_dwordx4 v[140:143], v1, s[8:11], s47 offen offset:3072 sc1
    s_add_u32 s39, s47, 4096
    buffer_load_dwordx4 v[144:147], v1, s[8:11], s39 offen offset:0 sc1
    buffer_load_dwordx4 v[148:151], v1, s[8:11], s39 offen offset:1024 sc1
    buffer_load_dwordx4 v[152:155], v1, s[8:11], s39 offen offset:2048 sc1
    buffer_load_dwordx4 v[156:159], v1, s[8:11], s39 offen offset:3072 sc1
    s_add_u32 s39, s47, 8192
    buffer_load_dwordx4 v[160:163], v1, s[8:11], s39 offen offset:0 sc1
    buffer_load_dwordx4 v[164:167], v1, s[8:11], s39 offen offset:1024 sc1
    buffer_load_dwordx4 v[168:171], v1, s[8:11], s39 offen offset:2048 sc1
    buffer_load_dwordx4 v[172:175], v1, s[8:11], s39 offen offset:3072 sc1
    s_add_u32 s39, s47, 12288
    buffer_load_dwordx4 v[176:179], v1, s[8:11], s39 offen offset:0 sc1
    buffer_load_dwordx4 v[180:183], v1, s[8:11], s39 offen offset:1024 sc1
    s_waitcnt vmcnt(14)
    s_barrier
    ds_read_b128 v[64:67], v1 offset:0
    ds_read_b128 v[68:71], v1 offset:1024
    ds_read_b128 v[72:75], v1 offset:2048
    ds_read_b128 v[76:79], v1 offset:3072
    ds_read_b128 v[80:83], v1 offset:4096
    ds_read_b128 v[84:87], v1 offset:5120
    ds_read_b128 v[88:91], v1 offset:6144
    s_waitcnt vmcnt(13) lgkmcnt(6)
    v_mfma_f32_32x32x16_bf16 v[16:31], v[64:67], v[128:131], 0
    ds_read_b128 v[92:95], v1 offset:7168
    buffer_load_dwordx4 v[184:187], v1, s[8:11], s39 offen offset:2048 sc1
    s_waitcnt lgkmcnt(6)
    v_mfma_f32_32x32x16_bf16 v[32:47], v[128:131], v[68:71], 0
    ds_read_b128 v[64:67], v1 offset:8192
    s_add_u32 s42, s21, 8454144
    buffer_load_dwordx4 v[96:99], v1, s[8:11], s42 offen offset:0 sc1
    buffer_load_dwordx4 v[100:103], v1, s[8:11], s42 offen offset:1024 sc1
    buffer_load_dwordx4 v[104:107], v1, s[8:11], s42 offen offset:2048 sc1
    buffer_load_dwordx4 v[108:111], v1, s[8:11], s42 offen offset:3072 sc1
    s_waitcnt vmcnt(17) lgkmcnt(6)
    v_mfma_f32_32x32x16_bf16 v[16:31], v[72:75], v[132:135], v[16:31]
    ds_read_b128 v[68:71], v1 offset:9216
    buffer_load_dwordx4 v[188:191], v1, s[8:11], s39 offen offset:3072 sc1
    s_waitcnt lgkmcnt(6)
    v_mfma_f32_32x32x16_bf16 v[32:47], v[132:135], v[76:79], v[32:47]
    ds_read_b128 v[72:75], v1 offset:10240
    s_waitcnt vmcnt(17) lgkmcnt(6)
    v_mfma_f32_32x32x16_bf16 v[16:31], v[80:83], v[136:139], v[16:31]
    ds_read_b128 v[76:79], v1 offset:11264
    s_add_u32 s39, s47, 16384
    buffer_load_dwordx4 v[192:195], v1, s[8:11], s39 offen offset:0 sc1
    s_waitcnt lgkmcnt(6)
    v_mfma_f32_32x32x16_bf16 v[32:47], v[136:139], v[84:87], v[32:47]
    ds_read_b128 v[80:83], v1 offset:12288
    s_waitcnt vmcnt(17) lgkmcnt(6)
    v_mfma_f32_32x32x16_bf16 v[16:31], v[88:91], v[140:143], v[16:31]
    ds_read_b128 v[84:87], v1 offset:13312
    buffer_load_dwordx4 v[196:199], v1, s[8:11], s39 offen offset:1024 sc1
    s_waitcnt lgkmcnt(6)
    v_mfma_f32_32x32x16_bf16 v[32:47], v[140:143], v[92:95], v[32:47]
    ds_read_b128 v[88:91], v1 offset:14336
    s_waitcnt vmcnt(17) lgkmcnt(6)
    v_mfma_f32_32x32x16_bf16 v[16:31], v[64:67], v[144:147], v[16:31]
    ds_read_b128 v[92:95], v1 offset:15360
    buffer_load_dwordx4 v[200:203], v1, s[8:11], s39 offen offset:2048 sc1
    s_waitcnt lgkmcnt(6)
    v_mfma_f32_32x32x16_bf16 v[32:47], v[144:147], v[68:71], v[32:47]
    ds_read_b128 v[64:67], v1 offset:16384
    s_waitcnt vmcnt(17) lgkmcnt(6)
    v_mfma_f32_32x32x16_bf16 v[16:31], v[72:75], v[148:151], v[16:31]
    ds_read_b128 v[68:71], v1 offset:17408
    buffer_load_dwordx4 v[204:207], v1, s[8:11], s39 offen offset:3072 sc1
    s_waitcnt lgkmcnt(6)
    v_mfma_f32_32x32x16_bf16 v[32:47], v[148:151], v[76:79], v[32:47]
    ds_read_b128 v[72:75], v1 offset:18432
    s_waitcnt vmcnt(17) lgkmcnt(6)
    v_mfma_f32_32x32x16_bf16 v[16:31], v[80:83], v[152:155], v[16:31]
    ds_read_b128 v[76:79], v1 offset:19456
    s_add_u32 s39, s47, 20480
    buffer_load_dwordx4 v[208:211], v1, s[8:11], s39 offen offset:0 sc1
    s_waitcnt lgkmcnt(6)
    v_mfma_f32_32x32x16_bf16 v[32:47], v[152:155], v[84:87], v[32:47]
    ds_read_b128 v[80:83], v1 offset:20480
    s_waitcnt vmcnt(17) lgkmcnt(6)
    v_mfma_f32_32x32x16_bf16 v[16:31], v[88:91], v[156:159], v[16:31]
    ds_read_b128 v[84:87], v1 offset:21504
    buffer_load_dwordx4 v[212:215], v1, s[8:11], s39 offen offset:1024 sc1
    s_waitcnt lgkmcnt(6)
    v_mfma_f32_32x32x16_bf16 v[32:47], v[156:159], v[92:95], v[32:47]
    ds_read_b128 v[88:91], v1 offset:22528
    s_waitcnt vmcnt(17) lgkmcnt(6)
    v_mfma_f32_32x32x16_bf16 v[16:31], v[64:67], v[160:163], v[16:31]
    ds_read_b128 v[92:95], v1 offset:23552
    buffer_load_dwordx4 v[216:219], v1, s[8:11], s39 offen offset:2048 sc1
    s_waitcnt lgkmcnt(6)
    v_mfma_f32_32x32x16_bf16 v[32:47], v[160:163], v[68:71], v[32:47]
    ds_read_b128 v[64:67], v1 offset:24576
    s_waitcnt vmcnt(17) lgkmcnt(6)
    v_mfma_f32_32x32x16_bf16 v[16:31], v[72:75], v[164:167], v[16:31]
    ds_read_b128 v[68:71], v1 offset:25600
    buffer_load_dwordx4 v[220:223], v1, s[8:11], s39 offen offset:3072 sc1
    s_waitcnt lgkmcnt(6)
    v_mfma_f32_32x32x16_bf16 v[32:47], v[164:167], v[76:79], v[32:47]
    ds_read_b128 v[72:75], v1 offset:26624
    s_waitcnt vmcnt(17) lgkmcnt(6)
    v_mfma_f32_32x32x16_bf16 v[16:31], v[80:83], v[168:171], v[16:31]
    ds_read_b128 v[76:79], v1 offset:27648
    s_add_u32 s39, s47, 24576
    buffer_load_dwordx4 v[224:227], v1, s[8:11], s39 offen offset:0 sc1
    s_waitcnt lgkmcnt(6)
    v_mfma_f32_32x32x16_bf16 v[32:47], v[168:171], v[84:87], v[32:47]
    ds_read_b128 v[80:83], v1 offset:28672
    s_waitcnt vmcnt(17) lgkmcnt(6)
    v_mfma_f32_32x32x16_bf16 v[16:31], v[88:91], v[172:175], v[16:31]
    ds_read_b128 v[84:87], v1 offset:29696
    buffer_load_dwordx4 v[228:231], v1, s[8:11], s39 offen offset:1024 sc1
    s_waitcnt lgkmcnt(6)
    v_mfma_f32_32x32x16_bf16 v[32:47], v[172:175], v[92:95], v[32:47]
    ds_read_b128 v[88:91], v1 offset:30720
    s_waitcnt vmcnt(17) lgkmcnt(6)
    v_mfma_f32_32x32x16_bf16 v[16:31], v[64:67], v[176:179], v[16:31]
    ds_read_b128 v[92:95], v1 offset:31744
    buffer_load_dwordx4 v[232:235], v1, s[8:11], s39 offen offset:2048 sc1
    s_waitcnt lgkmcnt(6)
    v_mfma_f32_32x32x16_bf16 v[32:47], v[176:179], v[68:71], v[32:47]
    ds_read_b128 v[64:67], v1 offset:32768
    s_waitcnt vmcnt(17) lgkmcnt(6)
    v_mfma_f32_32x32x16_bf16 v[16:31], v[72:75], v[180:183], v[16:31]
    ds_read_b128 v[68:71], v1 offset:33792
    buffer_load_dwordx4 v[236:239], v1, s[8:11], s39 offen offset:3072 sc1
    s_waitcnt lgkmcnt(6)
    v_mfma_f32_32x32x16_bf16 v[32:47], v[180:183], v[76:79], v[32:47]
    ds_read_b128 v[72:75], v1 offset:34816
    s_waitcnt vmcnt(17) lgkmcnt(6)
    v_mfma_f32_32x32x16_bf16 v[16:31], v[80:83], v[184:187], v[16:31]
    ds_read_b128 v[76:79], v1 offset:35840
    s_add_u32 s39, s47, 28672
    buffer_load_dwordx4 v[240:243], v1, s[8:11], s39 offen offset:0 sc1
    s_waitcnt lgkmcnt(6)
    v_mfma_f32_32x32x16_bf16 v[32:47], v[184:187], v[84:87], v[32:47]
    ds_read_b128 v[80:83], v1 offset:36864
    s_waitcnt vmcnt(13) lgkmcnt(6)
    v_mfma_f32_32x32x16_bf16 v[16:31], v[88:91], v[188:191], v[16:31]
    ds_read_b128 v[84:87], v1 offset:37888
    buffer_load_dwordx4 v[244:247], v1, s[8:11], s39 offen offset:1024 sc1
    v_accvgpr_read_b32 v7, a234
    v_accvgpr_read_b32 v9, a236
    s_waitcnt lgkmcnt(6)
    v_mfma_f32_32x32x16_bf16 v[32:47], v[188:191], v[92:95], v[32:47]
    ds_read_b128 v[88:91], v1 offset:38912
    v_add_f32 v96, v96, v100
    v_add_f32 v104, v104, v108
    s_waitcnt vmcnt(13) lgkmcnt(6)
    v_mfma_f32_32x32x16_bf16 v[16:31], v[64:67], v[192:195], v[16:31]
    ds_read_b128 v[92:95], v1 offset:39936
    buffer_load_dwordx4 v[248:251], v1, s[8:11], s39 offen offset:2048 sc1
    v_add_f32 v97, v97, v101
    v_add_f32 v105, v105, v109
    s_waitcnt lgkmcnt(6)
    v_mfma_f32_32x32x16_bf16 v[32:47], v[192:195], v[68:71], v[32:47]
    ds_read_b128 v[64:67], v1 offset:40960
    v_add_f32 v98, v98, v102
    v_add_f32 v106, v106, v110
    s_waitcnt vmcnt(13) lgkmcnt(6)
    v_mfma_f32_32x32x16_bf16 v[16:31], v[72:75], v[196:199], v[16:31]
    ds_read_b128 v[68:71], v1 offset:41984
    buffer_load_dwordx4 v[252:255], v1, s[8:11], s39 offen offset:3072 sc1
    v_add_f32 v99, v99, v103
    v_add_f32 v107, v107, v111
    s_waitcnt lgkmcnt(6)
    v_mfma_f32_32x32x16_bf16 v[32:47], v[196:199], v[76:79], v[32:47]
    ds_read_b128 v[72:75], v1 offset:43008
    v_add_f32 v96, v96, v104
    v_add_f32 v97, v97, v105
    s_waitcnt vmcnt(13) lgkmcnt(6)
    v_mfma_f32_32x32x16_bf16 v[16:31], v[80:83], v[200:203], v[16:31]
    ds_read_b128 v[76:79], v1 offset:44032
    v_add_f32 v98, v98, v106
    v_add_f32 v99, v99, v107
    s_waitcnt lgkmcnt(6)
    v_mfma_f32_32x32x16_bf16 v[32:47], v[200:203], v[84:87], v[32:47]
    ds_read_b128 v[80:83], v1 offset:45056
    v_permlane32_swap_b32 v96, v98
    v_permlane32_swap_b32 v97, v99
    s_waitcnt vmcnt(12) lgkmcnt(6)
    v_mfma_f32_32x32x16_bf16 v[16:31], v[88:91], v[204:207], v[16:31]
    ds_read_b128 v[84:87], v1 offset:46080
    s_add_u32 m0, s26, 65536
    s_add_u32 s40, s22, 65536
    buffer_load_dwordx4 v1, s[8:11], s40 offen offset:0 sc1 lds
    v_add_f32 v96, v96, v98
    v_add_f32 v97, v97, v99
    s_waitcnt lgkmcnt(6)
    v_mfma_f32_32x32x16_bf16 v[32:47], v[204:207], v[92:95], v[32:47]
    ds_read_b128 v[88:91], v1 offset:47104
    v_permlane16_swap_b32 v96, v97
    v_add_f32 v96, v96, v97
    s_waitcnt vmcnt(12) lgkmcnt(6)
    v_mfma_f32_32x32x16_bf16 v[16:31], v[64:67], v[208:211], v[16:31]
    ds_read_b128 v[92:95], v1 offset:48128
    v_mov_b32 v97, v96
    s_nop 1
    v_permlane16_swap_b32 v96, v97
    s_waitcnt lgkmcnt(6)
    v_mfma_f32_32x32x16_bf16 v[32:47], v[208:211], v[68:71], v[32:47]
    ds_read_b128 v[64:67], v1 offset:49152
    buffer_load_dwordx4 v1, s[8:11], s40 offen offset:1024 sc1 lds
    v_mul_f32 v98, 0x3b000000, v96
    v_mul_f32 v97, 0x3b000000, v97
    s_waitcnt vmcnt(12) lgkmcnt(6)
    v_mfma_f32_32x32x16_bf16 v[16:31], v[72:75], v[212:215], v[16:31]
    ds_read_b128 v[68:71], v1 offset:50176
    v_fma_f32 v97, -v98, v98, v97
    v_max_f32 v97, 0, v97
    s_waitcnt lgkmcnt(6)
    v_mfma_f32_32x32x16_bf16 v[32:47], v[212:215], v[76:79], v[32:47]
    ds_read_b128 v[72:75], v1 offset:51200
    v_add_f32 v97, 0x3727c5ac, v97
    v_rsq_f32 v96, v97
    s_waitcnt vmcnt(11) lgkmcnt(6)
    v_mfma_f32_32x32x16_bf16 v[16:31], v[80:83], v[216:219], v[16:31]
    ds_read_b128 v[76:79], v1 offset:52224
    buffer_load_dwordx4 v1, s[8:11], s40 offen offset:2048 sc1 lds
    ds_write_b32 v7, v96 offset:12288
    ds_bpermute_b32 v5, v9, v96
    s_waitcnt lgkmcnt(8)
    v_mfma_f32_32x32x16_bf16 v[32:47], v[216:219], v[84:87], v[32:47]
    ds_read_b128 v[80:83], v1 offset:53248
    v_accvgpr_read_b32 v8, a235
    ds_bpermute_b32 v114, v9, v98
    s_waitcnt vmcnt(11) lgkmcnt(9)
    v_mfma_f32_32x32x16_bf16 v[16:31], v[88:91], v[220:223], v[16:31]
    ds_read_b128 v[84:87], v1 offset:54272
    s_waitcnt lgkmcnt(9)
    v_mfma_f32_32x32x16_bf16 v[32:47], v[220:223], v[92:95], v[32:47]
    ds_read_b128 v[88:91], v1 offset:55296
    buffer_load_dwordx4 v1, s[8:11], s40 offen offset:3072 sc1 lds
    s_waitcnt vmcnt(11) lgkmcnt(9)
    v_mfma_f32_32x32x16_bf16 v[16:31], v[64:67], v[224:227], v[16:31]
    ds_read_b128 v[92:95], v1 offset:56320
    s_waitcnt lgkmcnt(9)
    v_mfma_f32_32x32x16_bf16 v[32:47], v[224:227], v[68:71], v[32:47]
    ds_read_b128 v[64:67], v1 offset:57344
    s_waitcnt vmcnt(10) lgkmcnt(9)
    v_mfma_f32_32x32x16_bf16 v[16:31], v[72:75], v[228:231], v[16:31]
    ds_read_b128 v[68:71], v1 offset:58368
    s_add_u32 m0, s26, 81920
    s_add_u32 s40, s22, 81920
    buffer_load_dwordx4 v1, s[8:11], s40 offen offset:0 sc1 lds
    s_waitcnt lgkmcnt(5)
    v_cvt_pk_bf16_f32 v112, v114, v114
    v_cmp_gt_u32 vcc, 512, v1
    v_mfma_f32_32x32x16_bf16 v[32:47], v[228:231], v[76:79], v[32:47]
    ds_read_b128 v[72:75], v1 offset:59392
    v_lshlrev_b32 v113, 16, v112
    v_sub_f32 v113, v114, v113
    s_waitcnt vmcnt(10)
    v_mfma_f32_32x32x16_bf16 v[16:31], v[80:83], v[232:235], v[16:31]
    ds_read_b128 v[76:79], v1 offset:60416
    v_cvt_pk_bf16_f32 v113, v113, 0
    v_cndmask_b32 v112, 0, v112, vcc
    s_waitcnt lgkmcnt(6)
    v_mfma_f32_32x32x16_bf16 v[32:47], v[232:235], v[84:87], v[32:47]
    ds_read_b128 v[80:83], v1 offset:61440
    buffer_load_dwordx4 v1, s[8:11], s40 offen offset:1024 sc1 lds
    v_cndmask_b32 v113, 0, v113, vcc
    v_mov_b32 v114, 0
    s_waitcnt vmcnt(10) lgkmcnt(6)
    v_mfma_f32_32x32x16_bf16 v[16:31], v[88:91], v[236:239], v[16:31]
    ds_read_b128 v[84:87], v1 offset:62464
    v_mov_b32 v115, 0
    v_mov_b32 v118, 0
    s_waitcnt lgkmcnt(6)
    v_mfma_f32_32x32x16_bf16 v[32:47], v[236:239], v[92:95], v[32:47]
    ds_read_b128 v[88:91], v1 offset:63488
    v_mov_b32 v119, 0
    v_mul_f32 v5, 0x3fb8aa3b, v5
    s_waitcnt vmcnt(9) lgkmcnt(6)
    v_mfma_f32_32x32x16_bf16 v[16:31], v[64:67], v[240:243], v[16:31]
    ds_read_b128 v[92:95], v1 offset:64512
    buffer_load_dwordx4 v1, s[8:11], s40 offen offset:2048 sc1 lds
    s_waitcnt lgkmcnt(6)
    v_mfma_f32_32x32x16_bf16 v[32:47], v[240:243], v[68:71], v[32:47]
    v_accvgpr_read_b32 v116, a246
    v_accvgpr_read_b32 v117, a246
    s_waitcnt vmcnt(9) lgkmcnt(5)
    v_mfma_f32_32x32x16_bf16 v[16:31], v[72:75], v[244:247], v[16:31]
    v_mfma_f32_32x32x16_bf16 v[16:31], v[116:119], v[112:115], v[16:31]
    s_waitcnt lgkmcnt(4)
    v_mfma_f32_32x32x16_bf16 v[32:47], v[244:247], v[76:79], v[32:47]
    buffer_load_dwordx4 v1, s[8:11], s40 offen offset:3072 sc1 lds
    v_accvgpr_read_b32 v116, a247
    v_accvgpr_read_b32 v117, a247
    s_waitcnt vmcnt(9) lgkmcnt(3)
    v_mfma_f32_32x32x16_bf16 v[16:31], v[80:83], v[248:251], v[16:31]
    v_mfma_f32_32x32x16_bf16 v[32:47], v[112:115], v[116:119], v[32:47]
    s_waitcnt lgkmcnt(2)
    v_mfma_f32_32x32x16_bf16 v[32:47], v[248:251], v[84:87], v[32:47]
    v_accvgpr_read_b32 v116, a231
    v_accvgpr_read_b32 v117, a231
    s_waitcnt vmcnt(8) lgkmcnt(1)
    v_mfma_f32_32x32x16_bf16 v[16:31], v[88:91], v[252:255], v[16:31]
    v_mfma_f32_32x32x16_bf16 v[48:63], v[116:119], v[112:115], 0
    s_waitcnt lgkmcnt(0)
    v_mfma_f32_32x32x16_bf16 v[32:47], v[252:255], v[92:95], v[32:47]
    s_barrier
    s_add_u32 s58, s23, s26
    ds_read_b128 v[112:115], v8 offset:12288
    ds_read_b128 v[116:119], v8 offset:12320
    ds_read_b128 v[120:123], v8 offset:12352
    ds_read_b128 v[124:127], v8 offset:12384
    s_nop 2
    v_max3_f32 v10, v16, v17, v18
    v_min3_f32 v11, v16, v17, v18
    v_max3_f32 v10, v10, v19, v20
    v_min3_f32 v11, v11, v19, v20
    v_max3_f32 v10, v10, v21, v22
    s_add_u32 m0, s26, 0
    s_add_u32 s40, s58, 0
    buffer_load_dwordx4 v1, s[8:11], s40 offen offset:0 sc1 lds
    v_min3_f32 v11, v11, v21, v22
    v_max3_f32 v10, v10, v23, v24
    v_min3_f32 v11, v11, v23, v24
    v_max3_f32 v10, v10, v25, v26
    v_min3_f32 v11, v11, v25, v26
    v_max3_f32 v10, v10, v27, v28
    v_min3_f32 v11, v11, v27, v28
    v_max3_f32 v10, v10, v29, v30
    v_min3_f32 v11, v11, v29, v30
    v_max_f32 v10, v10, v31
    buffer_load_dwordx4 v1, s[8:11], s40 offen offset:1024 sc1 lds
    v_min_f32 v11, v11, v31
    v_mul_f32 v10, -v5, v10
    v_mul_f32 v11, v5, v11
    v_pk_fma_f32 v[96:97], v[16:17], v[4:5], v[10:11] op_sel:[0,1,1] op_sel_hi:[1,1,1] neg_lo:[0,1,0] neg_hi:[0,1,0]
    v_pk_fma_f32 v[16:17], v[16:17], v[4:5], v[10:11] op_sel:[0,1,0] op_sel_hi:[1,1,0]
    v_pk_fma_f32 v[98:99], v[18:19], v[4:5], v[10:11] op_sel:[0,1,1] op_sel_hi:[1,1,1] neg_lo:[0,1,0] neg_hi:[0,1,0]
    v_pk_fma_f32 v[18:19], v[18:19], v[4:5], v[10:11] op_sel:[0,1,0] op_sel_hi:[1,1,0]
    v_exp_f32 v16, v16
    v_exp_f32 v17, v17
    v_exp_f32 v96, v96
    buffer_load_dwordx4 v1, s[8:11], s40 offen offset:2048 sc1 lds
    v_exp_f32 v97, v97
    v_pk_fma_f32 v[100:101], v[20:21], v[4:5], v[10:11] op_sel:[0,1,1] op_sel_hi:[1,1,1] neg_lo:[0,1,0] neg_hi:[0,1,0]
    v_pk_fma_f32 v[20:21], v[20:21], v[4:5], v[10:11] op_sel:[0,1,0] op_sel_hi:[1,1,0]
    v_exp_f32 v18, v18
    v_exp_f32 v19, v19
    v_exp_f32 v98, v98
    v_exp_f32 v99, v99
    v_pk_fma_f32 v[102:103], v[22:23], v[4:5], v[10:11] op_sel:[0,1,1] op_sel_hi:[1,1,1] neg_lo:[0,1,0] neg_hi:[0,1,0]
    v_pk_fma_f32 v[22:23], v[22:23], v[4:5], v[10:11] op_sel:[0,1,0] op_sel_hi:[1,1,0]
    v_exp_f32 v20, v20
    buffer_load_dwordx4 v1, s[8:11], s40 offen offset:3072 sc1 lds
    v_exp_f32 v21, v21
    v_exp_f32 v100, v100
    v_exp_f32 v101, v101
    v_pk_fma_f32 v[104:105], v[24:25], v[4:5], v[10:11] op_sel:[0,1,1] op_sel_hi:[1,1,1] neg_lo:[0,1,0] neg_hi:[0,1,0]
    v_pk_fma_f32 v[24:25], v[24:25], v[4:5], v[10:11] op_sel:[0,1,0] op_sel_hi:[1,1,0]
    v_exp_f32 v22, v22
    v_exp_f32 v23, v23
    v_exp_f32 v102, v102
    v_exp_f32 v103, v103
    v_pk_fma_f32 v[106:107], v[26:27], v[4:5], v[10:11] op_sel:[0,1,1] op_sel_hi:[1,1,1] neg_lo:[0,1,0] neg_hi:[0,1,0]
    s_add_u32 m0, s26, 16384
    s_add_u32 s40, s58, 16384
    buffer_load_dwordx4 v1, s[8:11], s40 offen offset:0 sc1 lds
    v_pk_fma_f32 v[26:27], v[26:27], v[4:5], v[10:11] op_sel:[0,1,0] op_sel_hi:[1,1,0]
    v_exp_f32 v24, v24
    v_exp_f32 v25, v25
    v_exp_f32 v104, v104
    v_exp_f32 v105, v105
    v_pk_fma_f32 v[108:109], v[28:29], v[4:5], v[10:11] op_sel:[0,1,1] op_sel_hi:[1,1,1] neg_lo:[0,1,0] neg_hi:[0,1,0]
    v_pk_fma_f32 v[28:29], v[28:29], v[4:5], v[10:11] op_sel:[0,1,0] op_sel_hi:[1,1,0]
    v_exp_f32 v26, v26
    v_exp_f32 v27, v27
    v_exp_f32 v106, v106
    buffer_load_dwordx4 v1, s[8:11], s40 offen offset:1024 sc1 lds
    v_exp_f32 v107, v107
    v_pk_fma_f32 v[110:111], v[30:31], v[4:5], v[10:11] op_sel:[0,1,1] op_sel_hi:[1,1,1] neg_lo:[0,1,0] neg_hi:[0,1,0]
    v_pk_fma_f32 v[30:31], v[30:31], v[4:5], v[10:11] op_sel:[0,1,0] op_sel_hi:[1,1,0]
    v_exp_f32 v28, v28
    v_exp_f32 v29, v29
    v_exp_f32 v108, v108
    v_exp_f32 v109, v109
    v_exp_f32 v30, v30
    v_exp_f32 v31, v31
    v_exp_f32 v110, v110
    buffer_load_dwordx4 v1, s[8:11], s40 offen offset:2048 sc1 lds
    v_exp_f32 v111, v111
    v_pk_add_f32 v[12:13], v[16:17], v[18:19]
    v_pk_add_f32 v[14:15], v[96:97], v[98:99]
    v_pk_add_f32 v[12:13], v[12:13], v[20:21]
    v_pk_add_f32 v[14:15], v[14:15], v[100:101]
    v_pk_add_f32 v[12:13], v[12:13], v[22:23]
    v_pk_add_f32 v[14:15], v[14:15], v[102:103]
    v_pk_add_f32 v[12:13], v[12:13], v[24:25]
    v_pk_add_f32 v[14:15], v[14:15], v[104:105]
    v_pk_add_f32 v[12:13], v[12:13], v[26:27]
    buffer_load_dwordx4 v1, s[8:11], s40 offen offset:3072 sc1 lds
    v_pk_add_f32 v[14:15], v[14:15], v[106:107]
    v_pk_add_f32 v[12:13], v[12:13], v[28:29]
    v_pk_add_f32 v[14:15], v[14:15], v[108:109]
    v_pk_add_f32 v[12:13], v[12:13], v[30:31]
    v_pk_add_f32 v[14:15], v[14:15], v[110:111]
    v_add_f32 v12, v12, v13
    v_add_f32 v14, v14, v15
    v_rcp_f32 v12, v12
    v_rcp_f32 v14, v14
    v_pk_mul_f32 v[16:17], v[16:17], v[12:13] op_sel_hi:[1,0]
    s_add_u32 m0, s26, 32768
    s_add_u32 s40, s58, 32768
    buffer_load_dwordx4 v1, s[8:11], s40 offen offset:0 sc1 lds
    v_pk_mul_f32 v[18:19], v[18:19], v[12:13] op_sel_hi:[1,0]
    v_pk_mul_f32 v[20:21], v[20:21], v[12:13] op_sel_hi:[1,0]
    v_pk_mul_f32 v[22:23], v[22:23], v[12:13] op_sel_hi:[1,0]
    v_cvt_pk_bf16_f32 v64, v16, v17
    v_cvt_pk_bf16_f32 v65, v18, v19
    v_cvt_pk_bf16_f32 v66, v20, v21
    v_cvt_pk_bf16_f32 v67, v22, v23
    v_pk_mul_f32 v[96:97], v[96:97], v[14:15] op_sel_hi:[1,0]
    v_pk_mul_f32 v[98:99], v[98:99], v[14:15] op_sel_hi:[1,0]
    v_pk_mul_f32 v[100:101], v[100:101], v[14:15] op_sel_hi:[1,0]
    buffer_load_dwordx4 v1, s[8:11], s40 offen offset:1024 sc1 lds
    v_pk_mul_f32 v[102:103], v[102:103], v[14:15] op_sel_hi:[1,0]
    v_cvt_pk_bf16_f32 v72, v96, v97
    v_cvt_pk_bf16_f32 v73, v98, v99
    v_cvt_pk_bf16_f32 v74, v100, v101
    v_cvt_pk_bf16_f32 v75, v102, v103
    v_mfma_f32_32x32x16_bf16 v[80:95], v[64:67], a[248:251], 0
    v_pk_mul_f32 v[24:25], v[24:25], v[12:13] op_sel_hi:[1,0]
    v_pk_mul_f32 v[26:27], v[26:27], v[12:13] op_sel_hi:[1,0]
    v_pk_mul_f32 v[28:29], v[28:29], v[12:13] op_sel_hi:[1,0]
    v_pk_mul_f32 v[30:31], v[30:31], v[12:13] op_sel_hi:[1,0]
    buffer_load_dwordx4 v1, s[8:11], s40 offen offset:2048 sc1 lds
    v_cvt_pk_bf16_f32 v68, v24, v25
    v_cvt_pk_bf16_f32 v69, v26, v27
    v_cvt_pk_bf16_f32 v70, v28, v29
    v_cvt_pk_bf16_f32 v71, v30, v31
    s_nop 1
    v_mfma_f32_32x32x16_bf16 v[80:95], v[68:71], a[252:255], v[80:95]
    v_pk_mul_f32 v[104:105], v[104:105], v[14:15] op_sel_hi:[1,0]
    v_pk_mul_f32 v[106:107], v[106:107], v[14:15] op_sel_hi:[1,0]
    v_pk_mul_f32 v[108:109], v[108:109], v[14:15] op_sel_hi:[1,0]
    v_pk_mul_f32 v[110:111], v[110:111], v[14:15] op_sel_hi:[1,0]
    v_cvt_pk_bf16_f32 v76, v104, v105
    buffer_load_dwordx4 v1, s[8:11], s40 offen offset:3072 sc1 lds
    v_cvt_pk_bf16_f32 v77, v106, v107
    v_cvt_pk_bf16_f32 v78, v108, v109
    v_cvt_pk_bf16_f32 v79, v110, v111
    v_mfma_f32_32x32x16_bf16 v[16:31], v[72:75], a[248:251], 0
    s_waitcnt lgkmcnt(3)
    v_pk_mul_f32 v[32:33], v[32:33], v[112:113]
    v_pk_mul_f32 v[34:35], v[34:35], v[114:115]
    s_waitcnt lgkmcnt(2)
    v_pk_mul_f32 v[36:37], v[36:37], v[116:117]
    v_pk_mul_f32 v[38:39], v[38:39], v[118:119]
    s_waitcnt lgkmcnt(1)
    v_pk_mul_f32 v[40:41], v[40:41], v[120:121]
    v_pk_mul_f32 v[42:43], v[42:43], v[122:123]
    s_add_u32 m0, s26, 49152
    s_add_u32 s40, s58, 49152
    buffer_load_dwordx4 v1, s[8:11], s40 offen offset:0 sc1 lds
    s_waitcnt lgkmcnt(0)
    v_pk_mul_f32 v[44:45], v[44:45], v[124:125]
    v_pk_mul_f32 v[46:47], v[46:47], v[126:127]
    v_mfma_f32_32x32x16_bf16 v[16:31], v[76:79], a[252:255], v[16:31]
    v_cvt_pk_bf16_f32 v32, v32, v33
    v_cvt_pk_bf16_f32 v33, v34, v35
    v_cvt_pk_bf16_f32 v34, v36, v37
    v_cvt_pk_bf16_f32 v35, v38, v39
    v_cvt_pk_bf16_f32 v36, v40, v41
    v_cvt_pk_bf16_f32 v37, v42, v43
    v_cvt_pk_bf16_f32 v38, v44, v45
    buffer_load_dwordx4 v1, s[8:11], s40 offen offset:1024 sc1 lds
    v_cvt_pk_bf16_f32 v39, v46, v47
    v_cvt_pk_bf16_f32 v64, v80, v81
    v_cvt_pk_bf16_f32 v65, v82, v83
    v_cvt_pk_bf16_f32 v66, v84, v85
    v_cvt_pk_bf16_f32 v67, v86, v87
    v_cvt_pk_bf16_f32 v68, v88, v89
    v_cvt_pk_bf16_f32 v69, v90, v91
    v_cvt_pk_bf16_f32 v70, v92, v93
    v_cvt_pk_bf16_f32 v71, v94, v95
    v_mfma_f32_32x32x16_bf16 v[112:127], v[64:67], v[32:35], 0
    buffer_load_dwordx4 v1, s[8:11], s40 offen offset:2048 sc1 lds
    v_pk_add_f32 v[8:9], v[80:81], v[82:83]
    v_pk_add_f32 v[8:9], v[8:9], v[84:85]
    v_pk_add_f32 v[8:9], v[8:9], v[86:87]
    v_pk_add_f32 v[8:9], v[8:9], v[88:89]
    v_pk_add_f32 v[8:9], v[8:9], v[90:91]
    v_pk_add_f32 v[8:9], v[8:9], v[92:93]
    v_pk_add_f32 v[8:9], v[8:9], v[94:95]
    v_mfma_f32_32x32x16_bf16 v[112:127], v[68:71], v[36:39], v[112:127]
    v_cvt_pk_bf16_f32 v72, v16, v17
    v_cvt_pk_bf16_f32 v73, v18, v19
    buffer_load_dwordx4 v1, s[8:11], s40 offen offset:3072 sc1 lds
    v_cvt_pk_bf16_f32 v74, v20, v21
    v_cvt_pk_bf16_f32 v75, v22, v23
    v_cvt_pk_bf16_f32 v76, v24, v25
    v_cvt_pk_bf16_f32 v77, v26, v27
    v_cvt_pk_bf16_f32 v78, v28, v29
    v_cvt_pk_bf16_f32 v79, v30, v31
    v_mfma_f32_32x32x16_bf16 v[96:111], v[72:75], v[32:35], 0
    v_pk_add_f32 v[40:41], v[16:17], v[18:19]
    v_pk_add_f32 v[40:41], v[40:41], v[20:21]
    v_pk_add_f32 v[40:41], v[40:41], v[22:23]
    v_pk_add_f32 v[40:41], v[40:41], v[24:25]
    v_pk_add_f32 v[40:41], v[40:41], v[26:27]
    v_pk_add_f32 v[40:41], v[40:41], v[28:29]
    v_pk_add_f32 v[40:41], v[40:41], v[30:31]
    v_mfma_f32_32x32x16_bf16 v[96:111], v[76:79], v[36:39], v[96:111]
    v_add_f32 v8, v8, v9
    v_add_f32 v9, v40, v41
    v_accvgpr_read_b32 v6, a233
    v_and_b32 v7, 0x100, v1
    v_permlane32_swap_b32 v8, v9
    v_cmp_ne_u32 vcc, 0, v7
    v_add_f32 v8, v8, v9
    v_accvgpr_read_b32 v7, a232
    ds_write_b32 v6, v8 offset:4096
    v_cndmask_b32 v16, v112, v120, vcc
    v_cndmask_b32 v17, v113, v121, vcc
    v_cndmask_b32 v18, v114, v122, vcc
    v_cndmask_b32 v19, v115, v123, vcc
    v_cndmask_b32 v20, v116, v124, vcc
    v_cndmask_b32 v21, v117, v125, vcc
    v_cndmask_b32 v22, v118, v126, vcc
    v_cndmask_b32 v23, v119, v127, vcc
    ds_write_b128 v7, v[16:19]
    ds_write_b128 v7, v[20:23] offset:512
    v_cndmask_b32 v24, v96, v104, vcc
    v_cndmask_b32 v25, v97, v105, vcc
    v_cndmask_b32 v26, v98, v106, vcc
    v_cndmask_b32 v27, v99, v107, vcc
    v_cndmask_b32 v28, v100, v108, vcc
    v_cndmask_b32 v29, v101, v109, vcc
    v_cndmask_b32 v30, v102, v110, vcc
    v_cndmask_b32 v31, v103, v111, vcc
    ds_write_b128 v7, v[24:27] offset:2048
    ds_write_b128 v7, v[28:31] offset:2560
    s_lshl_b32 s42, s3, 10
    s_add_u32 s42, s42, 98304
    v_add_u32 v7, s42, v1
    v_add_u32 v8, 102400, v4
    v_accvgpr_read_b32 v6, a241
    s_lshl_b32 s42, s17, 4
    s_add_u32 s42, s42, s16
    s_lshl_b32 s52, s42, 8
    s_add_u32 s52, s52, 23724032
    s_lshl_b32 s42, s42, 11
    s_add_u32 s42, s42, 22499328
    s_lshl_b32 s43, s3, 4
    s_mov_b64 s[34:35], 0xffff
    s_lshl_b64 s[34:35], s[34:35], s43
    s_waitcnt vmcnt(16)
    s_waitcnt lgkmcnt(0)
    s_barrier
    ds_read_b128 v[64:67], v7 offset:0
    ds_read_b128 v[68:71], v7 offset:16384
    ds_read_b128 v[72:75], v7 offset:32768
    ds_read_b128 v[76:79], v7 offset:49152
    ds_read2st64_b32 v[80:81], v8 offset0:0 offset1:64
    ds_read2st64_b32 v[82:83], v8 offset0:128 offset1:192
    ds_read_b128 v[96:99], v2 offset:0
    ds_read_b128 v[100:103], v2 offset:1024
    ds_read_b128 v[104:107], v2 offset:2048
    ds_read_b128 v[108:111], v2 offset:3072
    ds_read_b128 v[112:115], v2 offset:4096
    ds_read_b128 v[116:119], v2 offset:5120
    ds_read_b128 v[120:123], v2 offset:6144
    s_waitcnt lgkmcnt(11)
    v_pk_add_f32 v[64:65], v[64:65], v[68:69]
    v_pk_add_f32 v[66:67], v[66:67], v[70:71]
    s_waitcnt lgkmcnt(9)
    v_pk_add_f32 v[72:73], v[72:73], v[76:77]
    v_pk_add_f32 v[74:75], v[74:75], v[78:79]
    v_pk_add_f32 v[64:65], v[64:65], v[72:73]
    v_pk_add_f32 v[66:67], v[66:67], v[74:75]
    v_cvt_pk_bf16_f32 v64, v64, v65
    v_cvt_pk_bf16_f32 v65, v66, v67
    buffer_store_dwordx2 v[64:65], v6, s[8:11], s42 offen sc1
    s_waitcnt lgkmcnt(7)
    v_pk_add_f32 v[80:81], v[80:81], v[82:83]
    v_add_f32 v80, v80, v81
    s_mov_b64 exec, s[34:35]
    buffer_store_dword v80, v4, s[8:11], s52 offen sc1
    s_mov_b64 exec, -1
    s_lshl_b32 s42, s3, 4
    s_add_u32 s42, s42, s17
    s_lshl_b32 s42, s42, 7
    s_add_u32 s52, s42, 7610368
    s_waitcnt lgkmcnt(6)
    v_mfma_f32_32x32x16_bf16 v[48:63], v[96:99], v[128:131], v[48:63]
    ds_read_b128 v[124:127], v2 offset:7168
    s_waitcnt lgkmcnt(6)
    v_mfma_f32_32x32x16_bf16 v[48:63], v[100:103], v[132:135], v[48:63]
    ds_read_b128 v[96:99], v2 offset:8192
    s_waitcnt lgkmcnt(6)
    v_mfma_f32_32x32x16_bf16 v[48:63], v[104:107], v[136:139], v[48:63]
    ds_read_b128 v[100:103], v2 offset:9216
    s_waitcnt lgkmcnt(6)
    v_mfma_f32_32x32x16_bf16 v[48:63], v[108:111], v[140:143], v[48:63]
    ds_read_b128 v[104:107], v2 offset:10240
    s_waitcnt lgkmcnt(6)
    v_mfma_f32_32x32x16_bf16 v[48:63], v[112:115], v[144:147], v[48:63]
    ds_read_b128 v[108:111], v2 offset:11264
    s_waitcnt lgkmcnt(6)
    v_mfma_f32_32x32x16_bf16 v[48:63], v[116:119], v[148:151], v[48:63]
    ds_read_b128 v[112:115], v2 offset:12288
    s_waitcnt lgkmcnt(6)
    v_mfma_f32_32x32x16_bf16 v[48:63], v[120:123], v[152:155], v[48:63]
    ds_read_b128 v[116:119], v2 offset:13312
    s_waitcnt lgkmcnt(6)
    v_mfma_f32_32x32x16_bf16 v[48:63], v[124:127], v[156:159], v[48:63]
    ds_read_b128 v[120:123], v2 offset:14336
    s_waitcnt lgkmcnt(6)
    v_mfma_f32_32x32x16_bf16 v[48:63], v[96:99], v[160:163], v[48:63]
    ds_read_b128 v[124:127], v2 offset:15360
    s_waitcnt lgkmcnt(6)
    v_mfma_f32_32x32x16_bf16 v[48:63], v[100:103], v[164:167], v[48:63]
    ds_read_b128 v[96:99], v2 offset:16384
    s_waitcnt lgkmcnt(6)
    v_mfma_f32_32x32x16_bf16 v[48:63], v[104:107], v[168:171], v[48:63]
    ds_read_b128 v[100:103], v2 offset:17408
    s_waitcnt lgkmcnt(6)
    v_mfma_f32_32x32x16_bf16 v[48:63], v[108:111], v[172:175], v[48:63]
    ds_read_b128 v[104:107], v2 offset:18432
    s_waitcnt lgkmcnt(6)
    v_mfma_f32_32x32x16_bf16 v[48:63], v[112:115], v[176:179], v[48:63]
    ds_read_b128 v[108:111], v2 offset:19456
    s_waitcnt lgkmcnt(6)
    v_mfma_f32_32x32x16_bf16 v[48:63], v[116:119], v[180:183], v[48:63]
    ds_read_b128 v[112:115], v2 offset:20480
    s_waitcnt lgkmcnt(6)
    v_mfma_f32_32x32x16_bf16 v[48:63], v[120:123], v[184:187], v[48:63]
    ds_read_b128 v[116:119], v2 offset:21504
    s_waitcnt lgkmcnt(6)
    v_mfma_f32_32x32x16_bf16 v[48:63], v[124:127], v[188:191], v[48:63]
    ds_read_b128 v[120:123], v2 offset:22528
    s_waitcnt lgkmcnt(6)
    v_mfma_f32_32x32x16_bf16 v[48:63], v[96:99], v[192:195], v[48:63]
    ds_read_b128 v[124:127], v2 offset:23552
    s_waitcnt lgkmcnt(6)
    v_mfma_f32_32x32x16_bf16 v[48:63], v[100:103], v[196:199], v[48:63]
    ds_read_b128 v[96:99], v2 offset:24576
    s_waitcnt lgkmcnt(6)
    v_mfma_f32_32x32x16_bf16 v[48:63], v[104:107], v[200:203], v[48:63]
    ds_read_b128 v[100:103], v2 offset:25600
    s_waitcnt lgkmcnt(6)
    v_mfma_f32_32x32x16_bf16 v[48:63], v[108:111], v[204:207], v[48:63]
    ds_read_b128 v[104:107], v2 offset:26624
    s_waitcnt lgkmcnt(6)
    v_mfma_f32_32x32x16_bf16 v[48:63], v[112:115], v[208:211], v[48:63]
    ds_read_b128 v[108:111], v2 offset:27648
    s_waitcnt lgkmcnt(6)
    v_mfma_f32_32x32x16_bf16 v[48:63], v[116:119], v[212:215], v[48:63]
    ds_read_b128 v[112:115], v2 offset:28672
    s_waitcnt lgkmcnt(6)
    v_mfma_f32_32x32x16_bf16 v[48:63], v[120:123], v[216:219], v[48:63]
    ds_read_b128 v[116:119], v2 offset:29696
    s_waitcnt lgkmcnt(6)
    v_mfma_f32_32x32x16_bf16 v[48:63], v[124:127], v[220:223], v[48:63]
    ds_read_b128 v[120:123], v2 offset:30720
    s_waitcnt lgkmcnt(6)
    v_mfma_f32_32x32x16_bf16 v[48:63], v[96:99], v[224:227], v[48:63]
    ds_read_b128 v[124:127], v2 offset:31744
    s_waitcnt lgkmcnt(0)
    s_waitcnt vmcnt(0)
    s_barrier
    s_mov_b32 s19, 1
    s_atomic_add s19, s[4:5], s52
    v_mfma_f32_32x32x16_bf16 v[48:63], v[100:103], v[228:231], v[48:63]
    buffer_load_dwordx4 v[128:131], v1, s[8:11], s24 offen offset:0 sc1
    v_mfma_f32_32x32x16_bf16 v[48:63], v[104:107], v[232:235], v[48:63]
    v_mfma_f32_32x32x16_bf16 v[48:63], v[108:111], v[236:239], v[48:63]
    buffer_load_dwordx4 v[132:135], v1, s[8:11], s24 offen offset:1024 sc1
    v_mfma_f32_32x32x16_bf16 v[48:63], v[112:115], v[240:243], v[48:63]
    v_mfma_f32_32x32x16_bf16 v[48:63], v[116:119], v[244:247], v[48:63]
    buffer_load_dwordx4 v[136:139], v1, s[8:11], s24 offen offset:2048 sc1
    v_mfma_f32_32x32x16_bf16 v[48:63], v[120:123], v[248:251], v[48:63]
    v_mfma_f32_32x32x16_bf16 v[48:63], v[124:127], v[252:255], v[48:63]
    buffer_load_dwordx4 v[140:143], v1, s[8:11], s24 offen offset:3072 sc1
    s_nop 10
    v_max3_f32 v10, v48, v49, v50
    v_min3_f32 v11, v48, v49, v50
    v_max3_f32 v10, v10, v51, v52
    s_add_u32 s61, s24, 4096
    buffer_load_dwordx4 v[144:147], v1, s[8:11], s61 offen offset:0 sc1
    v_min3_f32 v11, v11, v51, v52
    v_max3_f32 v10, v10, v53, v54
    v_min3_f32 v11, v11, v53, v54
    v_max3_f32 v10, v10, v55, v56
    v_min3_f32 v11, v11, v55, v56
    v_max3_f32 v10, v10, v57, v58
    v_min3_f32 v11, v11, v57, v58
    v_max3_f32 v10, v10, v59, v60
    v_min3_f32 v11, v11, v59, v60
    v_max3_f32 v10, v10, v61, v62
    buffer_load_dwordx4 v[148:151], v1, s[8:11], s61 offen offset:1024 sc1
    v_min3_f32 v11, v11, v61, v62
    v_max_f32 v10, v10, v63
    v_min_f32 v11, v11, v63
    v_mul_f32 v10, -v5, v10
    v_mul_f32 v11, v5, v11
    v_pk_fma_f32 v[96:97], v[48:49], v[4:5], v[10:11] op_sel:[0,1,1] op_sel_hi:[1,1,1] neg_lo:[0,1,0] neg_hi:[0,1,0]
    v_pk_fma_f32 v[48:49], v[48:49], v[4:5], v[10:11] op_sel:[0,1,0] op_sel_hi:[1,1,0]
    v_pk_fma_f32 v[98:99], v[50:51], v[4:5], v[10:11] op_sel:[0,1,1] op_sel_hi:[1,1,1] neg_lo:[0,1,0] neg_hi:[0,1,0]
    v_pk_fma_f32 v[50:51], v[50:51], v[4:5], v[10:11] op_sel:[0,1,0] op_sel_hi:[1,1,0]
    v_exp_f32 v48, v48
    buffer_load_dwordx4 v[152:155], v1, s[8:11], s61 offen offset:2048 sc1
    v_exp_f32 v49, v49
    v_exp_f32 v96, v96
    v_exp_f32 v97, v97
    v_pk_fma_f32 v[100:101], v[52:53], v[4:5], v[10:11] op_sel:[0,1,1] op_sel_hi:[1,1,1] neg_lo:[0,1,0] neg_hi:[0,1,0]
    v_pk_fma_f32 v[52:53], v[52:53], v[4:5], v[10:11] op_sel:[0,1,0] op_sel_hi:[1,1,0]
    v_exp_f32 v50, v50
    v_exp_f32 v51, v51
    v_exp_f32 v98, v98
    v_exp_f32 v99, v99
    v_pk_fma_f32 v[102:103], v[54:55], v[4:5], v[10:11] op_sel:[0,1,1] op_sel_hi:[1,1,1] neg_lo:[0,1,0] neg_hi:[0,1,0]
    buffer_load_dwordx4 v[156:159], v1, s[8:11], s61 offen offset:3072 sc1
    v_pk_fma_f32 v[54:55], v[54:55], v[4:5], v[10:11] op_sel:[0,1,0] op_sel_hi:[1,1,0]
    v_exp_f32 v52, v52
    v_exp_f32 v53, v53
    v_exp_f32 v100, v100
    v_exp_f32 v101, v101
    v_pk_fma_f32 v[104:105], v[56:57], v[4:5], v[10:11] op_sel:[0,1,1] op_sel_hi:[1,1,1] neg_lo:[0,1,0] neg_hi:[0,1,0]
    v_pk_fma_f32 v[56:57], v[56:57], v[4:5], v[10:11] op_sel:[0,1,0] op_sel_hi:[1,1,0]
    v_exp_f32 v54, v54
    v_exp_f32 v55, v55
    v_exp_f32 v102, v102
    s_add_u32 s61, s24, 8192
    buffer_load_dwordx4 v[160:163], v1, s[8:11], s61 offen offset:0 sc1
    v_exp_f32 v103, v103
    v_pk_fma_f32 v[106:107], v[58:59], v[4:5], v[10:11] op_sel:[0,1,1] op_sel_hi:[1,1,1] neg_lo:[0,1,0] neg_hi:[0,1,0]
    v_pk_fma_f32 v[58:59], v[58:59], v[4:5], v[10:11] op_sel:[0,1,0] op_sel_hi:[1,1,0]
    v_exp_f32 v56, v56
    v_exp_f32 v57, v57
    v_exp_f32 v104, v104
    v_exp_f32 v105, v105
    v_pk_fma_f32 v[108:109], v[60:61], v[4:5], v[10:11] op_sel:[0,1,1] op_sel_hi:[1,1,1] neg_lo:[0,1,0] neg_hi:[0,1,0]
    v_pk_fma_f32 v[60:61], v[60:61], v[4:5], v[10:11] op_sel:[0,1,0] op_sel_hi:[1,1,0]
    v_exp_f32 v58, v58
    buffer_load_dwordx4 v[164:167], v1, s[8:11], s61 offen offset:1024 sc1
    v_exp_f32 v59, v59
    v_exp_f32 v106, v106
    v_exp_f32 v107, v107
    v_pk_fma_f32 v[110:111], v[62:63], v[4:5], v[10:11] op_sel:[0,1,1] op_sel_hi:[1,1,1] neg_lo:[0,1,0] neg_hi:[0,1,0]
    v_pk_fma_f32 v[62:63], v[62:63], v[4:5], v[10:11] op_sel:[0,1,0] op_sel_hi:[1,1,0]
    v_exp_f32 v60, v60
    v_exp_f32 v61, v61
    s_mov_b32 s54, 0
    s_atomic_add s54, s[4:5], s52 glc
    v_exp_f32 v108, v108
    buffer_load_dwordx4 v[168:171], v1, s[8:11], s61 offen offset:2048 sc1
    v_exp_f32 v109, v109
    v_exp_f32 v62, v62
    v_exp_f32 v63, v63
    v_exp_f32 v110, v110
    v_exp_f32 v111, v111
    v_pk_add_f32 v[12:13], v[48:49], v[50:51]
    v_pk_add_f32 v[14:15], v[96:97], v[98:99]
    v_pk_add_f32 v[12:13], v[12:13], v[52:53]
    v_pk_add_f32 v[14:15], v[14:15], v[100:101]
    v_pk_add_f32 v[12:13], v[12:13], v[54:55]
    buffer_load_dwordx4 v[172:175], v1, s[8:11], s61 offen offset:3072 sc1
    v_pk_add_f32 v[14:15], v[14:15], v[102:103]
    v_pk_add_f32 v[12:13], v[12:13], v[56:57]
    v_pk_add_f32 v[14:15], v[14:15], v[104:105]
    v_pk_add_f32 v[12:13], v[12:13], v[58:59]
    v_pk_add_f32 v[14:15], v[14:15], v[106:107]
    v_pk_add_f32 v[12:13], v[12:13], v[60:61]
    v_pk_add_f32 v[14:15], v[14:15], v[108:109]
    v_pk_add_f32 v[12:13], v[12:13], v[62:63]
    v_pk_add_f32 v[14:15], v[14:15], v[110:111]
    v_add_f32 v12, v12, v13
    s_add_u32 s61, s24, 12288
    buffer_load_dwordx4 v[176:179], v1, s[8:11], s61 offen offset:0 sc1
    v_add_f32 v14, v14, v15
    v_rcp_f32 v12, v12
    v_rcp_f32 v14, v14
    v_pk_mul_f32 v[48:49], v[48:49], v[12:13] op_sel_hi:[1,0]
    v_pk_mul_f32 v[50:51], v[50:51], v[12:13] op_sel_hi:[1,0]
    v_pk_mul_f32 v[52:53], v[52:53], v[12:13] op_sel_hi:[1,0]
    v_pk_mul_f32 v[54:55], v[54:55], v[12:13] op_sel_hi:[1,0]
    v_cvt_pk_bf16_f32 v112, v48, v49
    v_cvt_pk_bf16_f32 v113, v50, v51
    v_cvt_pk_bf16_f32 v114, v52, v53
    buffer_load_dwordx4 v[180:183], v1, s[8:11], s61 offen offset:1024 sc1
    v_cvt_pk_bf16_f32 v115, v54, v55
    v_pk_mul_f32 v[56:57], v[56:57], v[12:13] op_sel_hi:[1,0]
    v_pk_mul_f32 v[58:59], v[58:59], v[12:13] op_sel_hi:[1,0]
    v_pk_mul_f32 v[60:61], v[60:61], v[12:13] op_sel_hi:[1,0]
    v_pk_mul_f32 v[62:63], v[62:63], v[12:13] op_sel_hi:[1,0]
    v_cvt_pk_bf16_f32 v116, v56, v57
    v_cvt_pk_bf16_f32 v117, v58, v59
    v_cvt_pk_bf16_f32 v118, v60, v61
    v_cvt_pk_bf16_f32 v119, v62, v63
    v_pk_mul_f32 v[96:97], v[96:97], v[14:15] op_sel_hi:[1,0]
    buffer_load_dwordx4 v[184:187], v1, s[8:11], s61 offen offset:2048 sc1
    v_pk_mul_f32 v[98:99], v[98:99], v[14:15] op_sel_hi:[1,0]
    v_pk_mul_f32 v[100:101], v[100:101], v[14:15] op_sel_hi:[1,0]
    v_pk_mul_f32 v[102:103], v[102:103], v[14:15] op_sel_hi:[1,0]
    v_cvt_pk_bf16_f32 v120, v96, v97
    v_cvt_pk_bf16_f32 v121, v98, v99
    v_cvt_pk_bf16_f32 v122, v100, v101
    v_cvt_pk_bf16_f32 v123, v102, v103
    v_pk_mul_f32 v[104:105], v[104:105], v[14:15] op_sel_hi:[1,0]
    v_pk_mul_f32 v[106:107], v[106:107], v[14:15] op_sel_hi:[1,0]
    v_pk_mul_f32 v[108:109], v[108:109], v[14:15] op_sel_hi:[1,0]
    buffer_load_dwordx4 v[188:191], v1, s[8:11], s61 offen offset:3072 sc1
    v_pk_mul_f32 v[110:111], v[110:111], v[14:15] op_sel_hi:[1,0]
    v_cvt_pk_bf16_f32 v124, v104, v105
    v_cvt_pk_bf16_f32 v125, v106, v107
    v_cvt_pk_bf16_f32 v126, v108, v109
    v_cvt_pk_bf16_f32 v127, v110, v111
    s_add_u32 s61, s24, 16384
    buffer_load_dwordx4 v[192:195], v1, s[8:11], s61 offen offset:0 sc1
    buffer_load_dwordx4 v[196:199], v1, s[8:11], s61 offen offset:1024 sc1
    buffer_load_dwordx4 v[200:203], v1, s[8:11], s61 offen offset:2048 sc1
    buffer_load_dwordx4 v[204:207], v1, s[8:11], s61 offen offset:3072 sc1
    v_mov_b32 v64, 0
    v_mov_b32 v65, 0
    v_mov_b32 v66, 0
    v_mov_b32 v67, 0
    ds_write_b128 v2, v[64:67] offset:61440
    ds_write_b128 v2, v[64:67] offset:62464
    s_lshl_b32 s42, s17, 15
    s_lshl_b32 s43, s3, 9
    s_add_u32 s42, s42, s43
    s_add_u32 s47, s42, 22609920
    s_lshl_b32 s42, s17, 12
    s_add_u32 s42, s42, 23724032
    v_and_b32 v7, 0x1ff, v1
    v_and_b32 v6, 0x200, v1
    v_lshl_add_u32 v7, v6, 2, v7
    s_mov_b32 s34, 0x3f80
    s_mov_b32 s35, 0x3f800000
    v_accvgpr_read_b32 v8, a244
    v_accvgpr_read_b32 v9, a241
    v_accvgpr_read_b32 v10, a243
    v_accvgpr_read_b32 v11, a242
    v_mov_b32 v64, 0
    v_mov_b32 v65, 0
    v_mov_b32 v66, 0
    v_mov_b32 v67, 0
    v_mov_b32 v68, 0
    v_mov_b32 v69, 0
    v_mov_b32 v70, 0
    v_mov_b32 v71, 0
    s_waitcnt lgkmcnt(0)
    s_bitcmp1_b32 s54, 4
    s_cbranch_scc1 L_ok_28
    s_mov_b32 s41, 65536
L_spin_27:
    s_mov_b32 s54, 0
    s_atomic_add s54, s[4:5], s52 glc
    s_waitcnt lgkmcnt(0)
    s_bitcmp1_b32 s54, 4
    s_cbranch_scc1 L_ok_28
    s_sub_u32 s41, s41, 1
    s_cbranch_scc0 L_spin_27
L_ok_28:
    buffer_load_dwordx4 v[16:19], v1, s[8:11], s42 offen offset:0 sc1
    buffer_load_dwordx4 v[20:23], v1, s[8:11], s42 offen offset:1024 sc1
    buffer_load_dwordx4 v[24:27], v1, s[8:11], s42 offen offset:2048 sc1
    buffer_load_dwordx4 v[28:31], v1, s[8:11], s42 offen offset:3072 sc1
    buffer_load_dwordx4 v[32:35], v7, s[8:11], s47 offen offset:0 sc1
    s_add_u32 s43, s47, 4096
    buffer_load_dwordx4 v[36:39], v7, s[8:11], s43 offen offset:0 sc1
    s_add_u32 s43, s47, 8192
    buffer_load_dwordx4 v[40:43], v7, s[8:11], s43 offen offset:0 sc1
    s_add_u32 s43, s47, 12288
    buffer_load_dwordx4 v[44:47], v7, s[8:11], s43 offen offset:0 sc1
    s_add_u32 s43, s47, 16384
    buffer_load_dwordx4 v[48:51], v7, s[8:11], s43 offen offset:0 sc1
    s_add_u32 s43, s47, 20480
    buffer_load_dwordx4 v[52:55], v7, s[8:11], s43 offen offset:0 sc1
    s_add_u32 s43, s47, 24576
    buffer_load_dwordx4 v[56:59], v7, s[8:11], s43 offen offset:0 sc1
    s_add_u32 s43, s47, 28672
    buffer_load_dwordx4 v[60:63], v7, s[8:11], s43 offen offset:0 sc1
    s_add_u32 s61, s24, 20480
    buffer_load_dwordx4 v[208:211], v1, s[8:11], s61 offen offset:0 sc1
    buffer_load_dwordx4 v[212:215], v1, s[8:11], s61 offen offset:1024 sc1
    buffer_load_dwordx4 v[216:219], v1, s[8:11], s61 offen offset:2048 sc1
    buffer_load_dwordx4 v[220:223], v1, s[8:11], s61 offen offset:3072 sc1
    s_add_u32 s61, s24, 24576
    buffer_load_dwordx4 v[224:227], v1, s[8:11], s61 offen offset:0 sc1
    buffer_load_dwordx4 v[228:231], v1, s[8:11], s61 offen offset:1024 sc1
    buffer_load_dwordx4 v[232:235], v1, s[8:11], s61 offen offset:2048 sc1
    buffer_load_dwordx4 v[236:239], v1, s[8:11], s61 offen offset:3072 sc1
    s_lshl_b32 s42, s17, 11
    s_add_u32 s42, s42, s20
    s_add_u32 s42, s42, 19464192
    s_lshl_b32 s43, s18, 2
    s_lshr_b32 s52, s17, 2
    s_add_u32 s52, s52, s43
    s_lshl_b32 s52, s52, 7
    s_add_u32 s52, s52, 7741440
    s_waitcnt vmcnt(18)
    v_pk_add_f32 v[16:17], v[16:17], v[20:21]
    v_pk_add_f32 v[18:19], v[18:19], v[22:23]
    s_waitcnt vmcnt(16)
    v_pk_add_f32 v[24:25], v[24:25], v[28:29]
    v_pk_add_f32 v[26:27], v[26:27], v[30:31]
    v_pk_add_f32 v[16:17], v[16:17], v[24:25]
    v_pk_add_f32 v[18:19], v[18:19], v[26:27]
    s_nop 1
    v_permlane32_swap_b32 v16, v18
    v_permlane32_swap_b32 v17, v19
    v_add_f32 v16, v16, v18
    v_add_f32 v17, v17, v19
    s_nop 1
    v_permlane16_swap_b32 v16, v17
    v_add_f32 v16, v16, v17
    v_cvt_pk_bf16_f32 v16, v16, v16
    ds_write_b16 v8, v16
    ds_read_b128 v[96:99], v10 offset:0
    ds_read_b128 v[100:103], v10 offset:16
    ds_read_b128 v[104:107], v10 offset:32
    ds_read_b128 v[108:111], v10 offset:48
    s_waitcnt vmcnt(15)
    v_dot2_f32_bf16 v64, v32, s34, v64
    v_dot2_f32_bf16 v65, v32, s35, v65
    v_dot2_f32_bf16 v66, v33, s34, v66
    v_dot2_f32_bf16 v67, v33, s35, v67
    v_dot2_f32_bf16 v68, v34, s34, v68
    v_dot2_f32_bf16 v69, v34, s35, v69
    v_dot2_f32_bf16 v70, v35, s34, v70
    v_dot2_f32_bf16 v71, v35, s35, v71
    s_waitcnt lgkmcnt(3)
    v_mfma_f32_32x32x16_bf16 v[80:95], v[96:99], v[112:115], 0
    s_waitcnt vmcnt(14)
    v_dot2_f32_bf16 v64, v36, s34, v64
    v_dot2_f32_bf16 v65, v36, s35, v65
    v_dot2_f32_bf16 v66, v37, s34, v66
    v_dot2_f32_bf16 v67, v37, s35, v67
    v_dot2_f32_bf16 v68, v38, s34, v68
    v_dot2_f32_bf16 v69, v38, s35, v69
    v_dot2_f32_bf16 v70, v39, s34, v70
    v_dot2_f32_bf16 v71, v39, s35, v71
    s_waitcnt lgkmcnt(2)
    v_mfma_f32_32x32x16_bf16 v[80:95], v[100:103], v[116:119], v[80:95]
    s_waitcnt vmcnt(13)
    v_dot2_f32_bf16 v64, v40, s34, v64
    v_dot2_f32_bf16 v65, v40, s35, v65
    v_dot2_f32_bf16 v66, v41, s34, v66
    v_dot2_f32_bf16 v67, v41, s35, v67
    v_dot2_f32_bf16 v68, v42, s34, v68
    v_dot2_f32_bf16 v69, v42, s35, v69
    v_dot2_f32_bf16 v70, v43, s34, v70
    v_dot2_f32_bf16 v71, v43, s35, v71
    s_waitcnt lgkmcnt(1)
    v_mfma_f32_32x32x16_bf16 v[80:95], v[104:107], v[120:123], v[80:95]
    s_waitcnt vmcnt(12)
    v_dot2_f32_bf16 v64, v44, s34, v64
    v_dot2_f32_bf16 v65, v44, s35, v65
    v_dot2_f32_bf16 v66, v45, s34, v66
    v_dot2_f32_bf16 v67, v45, s35, v67
    v_dot2_f32_bf16 v68, v46, s34, v68
    v_dot2_f32_bf16 v69, v46, s35, v69
    v_dot2_f32_bf16 v70, v47, s34, v70
    v_dot2_f32_bf16 v71, v47, s35, v71
    s_waitcnt lgkmcnt(0)
    v_mfma_f32_32x32x16_bf16 v[80:95], v[108:111], v[124:127], v[80:95]
    s_waitcnt vmcnt(11)
    v_dot2_f32_bf16 v64, v48, s34, v64
    v_dot2_f32_bf16 v65, v48, s35, v65
    v_dot2_f32_bf16 v66, v49, s34, v66
    v_dot2_f32_bf16 v67, v49, s35, v67
    v_dot2_f32_bf16 v68, v50, s34, v68
    v_dot2_f32_bf16 v69, v50, s35, v69
    v_dot2_f32_bf16 v70, v51, s34, v70
    v_dot2_f32_bf16 v71, v51, s35, v71
    s_waitcnt vmcnt(10)
    v_dot2_f32_bf16 v64, v52, s34, v64
    v_dot2_f32_bf16 v65, v52, s35, v65
    v_dot2_f32_bf16 v66, v53, s34, v66
    v_dot2_f32_bf16 v67, v53, s35, v67
    v_dot2_f32_bf16 v68, v54, s34, v68
    v_dot2_f32_bf16 v69, v54, s35, v69
    v_dot2_f32_bf16 v70, v55, s34, v70
    v_dot2_f32_bf16 v71, v55, s35, v71
    s_waitcnt vmcnt(9)
    v_dot2_f32_bf16 v64, v56, s34, v64
    v_dot2_f32_bf16 v65, v56, s35, v65
    v_dot2_f32_bf16 v66, v57, s34, v66
    v_dot2_f32_bf16 v67, v57, s35, v67
    v_dot2_f32_bf16 v68, v58, s34, v68
    v_dot2_f32_bf16 v69, v58, s35, v69
    v_dot2_f32_bf16 v70, v59, s34, v70
    v_dot2_f32_bf16 v71, v59, s35, v71
    v_add_f32 v80, 0x358637bd, v80
    v_rcp_f32 v80, v80
    s_waitcnt vmcnt(8)
    v_dot2_f32_bf16 v64, v60, s34, v64
    v_dot2_f32_bf16 v65, v60, s35, v65
    v_dot2_f32_bf16 v66, v61, s34, v66
    v_dot2_f32_bf16 v67, v61, s35, v67
    v_dot2_f32_bf16 v68, v62, s34, v68
    v_dot2_f32_bf16 v69, v62, s35, v69
    v_dot2_f32_bf16 v70, v63, s34, v70
    v_dot2_f32_bf16 v71, v63, s35, v71
    v_permlane32_swap_b32 v64, v68
    v_permlane32_swap_b32 v65, v69
    v_permlane32_swap_b32 v66, v70
    v_permlane32_swap_b32 v67, v71
    v_pk_add_f32 v[64:65], v[64:65], v[68:69]
    v_pk_add_f32 v[66:67], v[66:67], v[70:71]
    v_cvt_pk_bf16_f32 v64, v64, v65
    v_cvt_pk_bf16_f32 v65, v66, v67
    ds_write_b64 v9, v[64:65]
    s_waitcnt lgkmcnt(0)
    s_barrier
    ds_read_b128 v[32:35], v11 offset:0
    ds_read_b128 v[36:39], v11 offset:512
    ds_read_b128 v[40:43], v11 offset:1024
    ds_read_b128 v[44:47], v11 offset:1536
    s_waitcnt lgkmcnt(3)
    v_mfma_f32_32x32x16_bf16 v[16:31], v[32:35], v[112:115], 0
    s_waitcnt lgkmcnt(2)
    v_mfma_f32_32x32x16_bf16 v[16:31], v[36:39], v[116:119], v[16:31]
    s_waitcnt lgkmcnt(1)
    v_mfma_f32_32x32x16_bf16 v[16:31], v[40:43], v[120:123], v[16:31]
    s_waitcnt lgkmcnt(0)
    v_mfma_f32_32x32x16_bf16 v[16:31], v[44:47], v[124:127], v[16:31]
    s_nop 11
    v_pk_mul_f32 v[16:17], v[16:17], v[80:81] op_sel_hi:[1,0]
    v_pk_mul_f32 v[18:19], v[18:19], v[80:81] op_sel_hi:[1,0]
    v_pk_mul_f32 v[20:21], v[20:21], v[80:81] op_sel_hi:[1,0]
    v_pk_mul_f32 v[22:23], v[22:23], v[80:81] op_sel_hi:[1,0]
    v_cvt_pk_bf16_f32 v48, v16, v17
    v_cvt_pk_bf16_f32 v49, v18, v19
    v_cvt_pk_bf16_f32 v50, v20, v21
    v_cvt_pk_bf16_f32 v51, v22, v23
    buffer_store_dwordx4 v[48:51], v1, s[8:11], s42 offen offset:0 sc1
    v_pk_mul_f32 v[24:25], v[24:25], v[80:81] op_sel_hi:[1,0]
    v_pk_mul_f32 v[26:27], v[26:27], v[80:81] op_sel_hi:[1,0]
    v_pk_mul_f32 v[28:29], v[28:29], v[80:81] op_sel_hi:[1,0]
    v_pk_mul_f32 v[30:31], v[30:31], v[80:81] op_sel_hi:[1,0]
    v_cvt_pk_bf16_f32 v52, v24, v25
    v_cvt_pk_bf16_f32 v53, v26, v27
    v_cvt_pk_bf16_f32 v54, v28, v29
    v_cvt_pk_bf16_f32 v55, v30, v31
    buffer_store_dwordx4 v[52:55], v1, s[8:11], s42 offen offset:1024 sc1
    s_lshl_b32 s42, s28, 15
    s_lshl_b32 s43, s29, 11
    s_add_u32 s42, s42, s43
    s_add_u32 s42, s42, 13172736
    buffer_load_dwordx4 v[8:11], v1, s[8:11], s42 offen sc1
    buffer_load_dwordx4 v[12:15], v1, s[8:11], s42 offen offset:1024 sc1
    s_waitcnt vmcnt(2)
    s_mov_b32 s19, 1
    s_atomic_add s19, s[4:5], s52
    s_add_u32 s61, s24, 28672
    buffer_load_dwordx4 v[240:243], v1, s[8:11], s61 offen offset:0 sc1
    buffer_load_dwordx4 v[244:247], v1, s[8:11], s61 offen offset:1024 sc1
    buffer_load_dwordx4 v[248:251], v1, s[8:11], s61 offen offset:2048 sc1
    buffer_load_dwordx4 v[252:255], v1, s[8:11], s61 offen offset:3072 sc1
    s_add_u32 m0, s26, 65536
    s_add_u32 s40, s58, 65536
    buffer_load_dwordx4 v1, s[8:11], s40 offen offset:0 sc1 lds
    buffer_load_dwordx4 v1, s[8:11], s40 offen offset:1024 sc1 lds
    buffer_load_dwordx4 v1, s[8:11], s40 offen offset:2048 sc1 lds
    buffer_load_dwordx4 v1, s[8:11], s40 offen offset:3072 sc1 lds
    s_add_u32 m0, s26, 81920
    s_add_u32 s40, s58, 81920
    buffer_load_dwordx4 v1, s[8:11], s40 offen offset:0 sc1 lds
    buffer_load_dwordx4 v1, s[8:11], s40 offen offset:1024 sc1 lds
    buffer_load_dwordx4 v1, s[8:11], s40 offen offset:2048 sc1 lds
    buffer_load_dwordx4 v1, s[8:11], s40 offen offset:3072 sc1 lds
    s_waitcnt vmcnt(13)
    v_lshlrev_b32 v16, 16, v8
    v_and_b32 v17, 0xffff0000, v8
    v_lshlrev_b32 v18, 16, v9
    v_and_b32 v19, 0xffff0000, v9
    v_lshlrev_b32 v20, 16, v10
    v_and_b32 v21, 0xffff0000, v10
    v_lshlrev_b32 v22, 16, v11
    v_and_b32 v23, 0xffff0000, v11
    s_waitcnt vmcnt(12)
    v_lshlrev_b32 v24, 16, v12
    v_and_b32 v25, 0xffff0000, v12
    v_lshlrev_b32 v26, 16, v13
    v_and_b32 v27, 0xffff0000, v13
    v_lshlrev_b32 v28, 16, v14
    v_and_b32 v29, 0xffff0000, v14
    v_lshlrev_b32 v30, 16, v15
    v_and_b32 v31, 0xffff0000, v15
    s_lshl_b32 s42, s28, 2
    s_add_u32 s42, s42, s3
    s_lshl_b32 s42, s42, 7
    s_add_u32 s52, s42, 7741440
    s_lshl_b32 s47, s28, 15
    s_lshl_b32 s43, s3, 13
    s_add_u32 s47, s47, s43
    s_lshl_b32 s42, s28, 15
    s_lshl_b32 s43, s29, 11
    s_add_u32 s42, s42, s43
    s_add_u32 s42, s42, 15269888
    v_accvgpr_read_b32 v6, a237
    s_lshl_b32 s46, s28, 12
    s_lshl_b32 s43, s29, 8
    s_add_u32 s46, s46, s43
    s_add_u32 s46, s46, 8716288
    v_accvgpr_read_b32 v7, a240
    s_mov_b32 s54, 0
    s_atomic_add s54, s[4:5], s52 glc
    s_waitcnt lgkmcnt(0)
    s_bitcmp1_b32 s54, 2
    s_cbranch_scc1 L_ok_30
    s_mov_b32 s41, 65536
L_spin_29:
    s_mov_b32 s54, 0
    s_atomic_add s54, s[4:5], s52 glc
    s_waitcnt lgkmcnt(0)
    s_bitcmp1_b32 s54, 2
    s_cbranch_scc1 L_ok_30
    s_sub_u32 s41, s41, 1
    s_cbranch_scc0 L_spin_29
L_ok_30:
    s_add_u32 m0, s27, 98304
    s_add_u32 s40, s47, 19464192
    buffer_load_dwordx4 v1, s[8:11], s40 offen offset:0 sc1 lds
    buffer_load_dwordx4 v1, s[8:11], s40 offen offset:1024 sc1 lds
    buffer_load_dwordx4 v1, s[8:11], s40 offen offset:2048 sc1 lds
    buffer_load_dwordx4 v1, s[8:11], s40 offen offset:3072 sc1 lds
    s_add_u32 m0, s27, 102400
    s_add_u32 s40, s47, 19468288
    buffer_load_dwordx4 v1, s[8:11], s40 offen offset:0 sc1 lds
    buffer_load_dwordx4 v1, s[8:11], s40 offen offset:1024 sc1 lds
    buffer_load_dwordx4 v1, s[8:11], s40 offen offset:2048 sc1 lds
    buffer_load_dwordx4 v1, s[8:11], s40 offen offset:3072 sc1 lds
    s_waitcnt vmcnt(0)
    s_barrier
    ds_read_b128 v[80:83], v2 offset:32768
    ds_read_b128 v[84:87], v2 offset:33792
    ds_read_b128 v[88:91], v2 offset:34816
    ds_read_b128 v[92:95], v2 offset:35840
    ds_read_b128 v[96:99], v2 offset:36864
    ds_read_b128 v[100:103], v2 offset:37888
    ds_read_b128 v[104:107], v2 offset:38912
    s_waitcnt lgkmcnt(6)
    v_mfma_f32_32x32x16_bf16 v[16:31], v[128:131], v[80:83], v[16:31]
    ds_read_b128 v[108:111], v2 offset:39936
    s_waitcnt lgkmcnt(6)
    v_mfma_f32_32x32x16_bf16 v[16:31], v[132:135], v[84:87], v[16:31]
    ds_read_b128 v[80:83], v2 offset:49152
    s_waitcnt lgkmcnt(6)
    v_mfma_f32_32x32x16_bf16 v[16:31], v[136:139], v[88:91], v[16:31]
    ds_read_b128 v[84:87], v2 offset:50176
    s_waitcnt lgkmcnt(6)
    v_mfma_f32_32x32x16_bf16 v[16:31], v[140:143], v[92:95], v[16:31]
    ds_read_b128 v[88:91], v2 offset:51200
    s_waitcnt lgkmcnt(6)
    v_mfma_f32_32x32x16_bf16 v[16:31], v[144:147], v[96:99], v[16:31]
    ds_read_b128 v[92:95], v2 offset:52224
    s_waitcnt lgkmcnt(6)
    v_mfma_f32_32x32x16_bf16 v[16:31], v[148:151], v[100:103], v[16:31]
    ds_read_b128 v[96:99], v2 offset:53248
    s_waitcnt lgkmcnt(6)
    v_mfma_f32_32x32x16_bf16 v[16:31], v[152:155], v[104:107], v[16:31]
    ds_read_b128 v[100:103], v2 offset:54272
    s_waitcnt lgkmcnt(6)
    v_mfma_f32_32x32x16_bf16 v[16:31], v[156:159], v[108:111], v[16:31]
    ds_read_b128 v[104:107], v2 offset:55296
    s_waitcnt lgkmcnt(6)
    v_mfma_f32_32x32x16_bf16 v[16:31], v[160:163], v[80:83], v[16:31]
    ds_read_b128 v[108:111], v2 offset:56320
    s_waitcnt lgkmcnt(6)
    v_mfma_f32_32x32x16_bf16 v[16:31], v[164:167], v[84:87], v[16:31]
    ds_read_b128 v[80:83], v3 offset:0
    s_waitcnt lgkmcnt(6)
    v_mfma_f32_32x32x16_bf16 v[16:31], v[168:171], v[88:91], v[16:31]
    ds_read_b128 v[84:87], v3 offset:1024
    s_waitcnt lgkmcnt(6)
    v_mfma_f32_32x32x16_bf16 v[16:31], v[172:175], v[92:95], v[16:31]
    ds_read_b128 v[88:91], v3 offset:2048
    s_waitcnt lgkmcnt(6)
    v_mfma_f32_32x32x16_bf16 v[16:31], v[176:179], v[96:99], v[16:31]
    ds_read_b128 v[92:95], v3 offset:3072
    s_waitcnt lgkmcnt(6)
    v_mfma_f32_32x32x16_bf16 v[16:31], v[180:183], v[100:103], v[16:31]
    ds_read_b128 v[96:99], v3 offset:4096
    s_waitcnt lgkmcnt(6)
    v_mfma_f32_32x32x16_bf16 v[16:31], v[184:187], v[104:107], v[16:31]
    ds_read_b128 v[100:103], v3 offset:5120
    s_waitcnt lgkmcnt(6)
    v_mfma_f32_32x32x16_bf16 v[16:31], v[188:191], v[108:111], v[16:31]
    ds_read_b128 v[104:107], v3 offset:6144
    s_waitcnt lgkmcnt(6)
    v_mfma_f32_32x32x16_bf16 v[16:31], v[192:195], v[80:83], v[16:31]
    ds_read_b128 v[108:111], v3 offset:7168
    s_waitcnt lgkmcnt(6)
    v_mfma_f32_32x32x16_bf16 v[16:31], v[196:199], v[84:87], v[16:31]
    ds_read_b128 v[80:83], v3 offset:16384
    s_waitcnt lgkmcnt(6)
    v_mfma_f32_32x32x16_bf16 v[16:31], v[200:203], v[88:91], v[16:31]
    ds_read_b128 v[84:87], v3 offset:17408
    s_waitcnt lgkmcnt(6)
    v_mfma_f32_32x32x16_bf16 v[16:31], v[204:207], v[92:95], v[16:31]
    ds_read_b128 v[88:91], v3 offset:18432
    s_waitcnt lgkmcnt(6)
    v_mfma_f32_32x32x16_bf16 v[16:31], v[208:211], v[96:99], v[16:31]
    ds_read_b128 v[92:95], v3 offset:19456
    s_waitcnt lgkmcnt(6)
    v_mfma_f32_32x32x16_bf16 v[16:31], v[212:215], v[100:103], v[16:31]
    ds_read_b128 v[96:99], v3 offset:20480
    s_waitcnt lgkmcnt(6)
    v_mfma_f32_32x32x16_bf16 v[16:31], v[216:219], v[104:107], v[16:31]
    ds_read_b128 v[100:103], v3 offset:21504
    s_waitcnt lgkmcnt(6)
    v_mfma_f32_32x32x16_bf16 v[16:31], v[220:223], v[108:111], v[16:31]
    ds_read_b128 v[104:107], v3 offset:22528
    s_waitcnt lgkmcnt(6)
    v_mfma_f32_32x32x16_bf16 v[16:31], v[224:227], v[80:83], v[16:31]
    ds_read_b128 v[108:111], v3 offset:23552
    s_waitcnt lgkmcnt(6)
    v_mfma_f32_32x32x16_bf16 v[16:31], v[228:231], v[84:87], v[16:31]
    s_waitcnt lgkmcnt(5)
    v_mfma_f32_32x32x16_bf16 v[16:31], v[232:235], v[88:91], v[16:31]
    s_waitcnt lgkmcnt(4)
    v_mfma_f32_32x32x16_bf16 v[16:31], v[236:239], v[92:95], v[16:31]
    s_waitcnt lgkmcnt(3)
    v_mfma_f32_32x32x16_bf16 v[16:31], v[240:243], v[96:99], v[16:31]
    s_waitcnt lgkmcnt(2)
    v_mfma_f32_32x32x16_bf16 v[16:31], v[244:247], v[100:103], v[16:31]
    s_waitcnt lgkmcnt(1)
    v_mfma_f32_32x32x16_bf16 v[16:31], v[248:251], v[104:107], v[16:31]
    s_waitcnt lgkmcnt(0)
    v_mfma_f32_32x32x16_bf16 v[16:31], v[252:255], v[108:111], v[16:31]
    s_barrier
    s_nop 10
    v_cvt_pk_bf16_f32 v32, v16, v17
    v_cvt_pk_bf16_f32 v33, v18, v19
    v_cvt_pk_bf16_f32 v34, v20, v21
    v_cvt_pk_bf16_f32 v35, v22, v23
    buffer_store_dwordx4 v[32:35], v7, s[8:11], s42 offen offset:0 sc1
    v_cvt_pk_bf16_f32 v36, v24, v25
    v_cvt_pk_bf16_f32 v37, v26, v27
    v_cvt_pk_bf16_f32 v38, v28, v29
    v_cvt_pk_bf16_f32 v39, v30, v31
    buffer_store_dwordx4 v[36:39], v7, s[8:11], s42 offen offset:512 sc1
    v_pk_add_f32 v[40:41], v[16:17], v[18:19]
    v_pk_mul_f32 v[42:43], v[16:17], v[16:17]
    v_pk_fma_f32 v[42:43], v[18:19], v[18:19], v[42:43]
    v_pk_add_f32 v[40:41], v[40:41], v[20:21]
    v_pk_fma_f32 v[42:43], v[20:21], v[20:21], v[42:43]
    v_pk_add_f32 v[40:41], v[40:41], v[22:23]
    v_pk_fma_f32 v[42:43], v[22:23], v[22:23], v[42:43]
    v_pk_add_f32 v[40:41], v[40:41], v[24:25]
    v_pk_fma_f32 v[42:43], v[24:25], v[24:25], v[42:43]
    v_pk_add_f32 v[40:41], v[40:41], v[26:27]
    v_pk_fma_f32 v[42:43], v[26:27], v[26:27], v[42:43]
    v_pk_add_f32 v[40:41], v[40:41], v[28:29]
    v_pk_fma_f32 v[42:43], v[28:29], v[28:29], v[42:43]
    v_pk_add_f32 v[40:41], v[40:41], v[30:31]
    v_pk_fma_f32 v[42:43], v[30:31], v[30:31], v[42:43]
    v_add_f32 v40, v40, v41
    v_add_f32 v41, v42, v43
    s_nop 1
    v_permlane32_swap_b32 v40, v41
    v_add_f32 v40, v40, v41
    buffer_store_dword v40, v6, s[8:11], s46 offen sc1
    s_lshl_b32 s53, s3, 13
    s_add_u32 s53, s53, s23
    s_lshl_b32 s42, s28, 7
    s_add_u32 s42, s42, 7626752
    s_waitcnt vmcnt(0)
    s_mov_b32 s19, 1
    s_atomic_add s19, s[4:5], s42
    s_add_u32 m0, s27, 98304
    s_add_u32 s40, s53, 98304
    buffer_load_dwordx4 v1, s[8:11], s40 offen offset:0 sc1 lds
    buffer_load_dwordx4 v1, s[8:11], s40 offen offset:1024 sc1 lds
    buffer_load_dwordx4 v1, s[8:11], s40 offen offset:2048 sc1 lds
    buffer_load_dwordx4 v1, s[8:11], s40 offen offset:3072 sc1 lds
    s_add_u32 m0, s27, 102400
    s_add_u32 s40, s53, 102400
    buffer_load_dwordx4 v1, s[8:11], s40 offen offset:0 sc1 lds
    buffer_load_dwordx4 v1, s[8:11], s40 offen offset:1024 sc1 lds
    buffer_load_dwordx4 v1, s[8:11], s40 offen offset:2048 sc1 lds
    buffer_load_dwordx4 v1, s[8:11], s40 offen offset:3072 sc1 lds
    s_lshl_b32 s42, s18, 7
    s_add_u32 s52, s42, 7626752
    s_add_u32 s47, s20, 15269888
    s_mul_i32 s42, s18, 112
    s_mul_i32 s46, s17, 7
    s_add_u32 s42, s42, s46
    s_lshl_b32 s42, s42, 10
    s_add_u32 s34, s42, 31129600
    s_add_u32 s35, s34, 4096
    s_lshl_b32 s42, s18, 2
    s_lshr_b32 s43, s17, 2
    s_add_u32 s42, s42, s43
    s_lshl_b32 s42, s42, 7
    s_add_u32 s49, s42, 7675904
    s_and_b32 s42, s30, -2
    s_lshl_b32 s42, s42, 2
    s_add_u32 s42, s42, s3
    s_lshl_b32 s42, s42, 7
    s_add_u32 s48, s42, 7675904
    s_add_u32 s37, s48, 512
    s_mul_i32 s50, s32, 112
    s_mul_i32 s43, s3, 28
    s_add_u32 s50, s50, s43
    s_lshl_b32 s50, s50, 10
    s_add_u32 s50, s50, 31129600
    s_mul_i32 s51, s33, 112
    s_mul_i32 s43, s3, 28
    s_add_u32 s51, s51, s43
    s_lshl_b32 s51, s51, 10
    s_add_u32 s51, s51, 31129600
    s_lshl_b32 s36, s30, 15
    s_lshl_b32 s43, s31, 11
    s_add_u32 s36, s36, s43
    s_add_u32 s36, s36, 15269888
    s_add_u32 s46, s23, s26
    ds_read_b128 v[64:67], v1 offset:0
    ds_read_b128 v[68:71], v1 offset:1024
    ds_read_b128 v[72:75], v1 offset:32768
    ds_read_b128 v[76:79], v1 offset:33792
    ds_read_b128 v[80:83], v2 offset:0
    ds_read_b128 v[84:87], v2 offset:1024
    ds_read_b128 v[88:91], v1 offset:2048
    s_mov_b32 s54, 0
    s_atomic_add s54, s[4:5], s52 glc
    s_waitcnt lgkmcnt(0)
    s_bitcmp1_b32 s54, 4
    s_cbranch_scc1 L_ok_32
    s_mov_b32 s41, 65536
L_spin_31:
    s_mov_b32 s54, 0
    s_atomic_add s54, s[4:5], s52 glc
    s_waitcnt lgkmcnt(0)
    s_bitcmp1_b32 s54, 4
    s_cbranch_scc1 L_ok_32
    s_sub_u32 s41, s41, 1
    s_cbranch_scc0 L_spin_31
L_ok_32:
    buffer_load_dwordx4 v[128:131], v1, s[8:11], s47 offen offset:0 sc1
    buffer_load_dwordx4 v[132:135], v1, s[8:11], s47 offen offset:1024 sc1
    buffer_load_dwordx4 v[136:139], v1, s[8:11], s47 offen offset:2048 sc1
    buffer_load_dwordx4 v[140:143], v1, s[8:11], s47 offen offset:3072 sc1
    s_add_u32 s39, s47, 4096
    buffer_load_dwordx4 v[144:147], v1, s[8:11], s39 offen offset:0 sc1
    buffer_load_dwordx4 v[148:151], v1, s[8:11], s39 offen offset:1024 sc1
    buffer_load_dwordx4 v[152:155], v1, s[8:11], s39 offen offset:2048 sc1
    buffer_load_dwordx4 v[156:159], v1, s[8:11], s39 offen offset:3072 sc1
    s_add_u32 s39, s47, 8192
    buffer_load_dwordx4 v[160:163], v1, s[8:11], s39 offen offset:0 sc1
    buffer_load_dwordx4 v[164:167], v1, s[8:11], s39 offen offset:1024 sc1
    buffer_load_dwordx4 v[168:171], v1, s[8:11], s39 offen offset:2048 sc1
    buffer_load_dwordx4 v[172:175], v1, s[8:11], s39 offen offset:3072 sc1
    s_add_u32 s39, s47, 12288
    buffer_load_dwordx4 v[176:179], v1, s[8:11], s39 offen offset:0 sc1
    buffer_load_dwordx4 v[180:183], v1, s[8:11], s39 offen offset:1024 sc1
    s_waitcnt vmcnt(13)
    v_mfma_f32_16x16x32_bf16 v[16:19], v[64:67], v[128:131], 0
    ds_read_b128 v[92:95], v1 offset:3072
    s_waitcnt vmcnt(12)
    v_mfma_f32_16x16x32_bf16 v[20:23], v[64:67], v[132:135], 0
    buffer_load_dwordx4 v[184:187], v1, s[8:11], s39 offen offset:2048 sc1
    v_mfma_f32_16x16x32_bf16 v[28:31], v[68:71], v[132:135], 0
    ds_read_b128 v[64:67], v1 offset:34816
    v_mfma_f32_16x16x32_bf16 v[24:27], v[68:71], v[128:131], 0
    v_mfma_f32_16x16x32_bf16 v[32:35], v[72:75], v[128:131], 0
    ds_read_b128 v[68:71], v1 offset:35840
    v_mfma_f32_16x16x32_bf16 v[36:39], v[72:75], v[132:135], 0
    v_mfma_f32_16x16x32_bf16 v[44:47], v[76:79], v[132:135], 0
    ds_read_b128 v[72:75], v2 offset:2048
    v_mfma_f32_16x16x32_bf16 v[40:43], v[76:79], v[128:131], 0
    buffer_load_dwordx4 v[188:191], v1, s[8:11], s39 offen offset:3072 sc1
    v_mfma_f32_16x16x32_bf16 v[48:51], v[80:83], v[128:131], 0
    ds_read_b128 v[76:79], v2 offset:3072
    v_mfma_f32_16x16x32_bf16 v[52:55], v[80:83], v[132:135], 0
    s_add_u32 s42, s21, 8716288
    buffer_load_dwordx4 v[96:99], v1, s[8:11], s42 offen offset:0 sc1
    buffer_load_dwordx4 v[100:103], v1, s[8:11], s42 offen offset:1024 sc1
    buffer_load_dwordx4 v[104:107], v1, s[8:11], s42 offen offset:2048 sc1
    buffer_load_dwordx4 v[108:111], v1, s[8:11], s42 offen offset:3072 sc1
    v_mfma_f32_16x16x32_bf16 v[60:63], v[84:87], v[132:135], 0
    ds_read_b128 v[80:83], v1 offset:4096
    s_waitcnt lgkmcnt(5)
    v_mfma_f32_16x16x32_bf16 v[56:59], v[84:87], v[128:131], 0
    s_waitcnt vmcnt(17)
    v_mfma_f32_16x16x32_bf16 v[16:19], v[88:91], v[136:139], v[16:19]
    ds_read_b128 v[84:87], v1 offset:5120
    s_waitcnt vmcnt(16)
    v_mfma_f32_16x16x32_bf16 v[20:23], v[88:91], v[140:143], v[20:23]
    s_add_u32 s39, s47, 16384
    buffer_load_dwordx4 v[192:195], v1, s[8:11], s39 offen offset:0 sc1
    v_mfma_f32_16x16x32_bf16 v[28:31], v[92:95], v[140:143], v[28:31]
    ds_read_b128 v[88:91], v1 offset:36864
    s_waitcnt lgkmcnt(5)
    v_mfma_f32_16x16x32_bf16 v[24:27], v[92:95], v[136:139], v[24:27]
    v_mfma_f32_16x16x32_bf16 v[32:35], v[64:67], v[136:139], v[32:35]
    ds_read_b128 v[92:95], v1 offset:37888
    v_mfma_f32_16x16x32_bf16 v[36:39], v[64:67], v[140:143], v[36:39]
    v_mfma_f32_16x16x32_bf16 v[44:47], v[68:71], v[140:143], v[44:47]
    ds_read_b128 v[64:67], v2 offset:4096
    s_waitcnt lgkmcnt(5)
    v_mfma_f32_16x16x32_bf16 v[40:43], v[68:71], v[136:139], v[40:43]
    buffer_load_dwordx4 v[196:199], v1, s[8:11], s39 offen offset:1024 sc1
    v_mfma_f32_16x16x32_bf16 v[48:51], v[72:75], v[136:139], v[48:51]
    ds_read_b128 v[68:71], v2 offset:5120
    v_mfma_f32_16x16x32_bf16 v[52:55], v[72:75], v[140:143], v[52:55]
    v_mfma_f32_16x16x32_bf16 v[60:63], v[76:79], v[140:143], v[60:63]
    ds_read_b128 v[72:75], v1 offset:6144
    s_waitcnt lgkmcnt(5)
    v_mfma_f32_16x16x32_bf16 v[56:59], v[76:79], v[136:139], v[56:59]
    s_waitcnt vmcnt(17)
    v_mfma_f32_16x16x32_bf16 v[16:19], v[80:83], v[144:147], v[16:19]
    ds_read_b128 v[76:79], v1 offset:7168
    s_waitcnt vmcnt(16)
    v_mfma_f32_16x16x32_bf16 v[20:23], v[80:83], v[148:151], v[20:23]
    buffer_load_dwordx4 v[200:203], v1, s[8:11], s39 offen offset:2048 sc1
    v_mfma_f32_16x16x32_bf16 v[28:31], v[84:87], v[148:151], v[28:31]
    ds_read_b128 v[80:83], v1 offset:38912
    s_waitcnt lgkmcnt(5)
    v_mfma_f32_16x16x32_bf16 v[24:27], v[84:87], v[144:147], v[24:27]
    v_mfma_f32_16x16x32_bf16 v[32:35], v[88:91], v[144:147], v[32:35]
    ds_read_b128 v[84:87], v1 offset:39936
    v_mfma_f32_16x16x32_bf16 v[36:39], v[88:91], v[148:151], v[36:39]
    v_mfma_f32_16x16x32_bf16 v[44:47], v[92:95], v[148:151], v[44:47]
    ds_read_b128 v[88:91], v2 offset:6144
    s_waitcnt lgkmcnt(5)
    v_mfma_f32_16x16x32_bf16 v[40:43], v[92:95], v[144:147], v[40:43]
    buffer_load_dwordx4 v[204:207], v1, s[8:11], s39 offen offset:3072 sc1
    v_mfma_f32_16x16x32_bf16 v[48:51], v[64:67], v[144:147], v[48:51]
    ds_read_b128 v[92:95], v2 offset:7168
    v_mfma_f32_16x16x32_bf16 v[52:55], v[64:67], v[148:151], v[52:55]
    v_mfma_f32_16x16x32_bf16 v[60:63], v[68:71], v[148:151], v[60:63]
    ds_read_b128 v[64:67], v1 offset:8192
    s_waitcnt lgkmcnt(5)
    v_mfma_f32_16x16x32_bf16 v[56:59], v[68:71], v[144:147], v[56:59]
    s_waitcnt vmcnt(17)
    v_mfma_f32_16x16x32_bf16 v[16:19], v[72:75], v[152:155], v[16:19]
    ds_read_b128 v[68:71], v1 offset:9216
    s_waitcnt vmcnt(16)
    v_mfma_f32_16x16x32_bf16 v[20:23], v[72:75], v[156:159], v[20:23]
    s_add_u32 s39, s47, 20480
    buffer_load_dwordx4 v[208:211], v1, s[8:11], s39 offen offset:0 sc1
    v_mfma_f32_16x16x32_bf16 v[28:31], v[76:79], v[156:159], v[28:31]
    ds_read_b128 v[72:75], v1 offset:40960
    s_waitcnt lgkmcnt(5)
    v_mfma_f32_16x16x32_bf16 v[24:27], v[76:79], v[152:155], v[24:27]
    v_mfma_f32_16x16x32_bf16 v[32:35], v[80:83], v[152:155], v[32:35]
    ds_read_b128 v[76:79], v1 offset:41984
    v_mfma_f32_16x16x32_bf16 v[36:39], v[80:83], v[156:159], v[36:39]
    v_mfma_f32_16x16x32_bf16 v[44:47], v[84:87], v[156:159], v[44:47]
    ds_read_b128 v[80:83], v2 offset:8192
    s_waitcnt lgkmcnt(5)
    v_mfma_f32_16x16x32_bf16 v[40:43], v[84:87], v[152:155], v[40:43]
    buffer_load_dwordx4 v[212:215], v1, s[8:11], s39 offen offset:1024 sc1
    v_mfma_f32_16x16x32_bf16 v[48:51], v[88:91], v[152:155], v[48:51]
    ds_read_b128 v[84:87], v2 offset:9216
    v_mfma_f32_16x16x32_bf16 v[52:55], v[88:91], v[156:159], v[52:55]
    v_mfma_f32_16x16x32_bf16 v[60:63], v[92:95], v[156:159], v[60:63]
    ds_read_b128 v[88:91], v1 offset:10240
    s_waitcnt lgkmcnt(5)
    v_mfma_f32_16x16x32_bf16 v[56:59], v[92:95], v[152:155], v[56:59]
    s_waitcnt vmcnt(17)
    v_mfma_f32_16x16x32_bf16 v[16:19], v[64:67], v[160:163], v[16:19]
    ds_read_b128 v[92:95], v1 offset:11264
    s_waitcnt vmcnt(16)
    v_mfma_f32_16x16x32_bf16 v[20:23], v[64:67], v[164:167], v[20:23]
    buffer_load_dwordx4 v[216:219], v1, s[8:11], s39 offen offset:2048 sc1
    v_and_b32 v9, 16, v1
    v_mfma_f32_16x16x32_bf16 v[28:31], v[68:71], v[164:167], v[28:31]
    ds_read_b128 v[64:67], v1 offset:43008
    s_waitcnt lgkmcnt(5)
    v_mfma_f32_16x16x32_bf16 v[24:27], v[68:71], v[160:163], v[24:27]
    v_lshlrev_b32 v9, 3, v9
    v_mfma_f32_16x16x32_bf16 v[32:35], v[72:75], v[160:163], v[32:35]
    ds_read_b128 v[68:71], v1 offset:44032
    v_bfe_u32 v8, v1, 5, 3
    v_mfma_f32_16x16x32_bf16 v[36:39], v[72:75], v[164:167], v[36:39]
    v_mfma_f32_16x16x32_bf16 v[44:47], v[76:79], v[164:167], v[44:47]
    ds_read_b128 v[72:75], v2 offset:10240
    s_waitcnt lgkmcnt(5)
    v_mfma_f32_16x16x32_bf16 v[40:43], v[76:79], v[160:163], v[40:43]
    buffer_load_dwordx4 v[220:223], v1, s[8:11], s39 offen offset:3072 sc1
    v_lshl_add_u32 v9, v8, 2, v9
    v_mfma_f32_16x16x32_bf16 v[48:51], v[80:83], v[160:163], v[48:51]
    ds_read_b128 v[76:79], v2 offset:11264
    s_waitcnt vmcnt(10)
    v_add_f32 v96, v96, v100
    v_mfma_f32_16x16x32_bf16 v[52:55], v[80:83], v[164:167], v[52:55]
    v_mfma_f32_16x16x32_bf16 v[60:63], v[84:87], v[164:167], v[60:63]
    ds_read_b128 v[80:83], v1 offset:12288
    s_waitcnt lgkmcnt(5)
    v_mfma_f32_16x16x32_bf16 v[56:59], v[84:87], v[160:163], v[56:59]
    s_waitcnt vmcnt(8)
    v_add_f32 v104, v104, v108
    v_mfma_f32_16x16x32_bf16 v[16:19], v[88:91], v[168:171], v[16:19]
    ds_read_b128 v[84:87], v1 offset:13312
    v_mfma_f32_16x16x32_bf16 v[20:23], v[88:91], v[172:175], v[20:23]
    s_add_u32 s39, s47, 24576
    buffer_load_dwordx4 v[224:227], v1, s[8:11], s39 offen offset:0 sc1
    v_add_f32 v97, v97, v101
    v_mfma_f32_16x16x32_bf16 v[28:31], v[92:95], v[172:175], v[28:31]
    ds_read_b128 v[88:91], v1 offset:45056
    s_waitcnt lgkmcnt(5)
    v_mfma_f32_16x16x32_bf16 v[24:27], v[92:95], v[168:171], v[24:27]
    v_add_f32 v105, v105, v109
    v_mfma_f32_16x16x32_bf16 v[32:35], v[64:67], v[168:171], v[32:35]
    ds_read_b128 v[92:95], v1 offset:46080
    v_add_f32 v98, v98, v102
    v_mfma_f32_16x16x32_bf16 v[36:39], v[64:67], v[172:175], v[36:39]
    v_mfma_f32_16x16x32_bf16 v[44:47], v[68:71], v[172:175], v[44:47]
    ds_read_b128 v[64:67], v2 offset:12288
    s_waitcnt lgkmcnt(5)
    v_mfma_f32_16x16x32_bf16 v[40:43], v[68:71], v[168:171], v[40:43]
    buffer_load_dwordx4 v[228:231], v1, s[8:11], s39 offen offset:1024 sc1
    v_add_f32 v106, v106, v110
    v_mfma_f32_16x16x32_bf16 v[48:51], v[72:75], v[168:171], v[48:51]
    ds_read_b128 v[68:71], v2 offset:13312
    v_add_f32 v99, v99, v103
    v_mfma_f32_16x16x32_bf16 v[52:55], v[72:75], v[172:175], v[52:55]
    v_mfma_f32_16x16x32_bf16 v[60:63], v[76:79], v[172:175], v[60:63]
    ds_read_b128 v[72:75], v1 offset:14336
    s_waitcnt lgkmcnt(5)
    v_mfma_f32_16x16x32_bf16 v[56:59], v[76:79], v[168:171], v[56:59]
    v_add_f32 v107, v107, v111
    v_mfma_f32_16x16x32_bf16 v[16:19], v[80:83], v[176:179], v[16:19]
    ds_read_b128 v[76:79], v1 offset:15360
    v_mfma_f32_16x16x32_bf16 v[20:23], v[80:83], v[180:183], v[20:23]
    buffer_load_dwordx4 v[232:235], v1, s[8:11], s39 offen offset:2048 sc1
    v_add_f32 v96, v96, v104
    v_mfma_f32_16x16x32_bf16 v[28:31], v[84:87], v[180:183], v[28:31]
    ds_read_b128 v[80:83], v1 offset:47104
    s_waitcnt lgkmcnt(5)
    v_mfma_f32_16x16x32_bf16 v[24:27], v[84:87], v[176:179], v[24:27]
    v_add_f32 v97, v97, v105
    v_mfma_f32_16x16x32_bf16 v[32:35], v[88:91], v[176:179], v[32:35]
    ds_read_b128 v[84:87], v1 offset:48128
    v_add_f32 v98, v98, v106
    v_mfma_f32_16x16x32_bf16 v[36:39], v[88:91], v[180:183], v[36:39]
    v_mfma_f32_16x16x32_bf16 v[44:47], v[92:95], v[180:183], v[44:47]
    ds_read_b128 v[88:91], v2 offset:14336
    s_waitcnt lgkmcnt(5)
    v_mfma_f32_16x16x32_bf16 v[40:43], v[92:95], v[176:179], v[40:43]
    buffer_load_dwordx4 v[236:239], v1, s[8:11], s39 offen offset:3072 sc1
    v_add_f32 v99, v99, v107
    v_mfma_f32_16x16x32_bf16 v[48:51], v[64:67], v[176:179], v[48:51]
    ds_read_b128 v[92:95], v2 offset:15360
    v_permlane32_swap_b32 v96, v98
    v_mfma_f32_16x16x32_bf16 v[52:55], v[64:67], v[180:183], v[52:55]
    v_mfma_f32_16x16x32_bf16 v[60:63], v[68:71], v[180:183], v[60:63]
    ds_read_b128 v[64:67], v1 offset:16384
    s_waitcnt lgkmcnt(5)
    v_mfma_f32_16x16x32_bf16 v[56:59], v[68:71], v[176:179], v[56:59]
    v_permlane32_swap_b32 v97, v99
    v_mfma_f32_16x16x32_bf16 v[16:19], v[72:75], v[184:187], v[16:19]
    ds_read_b128 v[68:71], v1 offset:17408
    v_mfma_f32_16x16x32_bf16 v[20:23], v[72:75], v[188:191], v[20:23]
    s_add_u32 s39, s47, 28672
    buffer_load_dwordx4 v[240:243], v1, s[8:11], s39 offen offset:0 sc1
    v_add_f32 v96, v96, v98
    v_mfma_f32_16x16x32_bf16 v[28:31], v[76:79], v[188:191], v[28:31]
    ds_read_b128 v[72:75], v1 offset:49152
    s_waitcnt lgkmcnt(5)
    v_mfma_f32_16x16x32_bf16 v[24:27], v[76:79], v[184:187], v[24:27]
    v_add_f32 v97, v97, v99
    v_mfma_f32_16x16x32_bf16 v[32:35], v[80:83], v[184:187], v[32:35]
    ds_read_b128 v[76:79], v1 offset:50176
    v_permlane16_swap_b32 v96, v97
    v_mfma_f32_16x16x32_bf16 v[36:39], v[80:83], v[188:191], v[36:39]
    v_mfma_f32_16x16x32_bf16 v[44:47], v[84:87], v[188:191], v[44:47]
    ds_read_b128 v[80:83], v2 offset:16384
    s_waitcnt lgkmcnt(5)
    v_mfma_f32_16x16x32_bf16 v[40:43], v[84:87], v[184:187], v[40:43]
    buffer_load_dwordx4 v[244:247], v1, s[8:11], s39 offen offset:1024 sc1
    v_add_f32 v96, v96, v97
    v_mfma_f32_16x16x32_bf16 v[48:51], v[88:91], v[184:187], v[48:51]
    ds_read_b128 v[84:87], v2 offset:17408
    v_mov_b32 v97, v96
    v_mfma_f32_16x16x32_bf16 v[52:55], v[88:91], v[188:191], v[52:55]
    v_mfma_f32_16x16x32_bf16 v[60:63], v[92:95], v[188:191], v[60:63]
    ds_read_b128 v[88:91], v1 offset:18432
    s_waitcnt lgkmcnt(5)
    v_mfma_f32_16x16x32_bf16 v[56:59], v[92:95], v[184:187], v[56:59]
    v_permlane16_swap_b32 v96, v97
    s_waitcnt vmcnt(13)
    v_mfma_f32_16x16x32_bf16 v[16:19], v[64:67], v[192:195], v[16:19]
    ds_read_b128 v[92:95], v1 offset:19456
    s_waitcnt vmcnt(12)
    v_mfma_f32_16x16x32_bf16 v[20:23], v[64:67], v[196:199], v[20:23]
    buffer_load_dwordx4 v[248:251], v1, s[8:11], s39 offen offset:2048 sc1
    v_mul_f32 v98, 0x3b000000, v96
    s_barrier
    v_mfma_f32_16x16x32_bf16 v[28:31], v[68:71], v[196:199], v[28:31]
    ds_read_b128 v[64:67], v1 offset:51200
    s_waitcnt lgkmcnt(5)
    v_mfma_f32_16x16x32_bf16 v[24:27], v[68:71], v[192:195], v[24:27]
    v_mul_f32 v97, 0x3b000000, v97
    v_mfma_f32_16x16x32_bf16 v[32:35], v[72:75], v[192:195], v[32:35]
    ds_read_b128 v[68:71], v1 offset:52224
    v_fma_f32 v97, -v98, v98, v97
    v_mfma_f32_16x16x32_bf16 v[36:39], v[72:75], v[196:199], v[36:39]
    v_mfma_f32_16x16x32_bf16 v[44:47], v[76:79], v[196:199], v[44:47]
    ds_read_b128 v[72:75], v2 offset:18432
    s_waitcnt lgkmcnt(5)
    v_mfma_f32_16x16x32_bf16 v[40:43], v[76:79], v[192:195], v[40:43]
    buffer_load_dwordx4 v[252:255], v1, s[8:11], s39 offen offset:3072 sc1
    v_max_f32 v97, 0, v97
    v_mfma_f32_16x16x32_bf16 v[48:51], v[80:83], v[192:195], v[48:51]
    ds_read_b128 v[76:79], v2 offset:19456
    v_add_f32 v97, 0x3727c5ac, v97
    v_mfma_f32_16x16x32_bf16 v[52:55], v[80:83], v[196:199], v[52:55]
    v_mfma_f32_16x16x32_bf16 v[60:63], v[84:87], v[196:199], v[60:63]
    ds_read_b128 v[80:83], v1 offset:20480
    s_waitcnt lgkmcnt(5)
    v_mfma_f32_16x16x32_bf16 v[56:59], v[84:87], v[192:195], v[56:59]
    v_rsq_f32 v96, v97
    s_waitcnt vmcnt(13)
    v_mfma_f32_16x16x32_bf16 v[16:19], v[88:91], v[200:203], v[16:19]
    ds_read_b128 v[84:87], v1 offset:21504
    s_waitcnt vmcnt(12)
    v_mfma_f32_16x16x32_bf16 v[20:23], v[88:91], v[204:207], v[20:23]
    ds_bpermute_b32 v10, v9, v96
    s_add_u32 m0, s27, 106496
    s_add_u32 s40, s53, 131072
    buffer_load_dwordx4 v1, s[8:11], s40 offen offset:0 sc1 lds
    v_mfma_f32_16x16x32_bf16 v[28:31], v[92:95], v[204:207], v[28:31]
    ds_read_b128 v[88:91], v1 offset:53248
    s_waitcnt lgkmcnt(6)
    v_mfma_f32_16x16x32_bf16 v[24:27], v[92:95], v[200:203], v[24:27]
    ds_bpermute_b32 v11, v9, v96 offset:32
    v_mfma_f32_16x16x32_bf16 v[32:35], v[64:67], v[200:203], v[32:35]
    ds_read_b128 v[92:95], v1 offset:54272
    v_mfma_f32_16x16x32_bf16 v[36:39], v[64:67], v[204:207], v[36:39]
    ds_bpermute_b32 v12, v9, v98
    buffer_load_dwordx4 v1, s[8:11], s40 offen offset:1024 sc1 lds
    v_mfma_f32_16x16x32_bf16 v[44:47], v[68:71], v[204:207], v[44:47]
    ds_read_b128 v[64:67], v2 offset:20480
    s_waitcnt lgkmcnt(8)
    v_mfma_f32_16x16x32_bf16 v[40:43], v[68:71], v[200:203], v[40:43]
    ds_bpermute_b32 v13, v9, v98 offset:32
    v_mfma_f32_16x16x32_bf16 v[48:51], v[72:75], v[200:203], v[48:51]
    ds_read_b128 v[68:71], v2 offset:21504
    v_mfma_f32_16x16x32_bf16 v[52:55], v[72:75], v[204:207], v[52:55]
    buffer_load_dwordx4 v1, s[8:11], s40 offen offset:2048 sc1 lds
    v_mfma_f32_16x16x32_bf16 v[60:63], v[76:79], v[204:207], v[60:63]
    ds_read_b128 v[72:75], v1 offset:22528
    s_waitcnt lgkmcnt(9)
    v_mfma_f32_16x16x32_bf16 v[56:59], v[76:79], v[200:203], v[56:59]
    s_waitcnt vmcnt(14)
    v_mfma_f32_16x16x32_bf16 v[16:19], v[80:83], v[208:211], v[16:19]
    ds_read_b128 v[76:79], v1 offset:23552
    s_waitcnt vmcnt(13)
    v_mfma_f32_16x16x32_bf16 v[20:23], v[80:83], v[212:215], v[20:23]
    buffer_load_dwordx4 v1, s[8:11], s40 offen offset:3072 sc1 lds
    v_mfma_f32_16x16x32_bf16 v[28:31], v[84:87], v[212:215], v[28:31]
    ds_read_b128 v[80:83], v1 offset:55296
    s_waitcnt lgkmcnt(7)
    v_mfma_f32_16x16x32_bf16 v[24:27], v[84:87], v[208:211], v[24:27]
    v_mfma_f32_16x16x32_bf16 v[32:35], v[88:91], v[208:211], v[32:35]
    ds_read_b128 v[84:87], v1 offset:56320
    v_mul_f32 v10, v10, v10
    v_mfma_f32_16x16x32_bf16 v[36:39], v[88:91], v[212:215], v[36:39]
    v_mul_f32 v11, v11, v11
    s_add_u32 m0, s27, 110592
    s_add_u32 s40, s53, 135168
    buffer_load_dwordx4 v1, s[8:11], s40 offen offset:0 sc1 lds
    v_mfma_f32_16x16x32_bf16 v[44:47], v[92:95], v[212:215], v[44:47]
    ds_read_b128 v[88:91], v2 offset:22528
    s_waitcnt lgkmcnt(5)
    v_mfma_f32_16x16x32_bf16 v[40:43], v[92:95], v[208:211], v[40:43]
    s_mov_b64 s[44:45], 0xffff
    v_mfma_f32_16x16x32_bf16 v[48:51], v[64:67], v[208:211], v[48:51]
    ds_read_b128 v[92:95], v2 offset:23552
    v_mfma_f32_16x16x32_bf16 v[52:55], v[64:67], v[212:215], v[52:55]
    s_mov_b64 s[6:7], 0xffff0000
    v_cvt_pk_bf16_f32 v14, v12, v12
    buffer_load_dwordx4 v1, s[8:11], s40 offen offset:1024 sc1 lds
    v_mfma_f32_16x16x32_bf16 v[60:63], v[68:71], v[212:215], v[60:63]
    ds_read_b128 v[64:67], v1 offset:24576
    s_waitcnt lgkmcnt(5)
    v_mfma_f32_16x16x32_bf16 v[56:59], v[68:71], v[208:211], v[56:59]
    v_lshlrev_b32 v15, 16, v14
    s_waitcnt vmcnt(15)
    v_mfma_f32_16x16x32_bf16 v[16:19], v[72:75], v[216:219], v[16:19]
    ds_read_b128 v[68:71], v1 offset:25600
    v_sub_f32 v15, v12, v15
    s_waitcnt vmcnt(14)
    v_mfma_f32_16x16x32_bf16 v[20:23], v[72:75], v[220:223], v[20:23]
    v_cvt_pk_bf16_f32 v15, v15, 0
    buffer_load_dwordx4 v1, s[8:11], s40 offen offset:2048 sc1 lds
    v_mfma_f32_16x16x32_bf16 v[28:31], v[76:79], v[220:223], v[28:31]
    ds_read_b128 v[72:75], v1 offset:57344
    s_waitcnt lgkmcnt(5)
    v_mfma_f32_16x16x32_bf16 v[24:27], v[76:79], v[216:219], v[24:27]
    v_cndmask_b32 v120, 0, v14, s[44:45]
    v_mfma_f32_16x16x32_bf16 v[32:35], v[80:83], v[216:219], v[32:35]
    ds_read_b128 v[76:79], v1 offset:58368
    v_cndmask_b32 v121, 0, v15, s[44:45]
    v_mfma_f32_16x16x32_bf16 v[36:39], v[80:83], v[220:223], v[36:39]
    v_cndmask_b32 v124, 0, v14, s[6:7]
    buffer_load_dwordx4 v1, s[8:11], s40 offen offset:3072 sc1 lds
    v_mfma_f32_16x16x32_bf16 v[44:47], v[84:87], v[220:223], v[44:47]
    ds_read_b128 v[80:83], v2 offset:24576
    s_waitcnt lgkmcnt(5)
    v_mfma_f32_16x16x32_bf16 v[40:43], v[84:87], v[216:219], v[40:43]
    v_cndmask_b32 v125, 0, v15, s[6:7]
    v_mfma_f32_16x16x32_bf16 v[48:51], v[88:91], v[216:219], v[48:51]
    ds_read_b128 v[84:87], v2 offset:25600
    v_cvt_pk_bf16_f32 v14, v13, v13
    v_mfma_f32_16x16x32_bf16 v[52:55], v[88:91], v[220:223], v[52:55]
    v_lshlrev_b32 v15, 16, v14
    s_add_u32 m0, s26, 0
    s_add_u32 s40, s46, 163840
    buffer_load_dwordx4 v1, s[8:11], s40 offen offset:0 sc1 lds
    v_mfma_f32_16x16x32_bf16 v[60:63], v[92:95], v[220:223], v[60:63]
    ds_read_b128 v[88:91], v1 offset:26624
    s_waitcnt lgkmcnt(5)
    v_mfma_f32_16x16x32_bf16 v[56:59], v[92:95], v[216:219], v[56:59]
    v_sub_f32 v15, v13, v15
    s_waitcnt vmcnt(16)
    v_mfma_f32_16x16x32_bf16 v[16:19], v[64:67], v[224:227], v[16:19]
    ds_read_b128 v[92:95], v1 offset:27648
    v_cvt_pk_bf16_f32 v15, v15, 0
    s_waitcnt vmcnt(15)
    v_mfma_f32_16x16x32_bf16 v[20:23], v[64:67], v[228:231], v[20:23]
    v_cndmask_b32 v122, 0, v14, s[44:45]
    buffer_load_dwordx4 v1, s[8:11], s40 offen offset:1024 sc1 lds
    v_mfma_f32_16x16x32_bf16 v[28:31], v[68:71], v[228:231], v[28:31]
    ds_read_b128 v[64:67], v1 offset:59392
    s_waitcnt lgkmcnt(5)
    v_mfma_f32_16x16x32_bf16 v[24:27], v[68:71], v[224:227], v[24:27]
    v_cndmask_b32 v123, 0, v15, s[44:45]
    v_mfma_f32_16x16x32_bf16 v[32:35], v[72:75], v[224:227], v[32:35]
    ds_read_b128 v[68:71], v1 offset:60416
    v_cndmask_b32 v126, 0, v14, s[6:7]
    v_mfma_f32_16x16x32_bf16 v[36:39], v[72:75], v[228:231], v[36:39]
    v_cndmask_b32 v127, 0, v15, s[6:7]
    buffer_load_dwordx4 v1, s[8:11], s40 offen offset:2048 sc1 lds
    v_mfma_f32_16x16x32_bf16 v[44:47], v[76:79], v[228:231], v[44:47]
    ds_read_b128 v[72:75], v2 offset:26624
    s_waitcnt lgkmcnt(5)
    v_mfma_f32_16x16x32_bf16 v[40:43], v[76:79], v[224:227], v[40:43]
    v_mov_b32 v14, 0
    v_mfma_f32_16x16x32_bf16 v[48:51], v[80:83], v[224:227], v[48:51]
    ds_read_b128 v[76:79], v2 offset:27648
    v_mov_b32 v15, 0
    v_mfma_f32_16x16x32_bf16 v[52:55], v[80:83], v[228:231], v[52:55]
    buffer_load_dwordx4 v1, s[8:11], s40 offen offset:3072 sc1 lds
    v_mfma_f32_16x16x32_bf16 v[60:63], v[84:87], v[228:231], v[60:63]
    ds_read_b128 v[80:83], v1 offset:28672
    s_waitcnt lgkmcnt(5)
    v_mfma_f32_16x16x32_bf16 v[56:59], v[84:87], v[224:227], v[56:59]
    s_waitcnt vmcnt(17)
    v_mfma_f32_16x16x32_bf16 v[16:19], v[88:91], v[232:235], v[16:19]
    ds_read_b128 v[84:87], v1 offset:29696
    s_waitcnt vmcnt(16)
    v_mfma_f32_16x16x32_bf16 v[20:23], v[88:91], v[236:239], v[20:23]
    s_add_u32 m0, s26, 32768
    s_add_u32 s40, s46, 180224
    buffer_load_dwordx4 v1, s[8:11], s40 offen offset:0 sc1 lds
    v_mfma_f32_16x16x32_bf16 v[28:31], v[92:95], v[236:239], v[28:31]
    ds_read_b128 v[88:91], v1 offset:61440
    s_waitcnt lgkmcnt(5)
    v_mfma_f32_16x16x32_bf16 v[24:27], v[92:95], v[232:235], v[24:27]
    v_mfma_f32_16x16x32_bf16 v[32:35], v[64:67], v[232:235], v[32:35]
    ds_read_b128 v[92:95], v1 offset:62464
    v_accvgpr_read_b32 v12, a224
    v_mfma_f32_16x16x32_bf16 v[36:39], v[64:67], v[236:239], v[36:39]
    v_accvgpr_read_b32 v13, a224
    buffer_load_dwordx4 v1, s[8:11], s40 offen offset:1024 sc1 lds
    v_mfma_f32_16x16x32_bf16 v[44:47], v[68:71], v[236:239], v[44:47]
    ds_read_b128 v[64:67], v2 offset:28672
    s_waitcnt lgkmcnt(5)
    v_mfma_f32_16x16x32_bf16 v[40:43], v[68:71], v[232:235], v[40:43]
    v_mfma_f32_16x16x32_bf16 v[16:19], v[12:15], v[120:123], v[16:19]
    v_mfma_f32_16x16x32_bf16 v[20:23], v[12:15], v[122:125], v[20:23]
    v_mfma_f32_16x16x32_bf16 v[48:51], v[72:75], v[232:235], v[48:51]
    ds_read_b128 v[68:71], v2 offset:29696
    v_mfma_f32_16x16x32_bf16 v[52:55], v[72:75], v[236:239], v[52:55]
    v_mfma_f32_16x16x32_bf16 v[24:27], v[12:15], v[124:127], v[24:27]
    v_mfma_f32_16x16x32_bf16 v[28:31], v[12:15], v[126:129], v[28:31]
    buffer_load_dwordx4 v1, s[8:11], s40 offen offset:2048 sc1 lds
    v_mfma_f32_16x16x32_bf16 v[60:63], v[76:79], v[236:239], v[60:63]
    ds_read_b128 v[72:75], v1 offset:30720
    s_waitcnt lgkmcnt(5)
    v_mfma_f32_16x16x32_bf16 v[56:59], v[76:79], v[232:235], v[56:59]
    s_waitcnt vmcnt(18)
    v_mfma_f32_16x16x32_bf16 v[16:19], v[80:83], v[240:243], v[16:19]
    ds_read_b128 v[76:79], v1 offset:31744
    s_waitcnt vmcnt(17)
    v_mfma_f32_16x16x32_bf16 v[20:23], v[80:83], v[244:247], v[20:23]
    buffer_load_dwordx4 v1, s[8:11], s40 offen offset:3072 sc1 lds
    v_mfma_f32_16x16x32_bf16 v[28:31], v[84:87], v[244:247], v[28:31]
    ds_read_b128 v[80:83], v1 offset:63488
    s_waitcnt lgkmcnt(5)
    v_mfma_f32_16x16x32_bf16 v[24:27], v[84:87], v[240:243], v[24:27]
    v_accvgpr_read_b32 v12, a225
    v_accvgpr_read_b32 v13, a225
    v_mfma_f32_16x16x32_bf16 v[32:35], v[88:91], v[240:243], v[32:35]
    ds_read_b128 v[84:87], v1 offset:64512
    v_mfma_f32_16x16x32_bf16 v[36:39], v[88:91], v[244:247], v[36:39]
    v_mfma_f32_16x16x32_bf16 v[32:35], v[12:15], v[120:123], v[32:35]
    v_mfma_f32_16x16x32_bf16 v[36:39], v[12:15], v[122:125], v[36:39]
    s_add_u32 m0, s26, 65536
    s_add_u32 s40, s46, 196608
    buffer_load_dwordx4 v1, s[8:11], s40 offen offset:0 sc1 lds
    v_mfma_f32_16x16x32_bf16 v[44:47], v[92:95], v[244:247], v[44:47]
    ds_read_b128 v[88:91], v2 offset:30720
    s_waitcnt lgkmcnt(5)
    v_mfma_f32_16x16x32_bf16 v[40:43], v[92:95], v[240:243], v[40:43]
    v_mfma_f32_16x16x32_bf16 v[40:43], v[12:15], v[124:127], v[40:43]
    v_mfma_f32_16x16x32_bf16 v[44:47], v[12:15], v[126:129], v[44:47]
    v_mfma_f32_16x16x32_bf16 v[48:51], v[64:67], v[240:243], v[48:51]
    ds_read_b128 v[92:95], v2 offset:31744
    v_mfma_f32_16x16x32_bf16 v[52:55], v[64:67], v[244:247], v[52:55]
    buffer_load_dwordx4 v1, s[8:11], s40 offen offset:1024 sc1 lds
    v_mfma_f32_16x16x32_bf16 v[60:63], v[68:71], v[244:247], v[60:63]
    ds_read_b128 v[64:67], v2 offset:32768
    s_waitcnt lgkmcnt(5)
    v_mfma_f32_16x16x32_bf16 v[56:59], v[68:71], v[240:243], v[56:59]
    s_waitcnt vmcnt(19)
    v_mfma_f32_16x16x32_bf16 v[16:19], v[72:75], v[248:251], v[16:19]
    ds_read_b128 v[68:71], v2 offset:33792
    v_accvgpr_read_b32 v12, a226
    s_waitcnt vmcnt(18)
    v_mfma_f32_16x16x32_bf16 v[20:23], v[72:75], v[252:255], v[20:23]
    v_accvgpr_read_b32 v13, a226
    buffer_load_dwordx4 v1, s[8:11], s40 offen offset:2048 sc1 lds
    v_mfma_f32_16x16x32_bf16 v[28:31], v[76:79], v[252:255], v[28:31]
    ds_read_b128 v[72:75], v2 offset:34816
    s_waitcnt lgkmcnt(5)
    v_mfma_f32_16x16x32_bf16 v[24:27], v[76:79], v[248:251], v[24:27]
    v_mfma_f32_16x16x32_bf16 v[48:51], v[12:15], v[120:123], v[48:51]
    v_mfma_f32_16x16x32_bf16 v[52:55], v[12:15], v[122:125], v[52:55]
    v_mfma_f32_16x16x32_bf16 v[32:35], v[80:83], v[248:251], v[32:35]
    ds_read_b128 v[76:79], v2 offset:35840
    v_mfma_f32_16x16x32_bf16 v[36:39], v[80:83], v[252:255], v[36:39]
    v_mfma_f32_16x16x32_bf16 v[56:59], v[12:15], v[124:127], v[56:59]
    v_mfma_f32_16x16x32_bf16 v[60:63], v[12:15], v[126:129], v[60:63]
    buffer_load_dwordx4 v1, s[8:11], s40 offen offset:3072 sc1 lds
    v_mfma_f32_16x16x32_bf16 v[44:47], v[84:87], v[252:255], v[44:47]
    ds_read_b128 v[80:83], v2 offset:36864
    s_waitcnt lgkmcnt(5)
    v_mfma_f32_16x16x32_bf16 v[40:43], v[84:87], v[248:251], v[40:43]
    v_mfma_f32_16x16x32_bf16 v[48:51], v[88:91], v[248:251], v[48:51]
    ds_read_b128 v[84:87], v2 offset:37888
    v_mfma_f32_16x16x32_bf16 v[52:55], v[88:91], v[252:255], v[52:55]
    v_mfma_f32_16x16x32_bf16 v[60:63], v[92:95], v[252:255], v[60:63]
    ds_read_b128 v[88:91], v2 offset:38912
    s_waitcnt lgkmcnt(5)
    v_mfma_f32_16x16x32_bf16 v[56:59], v[92:95], v[248:251], v[56:59]
    v_mfma_f32_16x16x32_bf16 v[104:107], v[64:67], v[128:131], 0
    ds_read_b128 v[92:95], v2 offset:39936
    v_mfma_f32_16x16x32_bf16 v[108:111], v[64:67], v[132:135], 0
    v_mfma_f32_16x16x32_bf16 v[116:119], v[68:71], v[132:135], 0
    ds_read_b128 v[64:67], v2 offset:49152
    s_waitcnt lgkmcnt(5)
    v_mfma_f32_16x16x32_bf16 v[112:115], v[68:71], v[128:131], 0
    v_mul_f32 v16, v16, v10
    v_mul_f32 v17, v17, v10
    v_mfma_f32_16x16x32_bf16 v[104:107], v[72:75], v[136:139], v[104:107]
    ds_read_b128 v[68:71], v2 offset:50176
    v_mul_f32 v16, v16, v24
    v_mfma_f32_16x16x32_bf16 v[108:111], v[72:75], v[140:143], v[108:111]
    v_mul_f32 v17, v17, v25
    v_mfma_f32_16x16x32_bf16 v[116:119], v[76:79], v[140:143], v[116:119]
    ds_read_b128 v[72:75], v2 offset:51200
    s_waitcnt lgkmcnt(5)
    v_mfma_f32_16x16x32_bf16 v[112:115], v[76:79], v[136:139], v[112:115]
    v_cvt_pk_bf16_f32 v96, v16, v17
    v_mul_f32 v18, v18, v10
    v_mfma_f32_16x16x32_bf16 v[104:107], v[80:83], v[144:147], v[104:107]
    ds_read_b128 v[76:79], v2 offset:52224
    v_mul_f32 v19, v19, v10
    v_mfma_f32_16x16x32_bf16 v[108:111], v[80:83], v[148:151], v[108:111]
    v_mul_f32 v18, v18, v26
    v_mfma_f32_16x16x32_bf16 v[116:119], v[84:87], v[148:151], v[116:119]
    ds_read_b128 v[80:83], v2 offset:53248
    s_waitcnt lgkmcnt(5)
    v_mfma_f32_16x16x32_bf16 v[112:115], v[84:87], v[144:147], v[112:115]
    s_waitcnt vmcnt(12)
    s_barrier
    v_mul_f32 v19, v19, v27
    v_cvt_pk_bf16_f32 v97, v18, v19
    v_mfma_f32_16x16x32_bf16 v[104:107], v[88:91], v[152:155], v[104:107]
    ds_read_b128 v[84:87], v2 offset:54272
    v_mfma_f32_16x16x32_bf16 v[108:111], v[88:91], v[156:159], v[108:111]
    s_add_u32 m0, s26, 16384
    s_add_u32 s40, s46, 212992
    buffer_load_dwordx4 v1, s[8:11], s40 offen offset:0 sc1 lds
    v_mfma_f32_16x16x32_bf16 v[116:119], v[92:95], v[156:159], v[116:119]
    ds_read_b128 v[88:91], v2 offset:55296
    s_waitcnt lgkmcnt(5)
    v_mfma_f32_16x16x32_bf16 v[112:115], v[92:95], v[152:155], v[112:115]
    buffer_load_dwordx4 v1, s[8:11], s40 offen offset:1024 sc1 lds
    v_mfma_f32_16x16x32_bf16 v[104:107], v[64:67], v[160:163], v[104:107]
    ds_read_b128 v[92:95], v2 offset:56320
    v_mfma_f32_16x16x32_bf16 v[108:111], v[64:67], v[164:167], v[108:111]
    buffer_load_dwordx4 v1, s[8:11], s40 offen offset:2048 sc1 lds
    v_mul_f32 v20, v20, v11
    v_mul_f32 v21, v21, v11
    v_mfma_f32_16x16x32_bf16 v[116:119], v[68:71], v[164:167], v[116:119]
    ds_read_b128 v[64:67], v3 offset:0
    s_waitcnt lgkmcnt(5)
    v_mfma_f32_16x16x32_bf16 v[112:115], v[68:71], v[160:163], v[112:115]
    buffer_load_dwordx4 v1, s[8:11], s40 offen offset:3072 sc1 lds
    v_mul_f32 v20, v20, v28
    v_mul_f32 v21, v21, v29
    v_mfma_f32_16x16x32_bf16 v[104:107], v[72:75], v[168:171], v[104:107]
    ds_read_b128 v[68:71], v3 offset:1024
    v_cvt_pk_bf16_f32 v98, v20, v21
    v_mfma_f32_16x16x32_bf16 v[108:111], v[72:75], v[172:175], v[108:111]
    v_mul_f32 v22, v22, v11
    v_mfma_f32_16x16x32_bf16 v[116:119], v[76:79], v[172:175], v[116:119]
    ds_read_b128 v[72:75], v3 offset:2048
    s_waitcnt lgkmcnt(5)
    v_mfma_f32_16x16x32_bf16 v[112:115], v[76:79], v[168:171], v[112:115]
    v_mul_f32 v23, v23, v11
    v_mul_f32 v22, v22, v30
    v_mfma_f32_16x16x32_bf16 v[104:107], v[80:83], v[176:179], v[104:107]
    ds_read_b128 v[76:79], v3 offset:3072
    v_mul_f32 v23, v23, v31
    v_mfma_f32_16x16x32_bf16 v[108:111], v[80:83], v[180:183], v[108:111]
    v_cvt_pk_bf16_f32 v99, v22, v23
    v_mfma_f32_16x16x32_bf16 v[116:119], v[84:87], v[180:183], v[116:119]
    ds_read_b128 v[80:83], v3 offset:4096
    s_waitcnt lgkmcnt(5)
    v_mfma_f32_16x16x32_bf16 v[112:115], v[84:87], v[176:179], v[112:115]
    v_permlane16_swap_b32 v96, v98
    v_permlane16_swap_b32 v97, v99
    v_mfma_f32_16x16x32_bf16 v[104:107], v[88:91], v[184:187], v[104:107]
    ds_read_b128 v[84:87], v3 offset:5120
    v_mfma_f32_16x16x32_bf16 v[108:111], v[88:91], v[188:191], v[108:111]
    buffer_store_dwordx4 v[96:99], v1, s[8:11], s34 offen offset:0 sc1
    v_mul_f32 v32, v32, v10
    v_mfma_f32_16x16x32_bf16 v[116:119], v[92:95], v[188:191], v[116:119]
    ds_read_b128 v[88:91], v3 offset:6144
    s_waitcnt lgkmcnt(5)
    v_mfma_f32_16x16x32_bf16 v[112:115], v[92:95], v[184:187], v[112:115]
    v_mul_f32 v33, v33, v10
    v_mul_f32 v32, v32, v40
    v_mfma_f32_16x16x32_bf16 v[104:107], v[64:67], v[192:195], v[104:107]
    ds_read_b128 v[92:95], v3 offset:7168
    v_mul_f32 v33, v33, v41
    v_mfma_f32_16x16x32_bf16 v[108:111], v[64:67], v[196:199], v[108:111]
    v_cvt_pk_bf16_f32 v100, v32, v33
    v_mfma_f32_16x16x32_bf16 v[116:119], v[68:71], v[196:199], v[116:119]
    ds_read_b128 v[64:67], v3 offset:16384
    s_waitcnt lgkmcnt(5)
    v_mfma_f32_16x16x32_bf16 v[112:115], v[68:71], v[192:195], v[112:115]
    v_mul_f32 v34, v34, v10
    v_mul_f32 v35, v35, v10
    v_mfma_f32_16x16x32_bf16 v[104:107], v[72:75], v[200:203], v[104:107]
    ds_read_b128 v[68:71], v3 offset:17408
    v_mul_f32 v34, v34, v42
    v_mfma_f32_16x16x32_bf16 v[108:111], v[72:75], v[204:207], v[108:111]
    v_mul_f32 v35, v35, v43
    v_mfma_f32_16x16x32_bf16 v[116:119], v[76:79], v[204:207], v[116:119]
    ds_read_b128 v[72:75], v3 offset:18432
    s_waitcnt lgkmcnt(5)
    v_mfma_f32_16x16x32_bf16 v[112:115], v[76:79], v[200:203], v[112:115]
    v_cvt_pk_bf16_f32 v101, v34, v35
    v_mul_f32 v36, v36, v11
    v_mfma_f32_16x16x32_bf16 v[104:107], v[80:83], v[208:211], v[104:107]
    ds_read_b128 v[76:79], v3 offset:19456
    v_mul_f32 v37, v37, v11
    v_mfma_f32_16x16x32_bf16 v[108:111], v[80:83], v[212:215], v[108:111]
    v_mul_f32 v36, v36, v44
    v_mfma_f32_16x16x32_bf16 v[116:119], v[84:87], v[212:215], v[116:119]
    ds_read_b128 v[80:83], v3 offset:20480
    s_waitcnt lgkmcnt(5)
    v_mfma_f32_16x16x32_bf16 v[112:115], v[84:87], v[208:211], v[112:115]
    v_mul_f32 v37, v37, v45
    v_cvt_pk_bf16_f32 v102, v36, v37
    v_mfma_f32_16x16x32_bf16 v[104:107], v[88:91], v[216:219], v[104:107]
    ds_read_b128 v[84:87], v3 offset:21504
    v_mul_f32 v38, v38, v11
    v_mfma_f32_16x16x32_bf16 v[108:111], v[88:91], v[220:223], v[108:111]
    v_mul_f32 v39, v39, v11
    v_mfma_f32_16x16x32_bf16 v[116:119], v[92:95], v[220:223], v[116:119]
    ds_read_b128 v[88:91], v3 offset:22528
    s_waitcnt lgkmcnt(5)
    v_mfma_f32_16x16x32_bf16 v[112:115], v[92:95], v[216:219], v[112:115]
    v_mul_f32 v38, v38, v46
    v_mul_f32 v39, v39, v47
    v_mfma_f32_16x16x32_bf16 v[104:107], v[64:67], v[224:227], v[104:107]
    ds_read_b128 v[92:95], v3 offset:23552
    v_cvt_pk_bf16_f32 v103, v38, v39
    v_mfma_f32_16x16x32_bf16 v[108:111], v[64:67], v[228:231], v[108:111]
    v_permlane16_swap_b32 v100, v102
    v_mfma_f32_16x16x32_bf16 v[116:119], v[68:71], v[228:231], v[116:119]
    ds_read_b128 v[64:67], v2 offset:40960
    s_waitcnt lgkmcnt(5)
    v_mfma_f32_16x16x32_bf16 v[112:115], v[68:71], v[224:227], v[112:115]
    v_permlane16_swap_b32 v101, v103
    buffer_store_dwordx4 v[100:103], v1, s[8:11], s34 offen offset:1024 sc1
    v_mfma_f32_16x16x32_bf16 v[104:107], v[72:75], v[232:235], v[104:107]
    ds_read_b128 v[68:71], v2 offset:41984
    v_mul_f32 v48, v48, v10
    v_mfma_f32_16x16x32_bf16 v[108:111], v[72:75], v[236:239], v[108:111]
    v_mul_f32 v49, v49, v10
    v_mfma_f32_16x16x32_bf16 v[116:119], v[76:79], v[236:239], v[116:119]
    ds_read_b128 v[72:75], v2 offset:43008
    s_waitcnt lgkmcnt(5)
    v_mfma_f32_16x16x32_bf16 v[112:115], v[76:79], v[232:235], v[112:115]
    v_mul_f32 v48, v48, v56
    v_mul_f32 v49, v49, v57
    v_mfma_f32_16x16x32_bf16 v[104:107], v[80:83], v[240:243], v[104:107]
    ds_read_b128 v[76:79], v2 offset:44032
    v_accvgpr_read_b32 v12, a227
    v_mfma_f32_16x16x32_bf16 v[108:111], v[80:83], v[244:247], v[108:111]
    v_accvgpr_read_b32 v13, a227
    v_cvt_pk_bf16_f32 v96, v48, v49
    v_mul_f32 v50, v50, v10
    v_mfma_f32_16x16x32_bf16 v[116:119], v[84:87], v[244:247], v[116:119]
    ds_read_b128 v[80:83], v2 offset:45056
    s_waitcnt lgkmcnt(5)
    v_mfma_f32_16x16x32_bf16 v[112:115], v[84:87], v[240:243], v[112:115]
    v_mfma_f32_16x16x32_bf16 v[104:107], v[12:15], v[120:123], v[104:107]
    v_mfma_f32_16x16x32_bf16 v[108:111], v[12:15], v[122:125], v[108:111]
    v_mul_f32 v51, v51, v10
    v_mul_f32 v50, v50, v58
    v_mfma_f32_16x16x32_bf16 v[104:107], v[88:91], v[248:251], v[104:107]
    ds_read_b128 v[84:87], v2 offset:46080
    v_mfma_f32_16x16x32_bf16 v[108:111], v[88:91], v[252:255], v[108:111]
    v_mfma_f32_16x16x32_bf16 v[112:115], v[12:15], v[124:127], v[112:115]
    v_mfma_f32_16x16x32_bf16 v[116:119], v[12:15], v[126:129], v[116:119]
    v_mul_f32 v51, v51, v59
    v_cvt_pk_bf16_f32 v97, v50, v51
    v_mfma_f32_16x16x32_bf16 v[116:119], v[92:95], v[252:255], v[116:119]
    ds_read_b128 v[88:91], v2 offset:47104
    s_waitcnt lgkmcnt(5)
    v_mfma_f32_16x16x32_bf16 v[112:115], v[92:95], v[248:251], v[112:115]
    v_mul_f32 v52, v52, v11
    v_mul_f32 v53, v53, v11
    v_mfma_f32_16x16x32_bf16 v[16:19], v[64:67], v[128:131], 0
    ds_read_b128 v[92:95], v2 offset:48128
    v_mul_f32 v52, v52, v60
    v_mfma_f32_16x16x32_bf16 v[20:23], v[64:67], v[132:135], 0
    v_mul_f32 v53, v53, v61
    v_mfma_f32_16x16x32_bf16 v[28:31], v[68:71], v[132:135], 0
    ds_read_b128 v[64:67], v2 offset:57344
    s_waitcnt lgkmcnt(5)
    v_mfma_f32_16x16x32_bf16 v[24:27], v[68:71], v[128:131], 0
    v_cvt_pk_bf16_f32 v98, v52, v53
    v_mul_f32 v54, v54, v11
    v_mfma_f32_16x16x32_bf16 v[16:19], v[72:75], v[136:139], v[16:19]
    ds_read_b128 v[68:71], v2 offset:58368
    v_mul_f32 v55, v55, v11
    v_mfma_f32_16x16x32_bf16 v[20:23], v[72:75], v[140:143], v[20:23]
    v_mul_f32 v54, v54, v62
    v_mfma_f32_16x16x32_bf16 v[28:31], v[76:79], v[140:143], v[28:31]
    ds_read_b128 v[72:75], v2 offset:59392
    s_waitcnt lgkmcnt(5)
    v_mfma_f32_16x16x32_bf16 v[24:27], v[76:79], v[136:139], v[24:27]
    v_mul_f32 v55, v55, v63
    v_cvt_pk_bf16_f32 v99, v54, v55
    v_mfma_f32_16x16x32_bf16 v[16:19], v[80:83], v[144:147], v[16:19]
    ds_read_b128 v[76:79], v2 offset:60416
    v_permlane16_swap_b32 v96, v98
    v_mfma_f32_16x16x32_bf16 v[20:23], v[80:83], v[148:151], v[20:23]
    v_permlane16_swap_b32 v97, v99
    v_mfma_f32_16x16x32_bf16 v[28:31], v[84:87], v[148:151], v[28:31]
    ds_read_b128 v[80:83], v2 offset:61440
    s_waitcnt lgkmcnt(5)
    v_mfma_f32_16x16x32_bf16 v[24:27], v[84:87], v[144:147], v[24:27]
    buffer_store_dwordx4 v[96:99], v1, s[8:11], s34 offen offset:2048 sc1
    v_mfma_f32_16x16x32_bf16 v[16:19], v[88:91], v[152:155], v[16:19]
    ds_read_b128 v[84:87], v2 offset:62464
    v_mul_f32 v104, v104, v10
    v_mfma_f32_16x16x32_bf16 v[20:23], v[88:91], v[156:159], v[20:23]
    v_mul_f32 v105, v105, v10
    v_mfma_f32_16x16x32_bf16 v[28:31], v[92:95], v[156:159], v[28:31]
    ds_read_b128 v[88:91], v2 offset:63488
    s_waitcnt lgkmcnt(5)
    v_mfma_f32_16x16x32_bf16 v[24:27], v[92:95], v[152:155], v[24:27]
    v_mul_f32 v104, v104, v112
    v_mul_f32 v105, v105, v113
    v_mfma_f32_16x16x32_bf16 v[16:19], v[64:67], v[160:163], v[16:19]
    ds_read_b128 v[92:95], v2 offset:64512
    v_cvt_pk_bf16_f32 v100, v104, v105
    v_mfma_f32_16x16x32_bf16 v[20:23], v[64:67], v[164:167], v[20:23]
    v_mul_f32 v106, v106, v10
    v_mfma_f32_16x16x32_bf16 v[28:31], v[68:71], v[164:167], v[28:31]
    ds_read_b128 v[64:67], v3 offset:8192
    s_waitcnt lgkmcnt(5)
    v_mfma_f32_16x16x32_bf16 v[24:27], v[68:71], v[160:163], v[24:27]
    v_mul_f32 v107, v107, v10
    v_mul_f32 v106, v106, v114
    v_mfma_f32_16x16x32_bf16 v[16:19], v[72:75], v[168:171], v[16:19]
    ds_read_b128 v[68:71], v3 offset:9216
    v_mul_f32 v107, v107, v115
    v_mfma_f32_16x16x32_bf16 v[20:23], v[72:75], v[172:175], v[20:23]
    v_cvt_pk_bf16_f32 v101, v106, v107
    v_mfma_f32_16x16x32_bf16 v[28:31], v[76:79], v[172:175], v[28:31]
    ds_read_b128 v[72:75], v3 offset:10240
    s_waitcnt lgkmcnt(5)
    v_mfma_f32_16x16x32_bf16 v[24:27], v[76:79], v[168:171], v[24:27]
    v_mul_f32 v108, v108, v11
    v_mul_f32 v109, v109, v11
    v_mfma_f32_16x16x32_bf16 v[16:19], v[80:83], v[176:179], v[16:19]
    ds_read_b128 v[76:79], v3 offset:11264
    v_mul_f32 v108, v108, v116
    v_mfma_f32_16x16x32_bf16 v[20:23], v[80:83], v[180:183], v[20:23]
    v_mul_f32 v109, v109, v117
    v_mfma_f32_16x16x32_bf16 v[28:31], v[84:87], v[180:183], v[28:31]
    ds_read_b128 v[80:83], v3 offset:12288
    s_waitcnt lgkmcnt(5)
    v_mfma_f32_16x16x32_bf16 v[24:27], v[84:87], v[176:179], v[24:27]
    v_cvt_pk_bf16_f32 v102, v108, v109
    v_mul_f32 v110, v110, v11
    v_mfma_f32_16x16x32_bf16 v[16:19], v[88:91], v[184:187], v[16:19]
    ds_read_b128 v[84:87], v3 offset:13312
    v_mul_f32 v111, v111, v11
    v_mfma_f32_16x16x32_bf16 v[20:23], v[88:91], v[188:191], v[20:23]
    v_mul_f32 v110, v110, v118
    v_mfma_f32_16x16x32_bf16 v[28:31], v[92:95], v[188:191], v[28:31]
    ds_read_b128 v[88:91], v3 offset:14336
    s_waitcnt lgkmcnt(5)
    v_mfma_f32_16x16x32_bf16 v[24:27], v[92:95], v[184:187], v[24:27]
    v_mul_f32 v111, v111, v119
    v_cvt_pk_bf16_f32 v103, v110, v111
    v_mfma_f32_16x16x32_bf16 v[16:19], v[64:67], v[192:195], v[16:19]
    ds_read_b128 v[92:95], v3 offset:15360
    v_permlane16_swap_b32 v100, v102
    v_mfma_f32_16x16x32_bf16 v[20:23], v[64:67], v[196:199], v[20:23]
    v_permlane16_swap_b32 v101, v103
    v_mfma_f32_16x16x32_bf16 v[28:31], v[68:71], v[196:199], v[28:31]
    ds_read_b128 v[64:67], v3 offset:24576
    s_waitcnt lgkmcnt(5)
    v_mfma_f32_16x16x32_bf16 v[24:27], v[68:71], v[192:195], v[24:27]
    buffer_store_dwordx4 v[100:103], v1, s[8:11], s34 offen offset:3072 sc1
    v_mfma_f32_16x16x32_bf16 v[16:19], v[72:75], v[200:203], v[16:19]
    ds_read_b128 v[68:71], v3 offset:25600
    v_mfma_f32_16x16x32_bf16 v[20:23], v[72:75], v[204:207], v[20:23]
    v_mfma_f32_16x16x32_bf16 v[28:31], v[76:79], v[204:207], v[28:31]
    ds_read_b128 v[72:75], v3 offset:26624
    s_waitcnt lgkmcnt(5)
    v_mfma_f32_16x16x32_bf16 v[24:27], v[76:79], v[200:203], v[24:27]
    v_mfma_f32_16x16x32_bf16 v[16:19], v[80:83], v[208:211], v[16:19]
    ds_read_b128 v[76:79], v3 offset:27648
    v_mfma_f32_16x16x32_bf16 v[20:23], v[80:83], v[212:215], v[20:23]
    v_mfma_f32_16x16x32_bf16 v[28:31], v[84:87], v[212:215], v[28:31]
    ds_read_b128 v[80:83], v3 offset:28672
    s_waitcnt lgkmcnt(5)
    v_mfma_f32_16x16x32_bf16 v[24:27], v[84:87], v[208:211], v[24:27]
    v_mfma_f32_16x16x32_bf16 v[16:19], v[88:91], v[216:219], v[16:19]
    ds_read_b128 v[84:87], v3 offset:29696
    v_mfma_f32_16x16x32_bf16 v[20:23], v[88:91], v[220:223], v[20:23]
    v_mfma_f32_16x16x32_bf16 v[28:31], v[92:95], v[220:223], v[28:31]
    ds_read_b128 v[88:91], v3 offset:30720
    s_waitcnt lgkmcnt(5)
    v_mfma_f32_16x16x32_bf16 v[24:27], v[92:95], v[216:219], v[24:27]
    s_waitcnt vmcnt(4)
    s_barrier
    v_mfma_f32_16x16x32_bf16 v[16:19], v[64:67], v[224:227], v[16:19]
    ds_read_b128 v[92:95], v3 offset:31744
    v_accvgpr_read_b32 v12, a228
    v_mfma_f32_16x16x32_bf16 v[20:23], v[64:67], v[228:231], v[20:23]
    v_accvgpr_read_b32 v13, a228
    v_mfma_f32_16x16x32_bf16 v[28:31], v[68:71], v[228:231], v[28:31]
    ds_read_b128 v[64:67], v1 offset:0
    s_waitcnt lgkmcnt(5)
    v_mfma_f32_16x16x32_bf16 v[24:27], v[68:71], v[224:227], v[24:27]
    v_mfma_f32_16x16x32_bf16 v[16:19], v[12:15], v[120:123], v[16:19]
    v_mfma_f32_16x16x32_bf16 v[20:23], v[12:15], v[122:125], v[20:23]
    v_mfma_f32_16x16x32_bf16 v[16:19], v[72:75], v[232:235], v[16:19]
    ds_read_b128 v[68:71], v1 offset:1024
    v_mfma_f32_16x16x32_bf16 v[20:23], v[72:75], v[236:239], v[20:23]
    v_mfma_f32_16x16x32_bf16 v[24:27], v[12:15], v[124:127], v[24:27]
    v_mfma_f32_16x16x32_bf16 v[28:31], v[12:15], v[126:129], v[28:31]
    v_mfma_f32_16x16x32_bf16 v[28:31], v[76:79], v[236:239], v[28:31]
    ds_read_b128 v[72:75], v1 offset:2048
    s_waitcnt lgkmcnt(5)
    v_mfma_f32_16x16x32_bf16 v[24:27], v[76:79], v[232:235], v[24:27]
    v_mfma_f32_16x16x32_bf16 v[16:19], v[80:83], v[240:243], v[16:19]
    ds_read_b128 v[76:79], v1 offset:3072
    v_mfma_f32_16x16x32_bf16 v[20:23], v[80:83], v[244:247], v[20:23]
    v_mfma_f32_16x16x32_bf16 v[28:31], v[84:87], v[244:247], v[28:31]
    ds_read_b128 v[80:83], v1 offset:4096
    s_waitcnt lgkmcnt(5)
    v_mfma_f32_16x16x32_bf16 v[24:27], v[84:87], v[240:243], v[24:27]
    v_mfma_f32_16x16x32_bf16 v[16:19], v[88:91], v[248:251], v[16:19]
    ds_read_b128 v[84:87], v1 offset:5120
    v_mfma_f32_16x16x32_bf16 v[20:23], v[88:91], v[252:255], v[20:23]
    v_mfma_f32_16x16x32_bf16 v[28:31], v[92:95], v[252:255], v[28:31]
    ds_read_b128 v[88:91], v1 offset:6144
    s_waitcnt lgkmcnt(5)
    v_mfma_f32_16x16x32_bf16 v[24:27], v[92:95], v[248:251], v[24:27]
    v_mfma_f32_16x16x32_bf16 v[32:35], v[64:67], v[128:131], 0
    ds_read_b128 v[92:95], v1 offset:7168
    v_mfma_f32_16x16x32_bf16 v[36:39], v[64:67], v[132:135], 0
    s_waitcnt vmcnt(1)
    v_mov_b32 v5, 1
    s_mov_b64 exec, 1
    buffer_atomic_add v5, off, s[8:11], s49 sc1
    s_mov_b64 exec, -1
    v_mfma_f32_16x16x32_bf16 v[44:47], v[68:71], v[132:135], 0
    ds_read_b128 v[64:67], v1 offset:8192
    s_waitcnt lgkmcnt(5)
    v_mfma_f32_16x16x32_bf16 v[40:43], v[68:71], v[128:131], 0
    v_mfma_f32_16x16x32_bf16 v[32:35], v[72:75], v[136:139], v[32:35]
    ds_read_b128 v[68:71], v1 offset:9216
    v_mul_f32 v16, v16, v10
    v_mfma_f32_16x16x32_bf16 v[36:39], v[72:75], v[140:143], v[36:39]
    v_mul_f32 v17, v17, v10
    v_mfma_f32_16x16x32_bf16 v[44:47], v[76:79], v[140:143], v[44:47]
    ds_read_b128 v[72:75], v1 offset:10240
    s_waitcnt lgkmcnt(5)
    v_mfma_f32_16x16x32_bf16 v[40:43], v[76:79], v[136:139], v[40:43]
    v_mul_f32 v16, v16, v24
    v_mul_f32 v17, v17, v25
    v_mfma_f32_16x16x32_bf16 v[32:35], v[80:83], v[144:147], v[32:35]
    ds_read_b128 v[76:79], v1 offset:11264
    v_cvt_pk_bf16_f32 v96, v16, v17
    v_mfma_f32_16x16x32_bf16 v[36:39], v[80:83], v[148:151], v[36:39]
    v_mul_f32 v18, v18, v10
    v_mfma_f32_16x16x32_bf16 v[44:47], v[84:87], v[148:151], v[44:47]
    ds_read_b128 v[80:83], v1 offset:12288
    s_waitcnt lgkmcnt(5)
    v_mfma_f32_16x16x32_bf16 v[40:43], v[84:87], v[144:147], v[40:43]
    v_mul_f32 v19, v19, v10
    v_mul_f32 v18, v18, v26
    v_mfma_f32_16x16x32_bf16 v[32:35], v[88:91], v[152:155], v[32:35]
    ds_read_b128 v[84:87], v1 offset:13312
    v_mul_f32 v19, v19, v27
    v_mfma_f32_16x16x32_bf16 v[36:39], v[88:91], v[156:159], v[36:39]
    v_cvt_pk_bf16_f32 v97, v18, v19
    v_mfma_f32_16x16x32_bf16 v[44:47], v[92:95], v[156:159], v[44:47]
    ds_read_b128 v[88:91], v1 offset:14336
    s_waitcnt lgkmcnt(5)
    v_mfma_f32_16x16x32_bf16 v[40:43], v[92:95], v[152:155], v[40:43]
    v_mul_f32 v20, v20, v11
    v_mul_f32 v21, v21, v11
    v_mfma_f32_16x16x32_bf16 v[32:35], v[64:67], v[160:163], v[32:35]
    ds_read_b128 v[92:95], v1 offset:15360
    v_mul_f32 v20, v20, v28
    v_mfma_f32_16x16x32_bf16 v[36:39], v[64:67], v[164:167], v[36:39]
    v_mul_f32 v21, v21, v29
    v_mfma_f32_16x16x32_bf16 v[44:47], v[68:71], v[164:167], v[44:47]
    ds_read_b128 v[64:67], v1 offset:32768
    s_waitcnt lgkmcnt(5)
    v_mfma_f32_16x16x32_bf16 v[40:43], v[68:71], v[160:163], v[40:43]
    v_cvt_pk_bf16_f32 v98, v20, v21
    v_mul_f32 v22, v22, v11
    v_mfma_f32_16x16x32_bf16 v[32:35], v[72:75], v[168:171], v[32:35]
    ds_read_b128 v[68:71], v1 offset:33792
    v_mul_f32 v23, v23, v11
    v_mfma_f32_16x16x32_bf16 v[36:39], v[72:75], v[172:175], v[36:39]
    v_mul_f32 v22, v22, v30
    v_mfma_f32_16x16x32_bf16 v[44:47], v[76:79], v[172:175], v[44:47]
    ds_read_b128 v[72:75], v1 offset:34816
    s_waitcnt lgkmcnt(5)
    v_mfma_f32_16x16x32_bf16 v[40:43], v[76:79], v[168:171], v[40:43]
    v_mul_f32 v23, v23, v31
    v_cvt_pk_bf16_f32 v99, v22, v23
    v_mfma_f32_16x16x32_bf16 v[32:35], v[80:83], v[176:179], v[32:35]
    ds_read_b128 v[76:79], v1 offset:35840
    v_permlane16_swap_b32 v96, v98
    v_mfma_f32_16x16x32_bf16 v[36:39], v[80:83], v[180:183], v[36:39]
    v_permlane16_swap_b32 v97, v99
    v_mfma_f32_16x16x32_bf16 v[44:47], v[84:87], v[180:183], v[44:47]
    ds_read_b128 v[80:83], v1 offset:36864
    s_waitcnt lgkmcnt(5)
    v_mfma_f32_16x16x32_bf16 v[40:43], v[84:87], v[176:179], v[40:43]
    buffer_store_dwordx4 v[96:99], v1, s[8:11], s35 offen offset:0 sc1
    v_mfma_f32_16x16x32_bf16 v[32:35], v[88:91], v[184:187], v[32:35]
    ds_read_b128 v[84:87], v1 offset:37888
    v_mfma_f32_16x16x32_bf16 v[36:39], v[88:91], v[188:191], v[36:39]
    v_mfma_f32_16x16x32_bf16 v[44:47], v[92:95], v[188:191], v[44:47]
    ds_read_b128 v[88:91], v1 offset:38912
    s_waitcnt lgkmcnt(5)
    v_mfma_f32_16x16x32_bf16 v[40:43], v[92:95], v[184:187], v[40:43]
    v_mfma_f32_16x16x32_bf16 v[32:35], v[64:67], v[192:195], v[32:35]
    ds_read_b128 v[92:95], v1 offset:39936
    v_lshrrev_b32 v6, 9, v1
    v_mfma_f32_16x16x32_bf16 v[36:39], v[64:67], v[196:199], v[36:39]
    s_mov_b32 s54, 0
    s_atomic_add s54, s[4:5], s48 glc
    s_mov_b32 s55, 0
    s_atomic_add s55, s[4:5], s37 glc
    v_mfma_f32_16x16x32_bf16 v[44:47], v[68:71], v[196:199], v[44:47]
    ds_read_b128 v[64:67], v1 offset:40960
    s_waitcnt lgkmcnt(5)
    v_mfma_f32_16x16x32_bf16 v[40:43], v[68:71], v[192:195], v[40:43]
    v_mul_u32_u24 v6, 7168, v6
    v_mfma_f32_16x16x32_bf16 v[32:35], v[72:75], v[200:203], v[32:35]
    ds_read_b128 v[68:71], v1 offset:41984
    v_and_b32 v7, 0x100, v1
    v_mfma_f32_16x16x32_bf16 v[36:39], v[72:75], v[204:207], v[36:39]
    v_mfma_f32_16x16x32_bf16 v[44:47], v[76:79], v[204:207], v[44:47]
    ds_read_b128 v[72:75], v1 offset:43008
    s_waitcnt lgkmcnt(5)
    v_mfma_f32_16x16x32_bf16 v[40:43], v[76:79], v[200:203], v[40:43]
    v_lshl_add_u32 v6, v7, 1, v6
    v_mfma_f32_16x16x32_bf16 v[32:35], v[80:83], v[208:211], v[32:35]
    ds_read_b128 v[76:79], v1 offset:44032
    v_and_b32 v7, 0xf0, v1
    v_mfma_f32_16x16x32_bf16 v[36:39], v[80:83], v[212:215], v[36:39]
    v_mfma_f32_16x16x32_bf16 v[44:47], v[84:87], v[212:215], v[44:47]
    ds_read_b128 v[80:83], v1 offset:45056
    s_waitcnt lgkmcnt(5)
    v_mfma_f32_16x16x32_bf16 v[40:43], v[84:87], v[208:211], v[40:43]
    v_add_u32 v6, v6, v7
    v_mfma_f32_16x16x32_bf16 v[32:35], v[88:91], v[216:219], v[32:35]
    ds_read_b128 v[84:87], v1 offset:46080
    v_add_u32 v7, 14336, v6
    v_mfma_f32_16x16x32_bf16 v[36:39], v[88:91], v[220:223], v[36:39]
    v_mfma_f32_16x16x32_bf16 v[44:47], v[92:95], v[220:223], v[44:47]
    ds_read_b128 v[88:91], v1 offset:47104
    s_waitcnt lgkmcnt(5)
    v_mfma_f32_16x16x32_bf16 v[40:43], v[92:95], v[216:219], v[40:43]
    s_add_u32 s6, s50, 4096
    v_mfma_f32_16x16x32_bf16 v[32:35], v[64:67], v[224:227], v[32:35]
    ds_read_b128 v[92:95], v1 offset:48128
    v_accvgpr_read_b32 v12, a229
    v_mfma_f32_16x16x32_bf16 v[36:39], v[64:67], v[228:231], v[36:39]
    v_accvgpr_read_b32 v13, a229
    s_add_u32 s7, s51, 4096
    v_mfma_f32_16x16x32_bf16 v[44:47], v[68:71], v[228:231], v[44:47]
    ds_read_b128 v[64:67], v2 offset:0
    s_waitcnt lgkmcnt(5)
    v_mfma_f32_16x16x32_bf16 v[40:43], v[68:71], v[224:227], v[40:43]
    v_mfma_f32_16x16x32_bf16 v[32:35], v[12:15], v[120:123], v[32:35]
    v_mfma_f32_16x16x32_bf16 v[36:39], v[12:15], v[122:125], v[36:39]
    v_mfma_f32_16x16x32_bf16 v[32:35], v[72:75], v[232:235], v[32:35]
    ds_read_b128 v[68:71], v2 offset:1024
    v_mfma_f32_16x16x32_bf16 v[36:39], v[72:75], v[236:239], v[36:39]
    v_mfma_f32_16x16x32_bf16 v[40:43], v[12:15], v[124:127], v[40:43]
    v_mfma_f32_16x16x32_bf16 v[44:47], v[12:15], v[126:129], v[44:47]
    v_mfma_f32_16x16x32_bf16 v[44:47], v[76:79], v[236:239], v[44:47]
    ds_read_b128 v[72:75], v2 offset:2048
    s_waitcnt lgkmcnt(5)
    v_mfma_f32_16x16x32_bf16 v[40:43], v[76:79], v[232:235], v[40:43]
    v_mfma_f32_16x16x32_bf16 v[32:35], v[80:83], v[240:243], v[32:35]
    ds_read_b128 v[76:79], v2 offset:3072
    v_mfma_f32_16x16x32_bf16 v[36:39], v[80:83], v[244:247], v[36:39]
    v_mfma_f32_16x16x32_bf16 v[44:47], v[84:87], v[244:247], v[44:47]
    ds_read_b128 v[80:83], v2 offset:4096
    s_waitcnt lgkmcnt(5)
    v_mfma_f32_16x16x32_bf16 v[40:43], v[84:87], v[240:243], v[40:43]
    v_mfma_f32_16x16x32_bf16 v[32:35], v[88:91], v[248:251], v[32:35]
    ds_read_b128 v[84:87], v2 offset:5120
    v_mfma_f32_16x16x32_bf16 v[36:39], v[88:91], v[252:255], v[36:39]
    v_mfma_f32_16x16x32_bf16 v[44:47], v[92:95], v[252:255], v[44:47]
    ds_read_b128 v[88:91], v2 offset:6144
    s_waitcnt lgkmcnt(5)
    v_mfma_f32_16x16x32_bf16 v[40:43], v[92:95], v[248:251], v[40:43]
    v_mfma_f32_16x16x32_bf16 v[104:107], v[64:67], v[128:131], 0
    ds_read_b128 v[92:95], v2 offset:7168
    v_mfma_f32_16x16x32_bf16 v[108:111], v[64:67], v[132:135], 0
    v_mfma_f32_16x16x32_bf16 v[116:119], v[68:71], v[132:135], 0
    ds_read_b128 v[64:67], v2 offset:8192
    s_waitcnt lgkmcnt(5)
    v_mfma_f32_16x16x32_bf16 v[112:115], v[68:71], v[128:131], 0
    v_mfma_f32_16x16x32_bf16 v[104:107], v[72:75], v[136:139], v[104:107]
    ds_read_b128 v[68:71], v2 offset:9216
    v_mul_f32 v32, v32, v10
    v_mfma_f32_16x16x32_bf16 v[108:111], v[72:75], v[140:143], v[108:111]
    v_mul_f32 v33, v33, v10
    s_waitcnt lgkmcnt(0)
    s_and_b32 s54, s54, s55
    s_bitcmp1_b32 s54, 2
    s_cbranch_scc1 L_ok_34
    s_mov_b32 s41, 65536
L_spin_33:
    s_mov_b32 s54, 0
    s_atomic_add s54, s[4:5], s48 glc
    s_mov_b32 s55, 0
    s_atomic_add s55, s[4:5], s37 glc
    s_waitcnt lgkmcnt(0)
    s_and_b32 s54, s54, s55
    s_bitcmp1_b32 s54, 2
    s_cbranch_scc1 L_ok_34
    s_sub_u32 s41, s41, 1
    s_cbranch_scc0 L_spin_33
L_ok_34:
    buffer_load_dwordx4 v[48:51], v1, s[8:11], s36 offen sc1
    buffer_load_dwordx4 v[52:55], v1, s[8:11], s36 offen offset:1024 sc1
    buffer_load_dwordx4 v[128:131], v6, s[8:11], s50 offen offset:0 sc1
    v_mfma_f32_16x16x32_bf16 v[116:119], v[76:79], v[140:143], v[116:119]
    ds_read_b128 v[72:75], v2 offset:10240
    v_mfma_f32_16x16x32_bf16 v[112:115], v[76:79], v[136:139], v[112:115]
    v_mul_f32 v32, v32, v40
    v_mul_f32 v33, v33, v41
    v_mfma_f32_16x16x32_bf16 v[104:107], v[80:83], v[144:147], v[104:107]
    ds_read_b128 v[76:79], v2 offset:11264
    v_cvt_pk_bf16_f32 v100, v32, v33
    v_mfma_f32_16x16x32_bf16 v[108:111], v[80:83], v[148:151], v[108:111]
    v_mul_f32 v34, v34, v10
    buffer_load_dwordx4 v[132:135], v6, s[8:11], s50 offen offset:256 sc1
    v_mfma_f32_16x16x32_bf16 v[116:119], v[84:87], v[148:151], v[116:119]
    ds_read_b128 v[80:83], v2 offset:12288
    v_mfma_f32_16x16x32_bf16 v[112:115], v[84:87], v[144:147], v[112:115]
    v_mul_f32 v35, v35, v10
    v_mul_f32 v34, v34, v42
    v_mfma_f32_16x16x32_bf16 v[104:107], v[88:91], v[152:155], v[104:107]
    ds_read_b128 v[84:87], v2 offset:13312
    v_mul_f32 v35, v35, v43
    v_mfma_f32_16x16x32_bf16 v[108:111], v[88:91], v[156:159], v[108:111]
    v_cvt_pk_bf16_f32 v101, v34, v35
    buffer_load_dwordx4 v[136:139], v6, s[8:11], s51 offen offset:0 sc1
    v_mfma_f32_16x16x32_bf16 v[116:119], v[92:95], v[156:159], v[116:119]
    ds_read_b128 v[88:91], v2 offset:14336
    v_mfma_f32_16x16x32_bf16 v[112:115], v[92:95], v[152:155], v[112:115]
    v_mul_f32 v36, v36, v11
    v_mul_f32 v37, v37, v11
    v_mfma_f32_16x16x32_bf16 v[104:107], v[64:67], v[160:163], v[104:107]
    ds_read_b128 v[92:95], v2 offset:15360
    v_mul_f32 v36, v36, v44
    v_mfma_f32_16x16x32_bf16 v[108:111], v[64:67], v[164:167], v[108:111]
    v_mul_f32 v37, v37, v45
    buffer_load_dwordx4 v[140:143], v6, s[8:11], s51 offen offset:256 sc1
    v_mfma_f32_16x16x32_bf16 v[116:119], v[68:71], v[164:167], v[116:119]
    ds_read_b128 v[64:67], v1 offset:16384
    s_waitcnt lgkmcnt(5)
    v_mfma_f32_16x16x32_bf16 v[112:115], v[68:71], v[160:163], v[112:115]
    v_cvt_pk_bf16_f32 v102, v36, v37
    v_mul_f32 v38, v38, v11
    v_mfma_f32_16x16x32_bf16 v[104:107], v[72:75], v[168:171], v[104:107]
    ds_read_b128 v[68:71], v1 offset:17408
    v_mul_f32 v39, v39, v11
    v_mfma_f32_16x16x32_bf16 v[108:111], v[72:75], v[172:175], v[108:111]
    v_mul_f32 v38, v38, v46
    buffer_load_dwordx4 v[144:147], v7, s[8:11], s50 offen offset:0 sc1
    v_mfma_f32_16x16x32_bf16 v[116:119], v[76:79], v[172:175], v[116:119]
    ds_read_b128 v[72:75], v1 offset:18432
    s_waitcnt lgkmcnt(5)
    v_mfma_f32_16x16x32_bf16 v[112:115], v[76:79], v[168:171], v[112:115]
    v_mul_f32 v39, v39, v47
    v_cvt_pk_bf16_f32 v103, v38, v39
    v_mfma_f32_16x16x32_bf16 v[104:107], v[80:83], v[176:179], v[104:107]
    ds_read_b128 v[76:79], v1 offset:19456
    v_permlane16_swap_b32 v100, v102
    v_mfma_f32_16x16x32_bf16 v[108:111], v[80:83], v[180:183], v[108:111]
    v_permlane16_swap_b32 v101, v103
    buffer_load_dwordx4 v[148:151], v7, s[8:11], s50 offen offset:256 sc1
    v_mfma_f32_16x16x32_bf16 v[116:119], v[84:87], v[180:183], v[116:119]
    ds_read_b128 v[80:83], v1 offset:20480
    s_waitcnt lgkmcnt(5)
    v_mfma_f32_16x16x32_bf16 v[112:115], v[84:87], v[176:179], v[112:115]
    buffer_store_dwordx4 v[100:103], v1, s[8:11], s35 offen offset:1024 sc1
    v_mfma_f32_16x16x32_bf16 v[104:107], v[88:91], v[184:187], v[104:107]
    ds_read_b128 v[84:87], v1 offset:21504
    v_mfma_f32_16x16x32_bf16 v[108:111], v[88:91], v[188:191], v[108:111]
    buffer_load_dwordx4 v[152:155], v7, s[8:11], s51 offen offset:0 sc1
    v_mfma_f32_16x16x32_bf16 v[116:119], v[92:95], v[188:191], v[116:119]
    ds_read_b128 v[88:91], v1 offset:22528
    s_waitcnt lgkmcnt(5)
    v_mfma_f32_16x16x32_bf16 v[112:115], v[92:95], v[184:187], v[112:115]
    v_mfma_f32_16x16x32_bf16 v[104:107], v[64:67], v[192:195], v[104:107]
    ds_read_b128 v[92:95], v1 offset:23552
    v_mfma_f32_16x16x32_bf16 v[108:111], v[64:67], v[196:199], v[108:111]
    buffer_load_dwordx4 v[156:159], v7, s[8:11], s51 offen offset:256 sc1
    v_mfma_f32_16x16x32_bf16 v[116:119], v[68:71], v[196:199], v[116:119]
    ds_read_b128 v[64:67], v1 offset:24576
    s_waitcnt lgkmcnt(5)
    v_mfma_f32_16x16x32_bf16 v[112:115], v[68:71], v[192:195], v[112:115]
    v_mfma_f32_16x16x32_bf16 v[104:107], v[72:75], v[200:203], v[104:107]
    ds_read_b128 v[68:71], v1 offset:25600
    v_mfma_f32_16x16x32_bf16 v[108:111], v[72:75], v[204:207], v[108:111]
    buffer_load_dwordx4 v[160:163], v6, s[8:11], s50 offen offset:1024 sc1
    v_mfma_f32_16x16x32_bf16 v[116:119], v[76:79], v[204:207], v[116:119]
    ds_read_b128 v[72:75], v1 offset:26624
    s_waitcnt lgkmcnt(5)
    v_mfma_f32_16x16x32_bf16 v[112:115], v[76:79], v[200:203], v[112:115]
    v_mfma_f32_16x16x32_bf16 v[104:107], v[80:83], v[208:211], v[104:107]
    ds_read_b128 v[76:79], v1 offset:27648
    v_accvgpr_read_b32 v12, a230
    v_mfma_f32_16x16x32_bf16 v[108:111], v[80:83], v[212:215], v[108:111]
    v_accvgpr_read_b32 v13, a230
    buffer_load_dwordx4 v[164:167], v6, s[8:11], s50 offen offset:1280 sc1
    v_mfma_f32_16x16x32_bf16 v[116:119], v[84:87], v[212:215], v[116:119]
    ds_read_b128 v[80:83], v1 offset:28672
    s_waitcnt lgkmcnt(5)
    v_mfma_f32_16x16x32_bf16 v[112:115], v[84:87], v[208:211], v[112:115]
    v_mfma_f32_16x16x32_bf16 v[104:107], v[12:15], v[120:123], v[104:107]
    v_mfma_f32_16x16x32_bf16 v[108:111], v[12:15], v[122:125], v[108:111]
    v_mfma_f32_16x16x32_bf16 v[104:107], v[88:91], v[216:219], v[104:107]
    ds_read_b128 v[84:87], v1 offset:29696
    v_mfma_f32_16x16x32_bf16 v[108:111], v[88:91], v[220:223], v[108:111]
    v_mfma_f32_16x16x32_bf16 v[112:115], v[12:15], v[124:127], v[112:115]
    s_waitcnt vmcnt(10)
    v_mfma_f32_16x16x32_bf16 v[116:119], v[12:15], v[126:129], v[116:119]
    buffer_load_dwordx4 v[168:171], v6, s[8:11], s51 offen offset:1024 sc1
    v_mov_b32 v5, 256
    s_mov_b64 exec, 1
    buffer_atomic_add v5, off, s[8:11], s49 sc1
    s_mov_b64 exec, -1
    v_mfma_f32_16x16x32_bf16 v[116:119], v[92:95], v[220:223], v[116:119]
    ds_read_b128 v[88:91], v1 offset:30720
    s_waitcnt lgkmcnt(5)
    v_mfma_f32_16x16x32_bf16 v[112:115], v[92:95], v[216:219], v[112:115]
    v_mfma_f32_16x16x32_bf16 v[104:107], v[64:67], v[224:227], v[104:107]
    ds_read_b128 v[92:95], v1 offset:31744
    v_lshlrev_b32 v16, 16, v48
    v_mfma_f32_16x16x32_bf16 v[108:111], v[64:67], v[228:231], v[108:111]
    v_and_b32 v17, 0xffff0000, v48
    buffer_load_dwordx4 v[172:175], v6, s[8:11], s51 offen offset:1280 sc1
    v_mfma_f32_16x16x32_bf16 v[116:119], v[68:71], v[228:231], v[116:119]
    s_waitcnt lgkmcnt(4)
    v_mfma_f32_16x16x32_bf16 v[112:115], v[68:71], v[224:227], v[112:115]
    v_lshlrev_b32 v18, 16, v49
    v_and_b32 v19, 0xffff0000, v49
    v_mfma_f32_16x16x32_bf16 v[104:107], v[72:75], v[232:235], v[104:107]
    v_lshlrev_b32 v24, 16, v50
    v_mfma_f32_16x16x32_bf16 v[108:111], v[72:75], v[236:239], v[108:111]
    v_and_b32 v25, 0xffff0000, v50
    buffer_load_dwordx4 v[176:179], v7, s[8:11], s50 offen offset:1024 sc1
    v_mfma_f32_16x16x32_bf16 v[116:119], v[76:79], v[236:239], v[116:119]
    s_waitcnt lgkmcnt(2)
    v_mfma_f32_16x16x32_bf16 v[112:115], v[76:79], v[232:235], v[112:115]
    v_lshlrev_b32 v26, 16, v51
    v_and_b32 v27, 0xffff0000, v51
    v_mfma_f32_16x16x32_bf16 v[104:107], v[80:83], v[240:243], v[104:107]
    v_lshlrev_b32 v20, 16, v52
    v_mfma_f32_16x16x32_bf16 v[108:111], v[80:83], v[244:247], v[108:111]
    v_and_b32 v21, 0xffff0000, v52
    buffer_load_dwordx4 v[180:183], v7, s[8:11], s50 offen offset:1280 sc1
    v_mfma_f32_16x16x32_bf16 v[116:119], v[84:87], v[244:247], v[116:119]
    s_waitcnt lgkmcnt(0)
    v_mfma_f32_16x16x32_bf16 v[112:115], v[84:87], v[240:243], v[112:115]
    v_lshlrev_b32 v22, 16, v53
    v_and_b32 v23, 0xffff0000, v53
    v_mfma_f32_16x16x32_bf16 v[104:107], v[88:91], v[248:251], v[104:107]
    v_lshlrev_b32 v28, 16, v54
    v_mfma_f32_16x16x32_bf16 v[108:111], v[88:91], v[252:255], v[108:111]
    v_and_b32 v29, 0xffff0000, v54
    buffer_load_dwordx4 v[184:187], v7, s[8:11], s51 offen offset:1024 sc1
    v_mfma_f32_16x16x32_bf16 v[116:119], v[92:95], v[252:255], v[116:119]
    v_mfma_f32_16x16x32_bf16 v[112:115], v[92:95], v[248:251], v[112:115]
    v_lshlrev_b32 v30, 16, v55
    v_and_b32 v31, 0xffff0000, v55
    s_barrier
    v_mfma_f32_16x16x32_bf16 v[16:19], a[0:3], v[128:131], v[16:19]
    v_mul_f32 v104, v104, v10
    v_mfma_f32_16x16x32_bf16 v[24:27], a[4:7], v[128:131], v[24:27]
    v_mul_f32 v105, v105, v10
    s_nop 0
    v_mul_f32 v104, v104, v112
    v_mul_f32 v105, v105, v113
    v_cvt_pk_bf16_f32 v96, v104, v105
    v_mul_f32 v106, v106, v10
    v_mul_f32 v107, v107, v10
    v_mul_f32 v106, v106, v114
    v_mul_f32 v107, v107, v115
    v_cvt_pk_bf16_f32 v97, v106, v107
    v_mul_f32 v108, v108, v11
    v_mul_f32 v109, v109, v11
    v_mul_f32 v108, v108, v116
    v_mul_f32 v109, v109, v117
    v_cvt_pk_bf16_f32 v98, v108, v109
    v_mul_f32 v110, v110, v11
    v_mul_f32 v111, v111, v11
    v_mul_f32 v110, v110, v118
    v_mul_f32 v111, v111, v119
    v_cvt_pk_bf16_f32 v99, v110, v111
    v_permlane16_swap_b32 v96, v98
    s_nop 0
    v_permlane16_swap_b32 v97, v99
    buffer_store_dwordx4 v[96:99], v1, s[8:11], s35 offen offset:2048 sc1
    buffer_load_dwordx4 v[188:191], v7, s[8:11], s51 offen offset:1280 sc1
    v_mfma_f32_16x16x32_bf16 v[32:35], a[8:11], v[128:131], 0
    v_mfma_f32_16x16x32_bf16 v[40:43], a[12:15], v[128:131], 0
    s_waitcnt vmcnt(17)
    v_mfma_f32_16x16x32_bf16 v[44:47], a[12:15], v[132:135], 0
    buffer_load_dwordx4 v[192:195], v6, s[8:11], s50 offen offset:2048 sc1
    v_mfma_f32_16x16x32_bf16 v[36:39], a[8:11], v[132:135], 0
    v_mfma_f32_16x16x32_bf16 v[28:31], a[4:7], v[132:135], v[28:31]
    v_mfma_f32_16x16x32_bf16 v[20:23], a[0:3], v[132:135], v[20:23]
    s_waitcnt vmcnt(17)
    v_mfma_f32_16x16x32_bf16 v[48:51], a[0:3], v[136:139], 0
    buffer_load_dwordx4 v[196:199], v6, s[8:11], s50 offen offset:2304 sc1
    v_mfma_f32_16x16x32_bf16 v[56:59], a[4:7], v[136:139], 0
    s_mov_b32 s54, 0
    s_atomic_add s54, s[4:5], s48 glc
    s_mov_b32 s55, 0
    s_atomic_add s55, s[4:5], s37 glc
    v_mfma_f32_16x16x32_bf16 v[64:67], a[8:11], v[136:139], 0
    v_mfma_f32_16x16x32_bf16 v[72:75], a[12:15], v[136:139], 0
    s_waitcnt vmcnt(17)
    v_mfma_f32_16x16x32_bf16 v[76:79], a[12:15], v[140:143], 0
    buffer_load_dwordx4 v[200:203], v6, s[8:11], s51 offen offset:2048 sc1
    v_mfma_f32_16x16x32_bf16 v[68:71], a[8:11], v[140:143], 0
    v_mfma_f32_16x16x32_bf16 v[60:63], a[4:7], v[140:143], 0
    v_mfma_f32_16x16x32_bf16 v[52:55], a[0:3], v[140:143], 0
    s_waitcnt vmcnt(17)
    v_mfma_f32_16x16x32_bf16 v[16:19], a[16:19], v[144:147], v[16:19]
    buffer_load_dwordx4 v[204:207], v6, s[8:11], s51 offen offset:2304 sc1
    v_mfma_f32_16x16x32_bf16 v[24:27], a[20:23], v[144:147], v[24:27]
    v_mfma_f32_16x16x32_bf16 v[32:35], a[24:27], v[144:147], v[32:35]
    v_mfma_f32_16x16x32_bf16 v[40:43], a[28:31], v[144:147], v[40:43]
    s_waitcnt vmcnt(17)
    v_mfma_f32_16x16x32_bf16 v[44:47], a[28:31], v[148:151], v[44:47]
    buffer_load_dwordx4 v[208:211], v7, s[8:11], s50 offen offset:2048 sc1
    v_mfma_f32_16x16x32_bf16 v[36:39], a[24:27], v[148:151], v[36:39]
    v_mfma_f32_16x16x32_bf16 v[28:31], a[20:23], v[148:151], v[28:31]
    v_mfma_f32_16x16x32_bf16 v[20:23], a[16:19], v[148:151], v[20:23]
    s_waitcnt vmcnt(16)
    v_mfma_f32_16x16x32_bf16 v[48:51], a[16:19], v[152:155], v[48:51]
    buffer_load_dwordx4 v[212:215], v7, s[8:11], s50 offen offset:2304 sc1
    v_mfma_f32_16x16x32_bf16 v[56:59], a[20:23], v[152:155], v[56:59]
    v_mfma_f32_16x16x32_bf16 v[64:67], a[24:27], v[152:155], v[64:67]
    v_mfma_f32_16x16x32_bf16 v[72:75], a[28:31], v[152:155], v[72:75]
    s_waitcnt vmcnt(16)
    v_mfma_f32_16x16x32_bf16 v[76:79], a[28:31], v[156:159], v[76:79]
    buffer_load_dwordx4 v[216:219], v7, s[8:11], s51 offen offset:2048 sc1
    v_mfma_f32_16x16x32_bf16 v[68:71], a[24:27], v[156:159], v[68:71]
    v_mfma_f32_16x16x32_bf16 v[60:63], a[20:23], v[156:159], v[60:63]
    v_mfma_f32_16x16x32_bf16 v[52:55], a[16:19], v[156:159], v[52:55]
    s_waitcnt vmcnt(16)
    v_mfma_f32_16x16x32_bf16 v[16:19], a[32:35], v[160:163], v[16:19]
    buffer_load_dwordx4 v[220:223], v7, s[8:11], s51 offen offset:2304 sc1
    v_mfma_f32_16x16x32_bf16 v[24:27], a[36:39], v[160:163], v[24:27]
    v_mfma_f32_16x16x32_bf16 v[32:35], a[40:43], v[160:163], v[32:35]
    v_mfma_f32_16x16x32_bf16 v[40:43], a[44:47], v[160:163], v[40:43]
    s_waitcnt vmcnt(16)
    v_mfma_f32_16x16x32_bf16 v[44:47], a[44:47], v[164:167], v[44:47]
    v_mfma_f32_16x16x32_bf16 v[36:39], a[40:43], v[164:167], v[36:39]
    v_mfma_f32_16x16x32_bf16 v[28:31], a[36:39], v[164:167], v[28:31]
    v_mfma_f32_16x16x32_bf16 v[20:23], a[32:35], v[164:167], v[20:23]
    s_waitcnt vmcnt(15)
    v_mfma_f32_16x16x32_bf16 v[48:51], a[32:35], v[168:171], v[48:51]
    v_mfma_f32_16x16x32_bf16 v[56:59], a[36:39], v[168:171], v[56:59]
    s_waitcnt lgkmcnt(0)
    s_and_b32 s54, s54, s55
    s_bitcmp1_b32 s54, 10
    s_cbranch_scc1 L_ok_36
    s_mov_b32 s41, 65536
L_spin_35:
    s_mov_b32 s54, 0
    s_atomic_add s54, s[4:5], s48 glc
    s_mov_b32 s55, 0
    s_atomic_add s55, s[4:5], s37 glc
    s_waitcnt lgkmcnt(0)
    s_and_b32 s54, s54, s55
    s_bitcmp1_b32 s54, 10
    s_cbranch_scc1 L_ok_36
    s_sub_u32 s41, s41, 1
    s_cbranch_scc0 L_spin_35
L_ok_36:
    buffer_load_dwordx4 v[224:227], v6, s[8:11], s50 offen offset:3072 sc1
    v_mfma_f32_16x16x32_bf16 v[64:67], a[40:43], v[168:171], v[64:67]
    v_mfma_f32_16x16x32_bf16 v[72:75], a[44:47], v[168:171], v[72:75]
    s_waitcnt vmcnt(14)
    v_mfma_f32_16x16x32_bf16 v[76:79], a[44:47], v[172:175], v[76:79]
    buffer_load_dwordx4 v[228:231], v6, s[8:11], s50 offen offset:3328 sc1
    v_mfma_f32_16x16x32_bf16 v[68:71], a[40:43], v[172:175], v[68:71]
    v_mov_b32 v5, 65536
    s_mov_b64 exec, 1
    buffer_atomic_add v5, off, s[8:11], s49 sc1
    s_mov_b64 exec, -1
    v_mfma_f32_16x16x32_bf16 v[60:63], a[36:39], v[172:175], v[60:63]
    v_mfma_f32_16x16x32_bf16 v[52:55], a[32:35], v[172:175], v[52:55]
    s_waitcnt vmcnt(15)
    v_mfma_f32_16x16x32_bf16 v[16:19], a[48:51], v[176:179], v[16:19]
    buffer_load_dwordx4 v[232:235], v6, s[8:11], s51 offen offset:3072 sc1
    v_mfma_f32_16x16x32_bf16 v[24:27], a[52:55], v[176:179], v[24:27]
    v_mfma_f32_16x16x32_bf16 v[32:35], a[56:59], v[176:179], v[32:35]
    v_mfma_f32_16x16x32_bf16 v[40:43], a[60:63], v[176:179], v[40:43]
    s_waitcnt vmcnt(15)
    v_mfma_f32_16x16x32_bf16 v[44:47], a[60:63], v[180:183], v[44:47]
    buffer_load_dwordx4 v[236:239], v6, s[8:11], s51 offen offset:3328 sc1
    v_mfma_f32_16x16x32_bf16 v[36:39], a[56:59], v[180:183], v[36:39]
    v_mfma_f32_16x16x32_bf16 v[28:31], a[52:55], v[180:183], v[28:31]
    v_mfma_f32_16x16x32_bf16 v[20:23], a[48:51], v[180:183], v[20:23]
    s_waitcnt vmcnt(15)
    v_mfma_f32_16x16x32_bf16 v[48:51], a[48:51], v[184:187], v[48:51]
    buffer_load_dwordx4 v[240:243], v7, s[8:11], s50 offen offset:3072 sc1
    v_mfma_f32_16x16x32_bf16 v[56:59], a[52:55], v[184:187], v[56:59]
    v_mfma_f32_16x16x32_bf16 v[64:67], a[56:59], v[184:187], v[64:67]
    v_mfma_f32_16x16x32_bf16 v[72:75], a[60:63], v[184:187], v[72:75]
    s_waitcnt vmcnt(14)
    v_mfma_f32_16x16x32_bf16 v[76:79], a[60:63], v[188:191], v[76:79]
    buffer_load_dwordx4 v[244:247], v7, s[8:11], s50 offen offset:3328 sc1
    v_mfma_f32_16x16x32_bf16 v[68:71], a[56:59], v[188:191], v[68:71]
    v_mfma_f32_16x16x32_bf16 v[60:63], a[52:55], v[188:191], v[60:63]
    v_mfma_f32_16x16x32_bf16 v[52:55], a[48:51], v[188:191], v[52:55]
    s_waitcnt vmcnt(14)
    v_mfma_f32_16x16x32_bf16 v[16:19], a[64:67], v[192:195], v[16:19]
    buffer_load_dwordx4 v[248:251], v7, s[8:11], s51 offen offset:3072 sc1
    v_mfma_f32_16x16x32_bf16 v[24:27], a[68:71], v[192:195], v[24:27]
    v_mfma_f32_16x16x32_bf16 v[32:35], a[72:75], v[192:195], v[32:35]
    v_mfma_f32_16x16x32_bf16 v[40:43], a[76:79], v[192:195], v[40:43]
    s_waitcnt vmcnt(14)
    v_mfma_f32_16x16x32_bf16 v[44:47], a[76:79], v[196:199], v[44:47]
    buffer_load_dwordx4 v[252:255], v7, s[8:11], s51 offen offset:3328 sc1
    v_mfma_f32_16x16x32_bf16 v[36:39], a[72:75], v[196:199], v[36:39]
    v_mfma_f32_16x16x32_bf16 v[28:31], a[68:71], v[196:199], v[28:31]
    v_mfma_f32_16x16x32_bf16 v[20:23], a[64:67], v[196:199], v[20:23]
    s_waitcnt vmcnt(14)
    v_mfma_f32_16x16x32_bf16 v[48:51], a[64:67], v[200:203], v[48:51]
    buffer_load_dwordx4 v[80:83], v6, s[8:11], s6 offen offset:0 sc1
    v_mfma_f32_16x16x32_bf16 v[56:59], a[68:71], v[200:203], v[56:59]
    s_mov_b32 s54, 0
    s_atomic_add s54, s[4:5], s48 glc
    s_mov_b32 s55, 0
    s_atomic_add s55, s[4:5], s37 glc
    v_mfma_f32_16x16x32_bf16 v[64:67], a[72:75], v[200:203], v[64:67]
    v_mfma_f32_16x16x32_bf16 v[72:75], a[76:79], v[200:203], v[72:75]
    s_waitcnt vmcnt(14)
    v_mfma_f32_16x16x32_bf16 v[76:79], a[76:79], v[204:207], v[76:79]
    buffer_load_dwordx4 v[84:87], v6, s[8:11], s6 offen offset:256 sc1
    v_mfma_f32_16x16x32_bf16 v[68:71], a[72:75], v[204:207], v[68:71]
    v_mfma_f32_16x16x32_bf16 v[60:63], a[68:71], v[204:207], v[60:63]
    v_mfma_f32_16x16x32_bf16 v[52:55], a[64:67], v[204:207], v[52:55]
    s_waitcnt vmcnt(14)
    v_mfma_f32_16x16x32_bf16 v[16:19], a[80:83], v[208:211], v[16:19]
    buffer_load_dwordx4 v[88:91], v6, s[8:11], s7 offen offset:0 sc1
    v_mfma_f32_16x16x32_bf16 v[24:27], a[84:87], v[208:211], v[24:27]
    v_mfma_f32_16x16x32_bf16 v[32:35], a[88:91], v[208:211], v[32:35]
    v_mfma_f32_16x16x32_bf16 v[40:43], a[92:95], v[208:211], v[40:43]
    s_waitcnt vmcnt(14)
    v_mfma_f32_16x16x32_bf16 v[44:47], a[92:95], v[212:215], v[44:47]
    buffer_load_dwordx4 v[92:95], v6, s[8:11], s7 offen offset:256 sc1
    v_mfma_f32_16x16x32_bf16 v[36:39], a[88:91], v[212:215], v[36:39]
    v_mov_b32 v5, 16777216
    s_mov_b64 exec, 1
    buffer_atomic_add v5, off, s[8:11], s49 sc1
    s_mov_b64 exec, -1
    v_mfma_f32_16x16x32_bf16 v[28:31], a[84:87], v[212:215], v[28:31]
    v_mfma_f32_16x16x32_bf16 v[20:23], a[80:83], v[212:215], v[20:23]
    s_waitcnt vmcnt(15)
    v_mfma_f32_16x16x32_bf16 v[48:51], a[80:83], v[216:219], v[48:51]
    buffer_load_dwordx4 v[96:99], v7, s[8:11], s6 offen offset:0 sc1
    v_mfma_f32_16x16x32_bf16 v[56:59], a[84:87], v[216:219], v[56:59]
    v_mfma_f32_16x16x32_bf16 v[64:67], a[88:91], v[216:219], v[64:67]
    v_mfma_f32_16x16x32_bf16 v[72:75], a[92:95], v[216:219], v[72:75]
    s_waitcnt vmcnt(15)
    v_mfma_f32_16x16x32_bf16 v[76:79], a[92:95], v[220:223], v[76:79]
    buffer_load_dwordx4 v[100:103], v7, s[8:11], s6 offen offset:256 sc1
    v_mfma_f32_16x16x32_bf16 v[68:71], a[88:91], v[220:223], v[68:71]
    v_mfma_f32_16x16x32_bf16 v[60:63], a[84:87], v[220:223], v[60:63]
    v_mfma_f32_16x16x32_bf16 v[52:55], a[80:83], v[220:223], v[52:55]
    s_waitcnt vmcnt(15)
    v_mfma_f32_16x16x32_bf16 v[16:19], a[96:99], v[224:227], v[16:19]
    buffer_load_dwordx4 v[104:107], v7, s[8:11], s7 offen offset:0 sc1
    v_mfma_f32_16x16x32_bf16 v[24:27], a[100:103], v[224:227], v[24:27]
    v_mfma_f32_16x16x32_bf16 v[32:35], a[104:107], v[224:227], v[32:35]
    v_mfma_f32_16x16x32_bf16 v[40:43], a[108:111], v[224:227], v[40:43]
    s_waitcnt vmcnt(15)
    v_mfma_f32_16x16x32_bf16 v[44:47], a[108:111], v[228:231], v[44:47]
    buffer_load_dwordx4 v[108:111], v7, s[8:11], s7 offen offset:256 sc1
    v_mfma_f32_16x16x32_bf16 v[36:39], a[104:107], v[228:231], v[36:39]
    v_mfma_f32_16x16x32_bf16 v[28:31], a[100:103], v[228:231], v[28:31]
    v_mfma_f32_16x16x32_bf16 v[20:23], a[96:99], v[228:231], v[20:23]
    s_waitcnt vmcnt(14)
    v_mfma_f32_16x16x32_bf16 v[48:51], a[96:99], v[232:235], v[48:51]
    v_mfma_f32_16x16x32_bf16 v[56:59], a[100:103], v[232:235], v[56:59]
    s_waitcnt lgkmcnt(0)
    s_and_b32 s54, s54, s55
    s_bitcmp1_b32 s54, 18
    s_cbranch_scc1 L_ok_38
    s_mov_b32 s41, 65536
L_spin_37:
    s_mov_b32 s54, 0
    s_atomic_add s54, s[4:5], s48 glc
    s_mov_b32 s55, 0
    s_atomic_add s55, s[4:5], s37 glc
    s_waitcnt lgkmcnt(0)
    s_and_b32 s54, s54, s55
    s_bitcmp1_b32 s54, 18
    s_cbranch_scc1 L_ok_38
    s_sub_u32 s41, s41, 1
    s_cbranch_scc0 L_spin_37
L_ok_38:
    buffer_load_dwordx4 v[112:115], v6, s[8:11], s6 offen offset:1024 sc1
    v_mfma_f32_16x16x32_bf16 v[64:67], a[104:107], v[232:235], v[64:67]
    v_mfma_f32_16x16x32_bf16 v[72:75], a[108:111], v[232:235], v[72:75]
    s_waitcnt vmcnt(14)
    v_mfma_f32_16x16x32_bf16 v[76:79], a[108:111], v[236:239], v[76:79]
    buffer_load_dwordx4 v[116:119], v6, s[8:11], s6 offen offset:1280 sc1
    v_mfma_f32_16x16x32_bf16 v[68:71], a[104:107], v[236:239], v[68:71]
    v_mfma_f32_16x16x32_bf16 v[60:63], a[100:103], v[236:239], v[60:63]
    v_mfma_f32_16x16x32_bf16 v[52:55], a[96:99], v[236:239], v[52:55]
    s_waitcnt vmcnt(14)
    v_mfma_f32_16x16x32_bf16 v[16:19], a[112:115], v[240:243], v[16:19]
    buffer_load_dwordx4 v[120:123], v6, s[8:11], s7 offen offset:1024 sc1
    v_mfma_f32_16x16x32_bf16 v[24:27], a[116:119], v[240:243], v[24:27]
    s_mov_b32 s54, 0
    s_atomic_add s54, s[4:5], s48 glc
    s_mov_b32 s55, 0
    s_atomic_add s55, s[4:5], s37 glc
    v_mfma_f32_16x16x32_bf16 v[32:35], a[120:123], v[240:243], v[32:35]
    v_mfma_f32_16x16x32_bf16 v[40:43], a[124:127], v[240:243], v[40:43]
    s_waitcnt vmcnt(14)
    v_mfma_f32_16x16x32_bf16 v[44:47], a[124:127], v[244:247], v[44:47]
    buffer_load_dwordx4 v[124:127], v6, s[8:11], s7 offen offset:1280 sc1
    v_mfma_f32_16x16x32_bf16 v[36:39], a[120:123], v[244:247], v[36:39]
    v_mfma_f32_16x16x32_bf16 v[28:31], a[116:119], v[244:247], v[28:31]
    v_mfma_f32_16x16x32_bf16 v[20:23], a[112:115], v[244:247], v[20:23]
    s_waitcnt vmcnt(14)
    v_mfma_f32_16x16x32_bf16 v[48:51], a[112:115], v[248:251], v[48:51]
    buffer_load_dwordx4 v[128:131], v7, s[8:11], s6 offen offset:1024 sc1
    v_mfma_f32_16x16x32_bf16 v[56:59], a[116:119], v[248:251], v[56:59]
    v_mfma_f32_16x16x32_bf16 v[64:67], a[120:123], v[248:251], v[64:67]
    v_mfma_f32_16x16x32_bf16 v[72:75], a[124:127], v[248:251], v[72:75]
    s_waitcnt vmcnt(14)
    v_mfma_f32_16x16x32_bf16 v[76:79], a[124:127], v[252:255], v[76:79]
    buffer_load_dwordx4 v[132:135], v7, s[8:11], s6 offen offset:1280 sc1
    v_mfma_f32_16x16x32_bf16 v[68:71], a[120:123], v[252:255], v[68:71]
    v_mfma_f32_16x16x32_bf16 v[60:63], a[116:119], v[252:255], v[60:63]
    v_mfma_f32_16x16x32_bf16 v[52:55], a[112:115], v[252:255], v[52:55]
    s_waitcnt vmcnt(14)
    v_mfma_f32_16x16x32_bf16 v[16:19], a[128:131], v[80:83], v[16:19]
    buffer_load_dwordx4 v[136:139], v7, s[8:11], s7 offen offset:1024 sc1
    v_mfma_f32_16x16x32_bf16 v[24:27], a[132:135], v[80:83], v[24:27]
    v_mfma_f32_16x16x32_bf16 v[32:35], a[136:139], v[80:83], v[32:35]
    v_mfma_f32_16x16x32_bf16 v[40:43], a[140:143], v[80:83], v[40:43]
    s_waitcnt vmcnt(14)
    v_mfma_f32_16x16x32_bf16 v[44:47], a[140:143], v[84:87], v[44:47]
    buffer_load_dwordx4 v[140:143], v7, s[8:11], s7 offen offset:1280 sc1
    v_mfma_f32_16x16x32_bf16 v[36:39], a[136:139], v[84:87], v[36:39]
    v_mfma_f32_16x16x32_bf16 v[28:31], a[132:135], v[84:87], v[28:31]
    v_mfma_f32_16x16x32_bf16 v[20:23], a[128:131], v[84:87], v[20:23]
    s_waitcnt vmcnt(14)
    v_mfma_f32_16x16x32_bf16 v[48:51], a[128:131], v[88:91], v[48:51]
    v_mfma_f32_16x16x32_bf16 v[56:59], a[132:135], v[88:91], v[56:59]
    v_mfma_f32_16x16x32_bf16 v[64:67], a[136:139], v[88:91], v[64:67]
    v_mfma_f32_16x16x32_bf16 v[72:75], a[140:143], v[88:91], v[72:75]
    s_waitcnt vmcnt(13)
    v_mfma_f32_16x16x32_bf16 v[76:79], a[140:143], v[92:95], v[76:79]
    v_mfma_f32_16x16x32_bf16 v[68:71], a[136:139], v[92:95], v[68:71]
    v_mfma_f32_16x16x32_bf16 v[60:63], a[132:135], v[92:95], v[60:63]
    v_mfma_f32_16x16x32_bf16 v[52:55], a[128:131], v[92:95], v[52:55]
    s_waitcnt vmcnt(11)
    v_mfma_f32_16x16x32_bf16 v[16:19], a[144:147], v[96:99], v[16:19]
    v_mfma_f32_16x16x32_bf16 v[24:27], a[148:151], v[96:99], v[24:27]
    s_waitcnt lgkmcnt(0)
    s_and_b32 s54, s54, s55
    s_bitcmp1_b32 s54, 26
    s_cbranch_scc1 L_ok_40
    s_mov_b32 s41, 65536
L_spin_39:
    s_mov_b32 s54, 0
    s_atomic_add s54, s[4:5], s48 glc
    s_mov_b32 s55, 0
    s_atomic_add s55, s[4:5], s37 glc
    s_waitcnt lgkmcnt(0)
    s_and_b32 s54, s54, s55
    s_bitcmp1_b32 s54, 26
    s_cbranch_scc1 L_ok_40
    s_sub_u32 s41, s41, 1
    s_cbranch_scc0 L_spin_39
L_ok_40:
    buffer_load_dwordx4 v[144:147], v6, s[8:11], s7 offen offset:2048 sc1
    v_mfma_f32_16x16x32_bf16 v[32:35], a[152:155], v[96:99], v[32:35]
    buffer_load_dwordx4 v[148:151], v6, s[8:11], s7 offen offset:2304 sc1
    v_mfma_f32_16x16x32_bf16 v[40:43], a[156:159], v[96:99], v[40:43]
    s_waitcnt vmcnt(12)
    v_mfma_f32_16x16x32_bf16 v[44:47], a[156:159], v[100:103], v[44:47]
    buffer_load_dwordx4 v[152:155], v7, s[8:11], s7 offen offset:2048 sc1
    v_mfma_f32_16x16x32_bf16 v[36:39], a[152:155], v[100:103], v[36:39]
    v_mfma_f32_16x16x32_bf16 v[28:31], a[148:151], v[100:103], v[28:31]
    buffer_load_dwordx4 v[156:159], v7, s[8:11], s7 offen offset:2304 sc1
    v_mfma_f32_16x16x32_bf16 v[20:23], a[144:147], v[100:103], v[20:23]
    s_waitcnt vmcnt(13)
    v_mfma_f32_16x16x32_bf16 v[48:51], a[144:147], v[104:107], v[48:51]
    buffer_load_dwordx4 v[160:163], v6, s[8:11], s6 offen offset:2048 sc1
    v_mfma_f32_16x16x32_bf16 v[56:59], a[148:151], v[104:107], v[56:59]
    v_mfma_f32_16x16x32_bf16 v[64:67], a[152:155], v[104:107], v[64:67]
    buffer_load_dwordx4 v[164:167], v6, s[8:11], s6 offen offset:2304 sc1
    v_mfma_f32_16x16x32_bf16 v[72:75], a[156:159], v[104:107], v[72:75]
    s_waitcnt vmcnt(14)
    v_mfma_f32_16x16x32_bf16 v[76:79], a[156:159], v[108:111], v[76:79]
    buffer_load_dwordx4 v[168:171], v7, s[8:11], s6 offen offset:2048 sc1
    v_mfma_f32_16x16x32_bf16 v[68:71], a[152:155], v[108:111], v[68:71]
    v_mfma_f32_16x16x32_bf16 v[60:63], a[148:151], v[108:111], v[60:63]
    buffer_load_dwordx4 v[172:175], v7, s[8:11], s6 offen offset:2304 sc1
    v_mfma_f32_16x16x32_bf16 v[52:55], a[144:147], v[108:111], v[52:55]
    s_waitcnt vmcnt(15)
    v_mfma_f32_16x16x32_bf16 v[16:19], a[160:163], v[112:115], v[16:19]
    v_mfma_f32_16x16x32_bf16 v[24:27], a[164:167], v[112:115], v[24:27]
    v_mfma_f32_16x16x32_bf16 v[32:35], a[168:171], v[112:115], v[32:35]
    v_mfma_f32_16x16x32_bf16 v[40:43], a[172:175], v[112:115], v[40:43]
    s_waitcnt vmcnt(14)
    v_mfma_f32_16x16x32_bf16 v[44:47], a[172:175], v[116:119], v[44:47]
    v_mfma_f32_16x16x32_bf16 v[36:39], a[168:171], v[116:119], v[36:39]
    v_mfma_f32_16x16x32_bf16 v[28:31], a[164:167], v[116:119], v[28:31]
    v_mfma_f32_16x16x32_bf16 v[20:23], a[160:163], v[116:119], v[20:23]
    s_waitcnt vmcnt(13)
    v_mfma_f32_16x16x32_bf16 v[48:51], a[160:163], v[120:123], v[48:51]
    v_mfma_f32_16x16x32_bf16 v[56:59], a[164:167], v[120:123], v[56:59]
    v_mfma_f32_16x16x32_bf16 v[64:67], a[168:171], v[120:123], v[64:67]
    v_mfma_f32_16x16x32_bf16 v[72:75], a[172:175], v[120:123], v[72:75]
    s_waitcnt vmcnt(12)
    v_mfma_f32_16x16x32_bf16 v[76:79], a[172:175], v[124:127], v[76:79]
    v_mfma_f32_16x16x32_bf16 v[68:71], a[168:171], v[124:127], v[68:71]
    v_mfma_f32_16x16x32_bf16 v[60:63], a[164:167], v[124:127], v[60:63]
    v_mfma_f32_16x16x32_bf16 v[52:55], a[160:163], v[124:127], v[52:55]
    s_waitcnt vmcnt(11)
    v_mfma_f32_16x16x32_bf16 v[16:19], a[176:179], v[128:131], v[16:19]
    v_mfma_f32_16x16x32_bf16 v[24:27], a[180:183], v[128:131], v[24:27]
    v_mfma_f32_16x16x32_bf16 v[32:35], a[184:187], v[128:131], v[32:35]
    v_mfma_f32_16x16x32_bf16 v[40:43], a[188:191], v[128:131], v[40:43]
    s_waitcnt vmcnt(10)
    v_mfma_f32_16x16x32_bf16 v[44:47], a[188:191], v[132:135], v[44:47]
    v_mfma_f32_16x16x32_bf16 v[36:39], a[184:187], v[132:135], v[36:39]
    v_mfma_f32_16x16x32_bf16 v[28:31], a[180:183], v[132:135], v[28:31]
    v_mfma_f32_16x16x32_bf16 v[20:23], a[176:179], v[132:135], v[20:23]
    s_waitcnt vmcnt(9)
    v_mfma_f32_16x16x32_bf16 v[48:51], a[176:179], v[136:139], v[48:51]
    v_mfma_f32_16x16x32_bf16 v[56:59], a[180:183], v[136:139], v[56:59]
    s_xor_b32 s42, s3, 1
    s_lshl_b32 s42, s42, 14
    v_mfma_f32_16x16x32_bf16 v[64:67], a[184:187], v[136:139], v[64:67]
    v_mfma_f32_16x16x32_bf16 v[72:75], a[188:191], v[136:139], v[72:75]
    s_add_u32 s42, s42, 98304
    v_add_u32 v120, s42, v1
    s_waitcnt vmcnt(8)
    v_mfma_f32_16x16x32_bf16 v[76:79], a[188:191], v[140:143], v[76:79]
    v_mfma_f32_16x16x32_bf16 v[68:71], a[184:187], v[140:143], v[68:71]
    s_xor_b32 s42, s3, 2
    s_lshl_b32 s42, s42, 14
    v_mfma_f32_16x16x32_bf16 v[60:63], a[180:183], v[140:143], v[60:63]
    v_mfma_f32_16x16x32_bf16 v[52:55], a[176:179], v[140:143], v[52:55]
    s_add_u32 s42, s42, 102400
    v_add_u32 v121, s42, v1
    s_waitcnt vmcnt(7)
    v_mfma_f32_16x16x32_bf16 v[48:51], a[192:195], v[144:147], v[48:51]
    v_mfma_f32_16x16x32_bf16 v[56:59], a[196:199], v[144:147], v[56:59]
    s_xor_b32 s42, s3, 3
    s_lshl_b32 s42, s42, 14
    v_mfma_f32_16x16x32_bf16 v[64:67], a[200:203], v[144:147], v[64:67]
    v_mfma_f32_16x16x32_bf16 v[72:75], a[204:207], v[144:147], v[72:75]
    s_add_u32 s42, s42, 106496
    v_add_u32 v122, s42, v1
    s_waitcnt vmcnt(6)
    v_mfma_f32_16x16x32_bf16 v[76:79], a[204:207], v[148:151], v[76:79]
    v_mfma_f32_16x16x32_bf16 v[68:71], a[200:203], v[148:151], v[68:71]
    v_mfma_f32_16x16x32_bf16 v[60:63], a[196:199], v[148:151], v[60:63]
    v_mfma_f32_16x16x32_bf16 v[52:55], a[192:195], v[148:151], v[52:55]
    s_waitcnt vmcnt(5)
    v_mfma_f32_16x16x32_bf16 v[48:51], a[208:211], v[152:155], v[48:51]
    v_mfma_f32_16x16x32_bf16 v[56:59], a[212:215], v[152:155], v[56:59]
    v_mfma_f32_16x16x32_bf16 v[64:67], a[216:219], v[152:155], v[64:67]
    v_mfma_f32_16x16x32_bf16 v[72:75], a[220:223], v[152:155], v[72:75]
    s_waitcnt vmcnt(4)
    v_mfma_f32_16x16x32_bf16 v[76:79], a[220:223], v[156:159], v[76:79]
    v_mfma_f32_16x16x32_bf16 v[68:71], a[216:219], v[156:159], v[68:71]
    v_mfma_f32_16x16x32_bf16 v[60:63], a[212:215], v[156:159], v[60:63]
    v_mfma_f32_16x16x32_bf16 v[52:55], a[208:211], v[156:159], v[52:55]
    s_waitcnt vmcnt(3)
    v_mfma_f32_16x16x32_bf16 v[16:19], a[192:195], v[160:163], v[16:19]
    v_mfma_f32_16x16x32_bf16 v[24:27], a[196:199], v[160:163], v[24:27]
    v_mfma_f32_16x16x32_bf16 v[32:35], a[200:203], v[160:163], v[32:35]
    v_mfma_f32_16x16x32_bf16 v[40:43], a[204:207], v[160:163], v[40:43]
    s_waitcnt vmcnt(2)
    v_mfma_f32_16x16x32_bf16 v[44:47], a[204:207], v[164:167], v[44:47]
    ds_write_b128 v121, v[48:51] offset:0
    v_mfma_f32_16x16x32_bf16 v[36:39], a[200:203], v[164:167], v[36:39]
    v_mfma_f32_16x16x32_bf16 v[28:31], a[196:199], v[164:167], v[28:31]
    ds_write_b128 v121, v[52:55] offset:1024
    v_mfma_f32_16x16x32_bf16 v[20:23], a[192:195], v[164:167], v[20:23]
    s_waitcnt vmcnt(1)
    v_mfma_f32_16x16x32_bf16 v[16:19], a[208:211], v[168:171], v[16:19]
    ds_write_b128 v121, v[56:59] offset:2048
    v_mfma_f32_16x16x32_bf16 v[24:27], a[212:215], v[168:171], v[24:27]
    v_mfma_f32_16x16x32_bf16 v[32:35], a[216:219], v[168:171], v[32:35]
    ds_write_b128 v121, v[60:63] offset:3072
    v_mfma_f32_16x16x32_bf16 v[40:43], a[220:223], v[168:171], v[40:43]
    s_waitcnt vmcnt(0)
    v_mfma_f32_16x16x32_bf16 v[44:47], a[220:223], v[172:175], v[44:47]
    ds_write_b128 v122, v[64:67] offset:0
    v_mfma_f32_16x16x32_bf16 v[36:39], a[216:219], v[172:175], v[36:39]
    v_mfma_f32_16x16x32_bf16 v[28:31], a[212:215], v[172:175], v[28:31]
    ds_write_b128 v122, v[68:71] offset:1024
    v_mfma_f32_16x16x32_bf16 v[20:23], a[208:211], v[172:175], v[20:23]
    ds_write_b128 v122, v[72:75] offset:2048
    ds_write_b128 v122, v[76:79] offset:3072
    v_and_b32 v7, 0xf0, v1
    v_lshlrev_b32 v7, 6, v7
    v_lshrrev_b32 v8, 8, v1
    v_lshl_add_u32 v7, v8, 4, v7
    s_lshl_b32 s42, s30, 15
    s_lshl_b32 s43, s31, 6
    s_add_u32 s42, s42, s43
    s_add_u32 s46, s42, 16384
    ds_write_b128 v120, v[32:35] offset:0
    ds_write_b128 v120, v[36:39] offset:1024
    ds_write_b128 v120, v[40:43] offset:2048
    ds_write_b128 v120, v[44:47] offset:3072
    v_accvgpr_read_b32 v5, a239
    s_waitcnt lgkmcnt(0)
    s_barrier
    ds_read_b128 v[80:83], v5 offset:0
    ds_read_b128 v[84:87], v5 offset:1024
    ds_read_b128 v[88:91], v5 offset:2048
    ds_read_b128 v[92:95], v5 offset:3072
    ds_read_b128 v[96:99], v5 offset:4096
    ds_read_b128 v[100:103], v5 offset:5120
    ds_read_b128 v[104:107], v5 offset:6144
    ds_read_b128 v[108:111], v5 offset:7168
    ds_read_b128 v[112:115], v5 offset:8192
    ds_read_b128 v[116:119], v5 offset:9216
    ds_read_b128 v[120:123], v5 offset:10240
    ds_read_b128 v[124:127], v5 offset:11264
    s_waitcnt lgkmcnt(11)
    v_pk_add_f32 v[16:17], v[16:17], v[80:81]
    v_pk_add_f32 v[18:19], v[18:19], v[82:83]
    s_waitcnt lgkmcnt(10)
    v_pk_add_f32 v[20:21], v[20:21], v[84:85]
    v_pk_add_f32 v[22:23], v[22:23], v[86:87]
    s_waitcnt lgkmcnt(9)
    v_pk_add_f32 v[24:25], v[24:25], v[88:89]
    v_pk_add_f32 v[26:27], v[26:27], v[90:91]
    s_waitcnt lgkmcnt(8)
    v_pk_add_f32 v[28:29], v[28:29], v[92:93]
    v_pk_add_f32 v[30:31], v[30:31], v[94:95]
    s_waitcnt lgkmcnt(7)
    v_pk_add_f32 v[16:17], v[16:17], v[96:97]
    v_pk_add_f32 v[18:19], v[18:19], v[98:99]
    s_waitcnt lgkmcnt(6)
    v_pk_add_f32 v[20:21], v[20:21], v[100:101]
    v_pk_add_f32 v[22:23], v[22:23], v[102:103]
    s_waitcnt lgkmcnt(5)
    v_pk_add_f32 v[24:25], v[24:25], v[104:105]
    v_pk_add_f32 v[26:27], v[26:27], v[106:107]
    s_waitcnt lgkmcnt(4)
    v_pk_add_f32 v[28:29], v[28:29], v[108:109]
    v_pk_add_f32 v[30:31], v[30:31], v[110:111]
    s_waitcnt lgkmcnt(3)
    v_pk_add_f32 v[16:17], v[16:17], v[112:113]
    v_pk_add_f32 v[18:19], v[18:19], v[114:115]
    s_waitcnt lgkmcnt(2)
    v_pk_add_f32 v[20:21], v[20:21], v[116:117]
    v_pk_add_f32 v[22:23], v[22:23], v[118:119]
    s_waitcnt lgkmcnt(1)
    v_pk_add_f32 v[24:25], v[24:25], v[120:121]
    v_pk_add_f32 v[26:27], v[26:27], v[122:123]
    s_waitcnt lgkmcnt(0)
    v_pk_add_f32 v[28:29], v[28:29], v[124:125]
    v_pk_add_f32 v[30:31], v[30:31], v[126:127]
    v_cvt_pk_bf16_f32 v32, v16, v17
    v_cvt_pk_bf16_f32 v33, v18, v19
    v_cvt_pk_bf16_f32 v34, v24, v25
    v_cvt_pk_bf16_f32 v35, v26, v27
    buffer_store_dwordx4 v[32:35], v7, s[12:15], s42 offen
    v_cvt_pk_bf16_f32 v36, v20, v21
    v_cvt_pk_bf16_f32 v37, v22, v23
    v_cvt_pk_bf16_f32 v38, v28, v29
    v_cvt_pk_bf16_f32 v39, v30, v31
    buffer_store_dwordx4 v[36:39], v7, s[12:15], s46 offen
    s_or_b32 s42, s2, s3
    s_cmp_lg_u32 s42, 0
    s_cbranch_scc1 L_exit
    s_mov_b32 s42, 7815168
    v_mov_b32 v8, 0
    v_mov_b32 v9, s60
    s_mov_b64 exec, 1
    buffer_store_dword v9, v8, s[8:11], s42 offen sc1
L_exit:
    s_endpgm
L_code_end:
.section .rodata,"a"
.p2align 6
.amdhsa_kernel interleave_layers__linear_kernel_hedgehog__glu_gated_bilinear__prompt_kernel
  .amdhsa_next_free_vgpr 512
  .amdhsa_next_free_sgpr 102
  .amdhsa_accum_offset 256
  .amdhsa_group_segment_fixed_size 0
  .amdhsa_kernarg_size 88
  .amdhsa_user_sgpr_count 2
  .amdhsa_user_sgpr_kernarg_segment_ptr 1
  .amdhsa_system_sgpr_workgroup_id_x 1
  .amdhsa_float_denorm_mode_32 3
.end_amdhsa_kernel
```
